```python
import torch

def _softmax(x, axis=-1):
    return torch.softmax(x, dim=axis)
def _gelu(x):
    return torch.nn.functional.gelu(x, approximate="tanh")
def _silu(x):
    return torch.nn.functional.silu(x)
def _sigmoid(x):
    return torch.sigmoid(x)
def _layernorm(x, axis=-1, eps=1e-5):
    m = x.mean(dim=axis, keepdim=True)
    v = x.var(dim=axis, keepdim=True, unbiased=False)
    return (x - m) / torch.sqrt(v + eps)
def _scatter_add(tgt, idx, src, axis=0):
    return tgt.clone().index_add_(axis, idx, src)
def _segment_sum(src, seg, n):
    out = torch.zeros((n,) + src.shape[1:], dtype=src.dtype)
    return out.index_add_(0, seg, src)
def _pad(x, pw):
    flat = tuple(v for pair in reversed(pw) for v in pair)
    return torch.nn.functional.pad(x, flat)

kernel_name = 'standalone__mha_softmax__near_ridge'

def setup_inputs():

    _w = (lambda a: (lambda t: t.to(torch.bfloat16) if t.is_floating_point() else t)(torch.as_tensor(a)))
    B, H, Sq, Sk, D = 16, 32, 384, 1024, 128
    return {
        "q": _w((lambda *s: torch.randn(*s, dtype=torch.bfloat16) * 0.8)(B, H, Sq, D)),
        "k": _w((lambda *s: torch.randn(*s, dtype=torch.bfloat16) * 0.8)(B, H, Sk, D)),
        "v": _w((lambda *s: torch.randn(*s, dtype=torch.bfloat16) * 0.05)(B, H, Sk, D)),
    }

def reference(q, k, v):
    scale = q.shape[-1] ** -0.5
    scores = torch.einsum("bhqd,bhkd->bhqk", q, k) * scale
    p = _softmax(scores, axis=-1)
    return torch.einsum("bhqk,bhkd->bhqd", p, v)
```

```asm
; @launch grid=(256,1,1) block=(256,1,1) lds=163840
.amdgcn_target "amdgcn-amd-amdhsa--gfx950"
.text
.globl standalone__mha_softmax__near_ridge_kernel
.p2align 8
.type standalone__mha_softmax__near_ridge_kernel,@function
standalone__mha_softmax__near_ridge_kernel:
  s_cmp_ge_u32 s2, 256
  s_cbranch_scc1 L_exit
  s_load_dwordx8 s[36:43], s[0:1], 0
  v_lshrrev_b32 v21, 6, v0
  v_and_b32 v0, 63, v0
  v_readfirstlane_b32 s24, v21
  v_and_b32 v244, 15, v0
  v_lshrrev_b32 v245, 4, v0
  s_mov_b32 s26, s2
  v_lshlrev_b32 v240, 8, v244
  v_xor_b32 v243, v245, v244
  s_mul_i32 s48, s24, 24576
  s_lshl_b32 s25, s24, 12
  s_lshl_b32 s65, s24, 13
  s_add_u32 s65, s65, 131072
  v_add_u32 v240, s48, v240
  v_lshl_add_u32 v19, v245, 4, v240
  v_lshlrev_b32 v241, 8, v245
  v_add_u32 v241, s25, v241
  v_xor_b32 v242, 0, v243
  v_lshl_add_u32 v13, v242, 4, v241
  v_xor_b32 v242, 4, v243
  v_lshl_add_u32 v14, v242, 4, v241
  v_xor_b32 v242, 8, v243
  v_lshl_add_u32 v15, v242, 4, v241
  v_xor_b32 v242, 12, v243
  v_lshl_add_u32 v16, v242, 4, v241
  s_mov_b32 s10, 50331648
  s_mov_b32 s11, 0x20000
  s_mov_b32 s14, 134217728
  s_mov_b32 s15, 0x20000
  s_waitcnt lgkmcnt(0)
  s_mov_b32 s8, s36
  s_and_b32 s9, s37, 0xffff
  s_mov_b32 s12, s38
  s_and_b32 s13, s39, 0xffff
  s_mul_i32 s62, s26, 98304
  s_mul_i32 s49, s24, 20480
  s_add_u32 s62, s62, s49
  s_mul_i32 s28, s26, 262144
  s_add_u32 s33, s62, 0
  s_add_u32 m0, s65, 0
  s_nop 0
  buffer_load_dwordx4 v13, s[8:11], s33 offen offset:0 nt lds
  buffer_load_dwordx4 v14, s[8:11], s33 offen offset:1024 nt lds
  buffer_load_dwordx4 v15, s[8:11], s33 offen offset:2048 nt lds
  buffer_load_dwordx4 v16, s[8:11], s33 offen offset:3072 nt lds
  s_add_u32 m0, s25, 0
  s_nop 0
  buffer_load_dwordx4 v13, s[12:15], s28 offen offset:0 nt lds
  buffer_load_dwordx4 v14, s[12:15], s28 offen offset:1024 nt lds
  buffer_load_dwordx4 v15, s[12:15], s28 offen offset:2048 nt lds
  buffer_load_dwordx4 v16, s[12:15], s28 offen offset:3072 nt lds
  s_add_u32 s33, s62, 4096
  s_add_u32 m0, s65, 4096
  s_nop 0
  buffer_load_dwordx4 v13, s[8:11], s33 offen offset:0 nt lds
  buffer_load_dwordx4 v14, s[8:11], s33 offen offset:1024 nt lds
  buffer_load_dwordx4 v15, s[8:11], s33 offen offset:2048 nt lds
  buffer_load_dwordx4 v16, s[8:11], s33 offen offset:3072 nt lds
  s_getpc_b64 s[72:73]
L_pc:
  s_lshr_b32 s49, s2, 3
  s_lshl_b32 s49, s49, 2
  s_add_u32 s49, s49, s24
  s_cmp_ge_u32 s49, 41
  s_cbranch_scc1 L_nocpf
  s_lshl_b32 s49, s49, 10
  v_mbcnt_lo_u32_b32 v252, -1, 0
  v_mbcnt_hi_u32_b32 v252, -1, v252
  v_lshlrev_b32 v252, 4, v252
  v_add_u32 v252, s49, v252
  v_min_u32 v252, L_max_pre - L_pc - 16, v252
  global_load_dwordx4 v[252:255], v252, s[72:73]
L_nocpf:
  s_mov_b32 s16, s40
  s_and_b32 s17, s41, 0xffff
  s_mov_b32 s18, 134217728
  s_mov_b32 s19, 0x20000
  s_mov_b32 s20, s42
  s_and_b32 s21, s43, 0xffff
  s_mov_b32 s22, 50331648
  s_mov_b32 s23, 0x20000
  v_lshlrev_b32 v240, 1, v245
  v_xor_b32 v240, v240, v244
  v_xor_b32 v242, 0, v240
  v_lshl_add_u32 v17, v242, 4, v241
  v_xor_b32 v242, 8, v240
  v_lshl_add_u32 v18, v242, 4, v241
  v_lshlrev_b32 v241, 8, v244
  v_xor_b32 v242, 0, v243
  v_lshl_add_u32 v1, v242, 4, v241
  v_xor_b32 v242, 4, v243
  v_lshl_add_u32 v2, v242, 4, v241
  v_xor_b32 v242, 8, v243
  v_lshl_add_u32 v3, v242, 4, v241
  v_xor_b32 v242, 12, v243
  v_lshl_add_u32 v4, v242, 4, v241
  v_lshrrev_b32 v240, 2, v0
  v_and_b32 v242, 7, v240
  v_lshlrev_b32 v240, 8, v240
  v_and_b32 v241, 3, v0
  v_lshl_add_u32 v240, v241, 3, v240
  v_add_u32 v240, 65536, v240
  v_xor_b32 v241, 0, v242
  v_lshl_add_u32 v5, v241, 5, v240
  v_xor_b32 v241, 1, v242
  v_lshl_add_u32 v6, v241, 5, v240
  v_xor_b32 v241, 2, v242
  v_lshl_add_u32 v7, v241, 5, v240
  v_xor_b32 v241, 3, v242
  v_lshl_add_u32 v8, v241, 5, v240
  v_xor_b32 v241, 4, v242
  v_lshl_add_u32 v9, v241, 5, v240
  v_xor_b32 v241, 5, v242
  v_lshl_add_u32 v10, v241, 5, v240
  v_xor_b32 v241, 6, v242
  v_lshl_add_u32 v11, v241, 5, v240
  v_xor_b32 v241, 7, v242
  v_lshl_add_u32 v12, v241, 5, v240
  v_lshlrev_b32 v20, 4, v0
  v_add_u32 v20, s48, v20
  s_mov_b32 s69, s25
  s_add_u32 s70, s25, 32768
  v_lshrrev_b32 v240, 1, v245
  v_xor_b32 v240, v240, v244
  v_lshlrev_b32 v240, 4, v240
  v_lshl_add_u32 v240, v244, 8, v240
  v_and_b32 v241, 1, v245
  v_lshl_add_u32 v240, v241, 3, v240
  v_add_u32 v240, s65, v240
  v_accvgpr_write_b32 a254, v240
  v_lshlrev_b32 v240, 4, v243
  v_lshl_add_u32 v240, v245, 8, v240
  v_add_u32 v240, s65, v240
  v_accvgpr_write_b32 a255, v240
  v_mov_b32 v240, 0x3f803f80
  v_accvgpr_write_b32 a216, v240
  v_accvgpr_write_b32 a217, v240
  v_accvgpr_write_b32 a218, v240
  v_accvgpr_write_b32 a219, v240
  s_mov_b32 s44, 0x3e0293ee
  s_mov_b32 s45, 0x3e0293ee
  s_mov_b32 s46, 0xffff0000
  s_mov_b32 s35, 0x4f800000
  s_add_u32 s27, s2, 256
  s_mov_b32 s31, 0
  s_mov_b32 s32, 0
  s_mov_b32 s34, 1
  s_mov_b32 s68, 0
  v_mov_b32 v59, 0xff800000
  v_mov_b32 v63, 0xff800000
  v_mov_b32 v67, 0xff800000
  v_mov_b32 v71, 0xff800000
  v_mov_b32 v75, 0xff800000
  v_mov_b32 v79, 0xff800000
L_stream:
  s_mul_i32 s29, s27, 262144
  s_cmp_lt_u32 s27, 512
  s_cselect_b32 s29, s29, 268435456
  s_cselect_b32 s63, 3, 99
  s_cselect_b32 s74, 99, 3
  s_add_u32 s71, s63, 1
  s_mov_b32 s47, 1
  s_mov_b32 s51, 268435456
  s_mov_b32 s66, s34
  s_mov_b32 s34, 0
L_ramp:
  s_mov_b32 s30, 0
  s_mov_b32 s47, 0
  s_mov_b32 s34, s66
  s_waitcnt vmcnt(8)
  s_add_u32 s48, s65, 0
  v_add_u32 v240, s48, v1
  v_add_u32 v241, s48, v2
  v_add_u32 v242, s48, v3
  v_add_u32 v243, s48, v4
  ds_read_b128 v[80:83], v240 offset:0
  ds_read_b128 v[84:87], v241 offset:0
  ds_read_b128 v[88:91], v242 offset:0
  ds_read_b128 v[92:95], v243 offset:0
  s_add_u32 s33, s62, 8192
  s_add_u32 m0, s25, 114688
  s_nop 0
  buffer_load_dwordx4 v13, s[8:11], s33 offen offset:0 nt lds
  buffer_load_dwordx4 v14, s[8:11], s33 offen offset:1024 nt lds
  buffer_load_dwordx4 v15, s[8:11], s33 offen offset:2048 nt lds
  buffer_load_dwordx4 v16, s[8:11], s33 offen offset:3072 nt lds
  s_waitcnt lgkmcnt(0)
  v_lshlrev_b32 v240, 16, v80
  v_and_b32 v241, s46, v80
  v_lshlrev_b32 v242, 16, v81
  v_and_b32 v243, s46, v81
  v_lshlrev_b32 v244, 16, v82
  v_and_b32 v245, s46, v82
  v_lshlrev_b32 v246, 16, v83
  v_and_b32 v247, s46, v83
  v_pk_mul_f32 v[240:241], v[240:241], s[44:45]
  v_pk_mul_f32 v[242:243], v[242:243], s[44:45]
  v_pk_mul_f32 v[244:245], v[244:245], s[44:45]
  v_pk_mul_f32 v[246:247], v[246:247], s[44:45]
  v_cvt_pk_bf16_f32 v80, v240, v241
  v_cvt_pk_bf16_f32 v81, v242, v243
  v_cvt_pk_bf16_f32 v82, v244, v245
  v_cvt_pk_bf16_f32 v83, v246, v247
  v_lshlrev_b32 v240, 16, v84
  v_and_b32 v241, s46, v84
  v_lshlrev_b32 v242, 16, v85
  v_and_b32 v243, s46, v85
  v_lshlrev_b32 v244, 16, v86
  v_and_b32 v245, s46, v86
  v_lshlrev_b32 v246, 16, v87
  v_and_b32 v247, s46, v87
  v_pk_mul_f32 v[240:241], v[240:241], s[44:45]
  v_pk_mul_f32 v[242:243], v[242:243], s[44:45]
  v_pk_mul_f32 v[244:245], v[244:245], s[44:45]
  v_pk_mul_f32 v[246:247], v[246:247], s[44:45]
  v_cvt_pk_bf16_f32 v84, v240, v241
  v_cvt_pk_bf16_f32 v85, v242, v243
  v_cvt_pk_bf16_f32 v86, v244, v245
  v_cvt_pk_bf16_f32 v87, v246, v247
  v_lshlrev_b32 v240, 16, v88
  v_and_b32 v241, s46, v88
  v_lshlrev_b32 v242, 16, v89
  v_and_b32 v243, s46, v89
  v_lshlrev_b32 v244, 16, v90
  v_and_b32 v245, s46, v90
  v_lshlrev_b32 v246, 16, v91
  v_and_b32 v247, s46, v91
  v_pk_mul_f32 v[240:241], v[240:241], s[44:45]
  v_pk_mul_f32 v[242:243], v[242:243], s[44:45]
  v_pk_mul_f32 v[244:245], v[244:245], s[44:45]
  v_pk_mul_f32 v[246:247], v[246:247], s[44:45]
  v_cvt_pk_bf16_f32 v88, v240, v241
  v_cvt_pk_bf16_f32 v89, v242, v243
  v_cvt_pk_bf16_f32 v90, v244, v245
  v_cvt_pk_bf16_f32 v91, v246, v247
  v_lshlrev_b32 v240, 16, v92
  v_and_b32 v241, s46, v92
  v_lshlrev_b32 v242, 16, v93
  v_and_b32 v243, s46, v93
  v_lshlrev_b32 v244, 16, v94
  v_and_b32 v245, s46, v94
  v_lshlrev_b32 v246, 16, v95
  v_and_b32 v247, s46, v95
  v_pk_mul_f32 v[240:241], v[240:241], s[44:45]
  v_pk_mul_f32 v[242:243], v[242:243], s[44:45]
  v_pk_mul_f32 v[244:245], v[244:245], s[44:45]
  v_pk_mul_f32 v[246:247], v[246:247], s[44:45]
  v_cvt_pk_bf16_f32 v92, v240, v241
  v_cvt_pk_bf16_f32 v93, v242, v243
  v_cvt_pk_bf16_f32 v94, v244, v245
  v_cvt_pk_bf16_f32 v95, v246, v247
  s_waitcnt vmcnt(8)
  s_barrier
  ds_read_b128 a[128:131], v1 offset:0
  ds_read_b128 a[132:135], v2 offset:0
  ds_read_b128 a[136:139], v3 offset:0
  ds_read_b128 a[140:143], v4 offset:0
  ds_read_b128 a[144:147], v1 offset:4096
  ds_read_b128 a[148:151], v2 offset:4096
  ds_read_b128 a[152:155], v3 offset:4096
  ds_read_b128 a[156:159], v4 offset:4096
  s_add_u32 m0, s25, 65536
  s_nop 0
  buffer_load_dwordx4 v17, s[16:19], s28 offen offset:0 nt lds
  buffer_load_dwordx4 v18, s[16:19], s28 offen offset:1024 nt lds
  buffer_load_dwordx4 v17, s[16:19], s28 offen offset:2048 nt lds
  buffer_load_dwordx4 v18, s[16:19], s28 offen offset:3072 nt lds
  s_add_u32 s28, s28, 16384
  s_waitcnt vmcnt(8)
  s_add_u32 s48, s65, 4096
  v_add_u32 v240, s48, v1
  v_add_u32 v241, s48, v2
  v_add_u32 v242, s48, v3
  v_add_u32 v243, s48, v4
  ds_read_b128 v[96:99], v240 offset:0
  ds_read_b128 v[100:103], v241 offset:0
  ds_read_b128 v[104:107], v242 offset:0
  ds_read_b128 v[108:111], v243 offset:0
  s_add_u32 m0, s25, 16384
  s_nop 0
  buffer_load_dwordx4 v13, s[12:15], s28 offen offset:0 nt lds
  buffer_load_dwordx4 v14, s[12:15], s28 offen offset:1024 nt lds
  buffer_load_dwordx4 v15, s[12:15], s28 offen offset:2048 nt lds
  buffer_load_dwordx4 v16, s[12:15], s28 offen offset:3072 nt lds
  s_waitcnt lgkmcnt(4)
  v_mfma_f32_16x16x32_bf16 v[32:35], a[128:131], v[80:83], 0
  s_waitcnt lgkmcnt(0)
  v_lshlrev_b32 v240, 16, v96
  v_and_b32 v241, s46, v96
  v_lshlrev_b32 v242, 16, v97
  v_and_b32 v243, s46, v97
  v_lshlrev_b32 v244, 16, v98
  v_and_b32 v245, s46, v98
  v_lshlrev_b32 v246, 16, v99
  v_and_b32 v247, s46, v99
  v_pk_mul_f32 v[240:241], v[240:241], s[44:45]
  v_pk_mul_f32 v[242:243], v[242:243], s[44:45]
  v_pk_mul_f32 v[244:245], v[244:245], s[44:45]
  v_pk_mul_f32 v[246:247], v[246:247], s[44:45]
  v_mfma_f32_16x16x32_bf16 v[32:35], a[132:135], v[84:87], v[32:35]
  v_cvt_pk_bf16_f32 v96, v240, v241
  v_cvt_pk_bf16_f32 v97, v242, v243
  v_cvt_pk_bf16_f32 v98, v244, v245
  v_cvt_pk_bf16_f32 v99, v246, v247
  v_lshlrev_b32 v240, 16, v100
  v_and_b32 v241, s46, v100
  v_lshlrev_b32 v242, 16, v101
  v_and_b32 v243, s46, v101
  v_lshlrev_b32 v244, 16, v102
  v_mfma_f32_16x16x32_bf16 v[32:35], a[136:139], v[88:91], v[32:35]
  v_and_b32 v245, s46, v102
  v_lshlrev_b32 v246, 16, v103
  v_and_b32 v247, s46, v103
  v_pk_mul_f32 v[240:241], v[240:241], s[44:45]
  v_pk_mul_f32 v[242:243], v[242:243], s[44:45]
  v_pk_mul_f32 v[244:245], v[244:245], s[44:45]
  v_pk_mul_f32 v[246:247], v[246:247], s[44:45]
  v_cvt_pk_bf16_f32 v100, v240, v241
  v_cvt_pk_bf16_f32 v101, v242, v243
  v_cvt_pk_bf16_f32 v102, v244, v245
  v_mfma_f32_16x16x32_bf16 v[32:35], a[140:143], v[92:95], v[32:35]
  v_cvt_pk_bf16_f32 v103, v246, v247
  v_lshlrev_b32 v240, 16, v104
  v_and_b32 v241, s46, v104
  v_lshlrev_b32 v242, 16, v105
  v_and_b32 v243, s46, v105
  v_lshlrev_b32 v244, 16, v106
  v_and_b32 v245, s46, v106
  v_lshlrev_b32 v246, 16, v107
  v_and_b32 v247, s46, v107
  v_pk_mul_f32 v[240:241], v[240:241], s[44:45]
  v_pk_mul_f32 v[242:243], v[242:243], s[44:45]
  v_pk_mul_f32 v[244:245], v[244:245], s[44:45]
  v_pk_mul_f32 v[246:247], v[246:247], s[44:45]
  v_mfma_f32_16x16x32_bf16 v[36:39], a[144:147], v[80:83], 0
  v_cvt_pk_bf16_f32 v104, v240, v241
  v_cvt_pk_bf16_f32 v105, v242, v243
  v_cvt_pk_bf16_f32 v106, v244, v245
  v_cvt_pk_bf16_f32 v107, v246, v247
  v_lshlrev_b32 v240, 16, v108
  v_and_b32 v241, s46, v108
  v_lshlrev_b32 v242, 16, v109
  v_and_b32 v243, s46, v109
  v_lshlrev_b32 v244, 16, v110
  v_mfma_f32_16x16x32_bf16 v[36:39], a[148:151], v[84:87], v[36:39]
  v_and_b32 v245, s46, v110
  v_lshlrev_b32 v246, 16, v111
  v_and_b32 v247, s46, v111
  v_pk_mul_f32 v[240:241], v[240:241], s[44:45]
  v_pk_mul_f32 v[242:243], v[242:243], s[44:45]
  v_pk_mul_f32 v[244:245], v[244:245], s[44:45]
  v_pk_mul_f32 v[246:247], v[246:247], s[44:45]
  v_cvt_pk_bf16_f32 v108, v240, v241
  v_cvt_pk_bf16_f32 v109, v242, v243
  v_cvt_pk_bf16_f32 v110, v244, v245
  v_mfma_f32_16x16x32_bf16 v[36:39], a[152:155], v[88:91], v[36:39]
  v_cvt_pk_bf16_f32 v111, v246, v247
  s_waitcnt vmcnt(8)
  s_add_u32 s48, s25, 114688
  v_add_u32 v240, s48, v1
  v_add_u32 v241, s48, v2
  v_add_u32 v242, s48, v3
  v_add_u32 v243, s48, v4
  ds_read_b128 v[112:115], v240 offset:0
  ds_read_b128 v[116:119], v241 offset:0
  ds_read_b128 v[120:123], v242 offset:0
  ds_read_b128 v[124:127], v243 offset:0
  v_mfma_f32_16x16x32_bf16 v[36:39], a[156:159], v[92:95], v[36:39]
  s_add_u32 m0, s25, 81920
  s_nop 0
  buffer_load_dwordx4 v17, s[16:19], s28 offen offset:0 nt lds
  buffer_load_dwordx4 v18, s[16:19], s28 offen offset:1024 nt lds
  buffer_load_dwordx4 v17, s[16:19], s28 offen offset:2048 nt lds
  buffer_load_dwordx4 v18, s[16:19], s28 offen offset:3072 nt lds
  s_add_u32 s28, s28, 16384
  v_mfma_f32_16x16x32_bf16 v[40:43], a[128:131], v[96:99], 0
  v_max3_f32 v59, v32, v33, v59
  v_max3_f32 v59, v34, v35, v59
  v_max3_f32 v59, v36, v37, v59
  v_max3_f32 v59, v38, v39, v59
  v_mov_b32 v22, v59
  s_nop 1
  v_permlane32_swap_b32 v22, v59
  v_max_f32 v59, v22, v59
  v_mov_b32 v22, v59
  s_nop 1
  v_permlane16_swap_b32 v22, v59
  v_max_f32 v22, v22, v59
  v_sub_f32 v32, v32, v22
  v_sub_f32 v33, v33, v22
  v_sub_f32 v34, v34, v22
  v_sub_f32 v35, v35, v22
  v_sub_f32 v36, v36, v22
  v_sub_f32 v37, v37, v22
  v_sub_f32 v38, v38, v22
  v_mfma_f32_16x16x32_bf16 v[40:43], a[132:135], v[100:103], v[40:43]
  v_sub_f32 v39, v39, v22
  v_sub_f32 v56, 0, v22
  v_sub_f32 v57, 0, v22
  v_sub_f32 v58, 0, v22
  v_sub_f32 v59, 0, v22
  v_exp_f32 v32, v32
  v_exp_f32 v33, v33
  v_exp_f32 v34, v34
  v_cvt_pk_bf16_f32 v48, v32, v33
  v_exp_f32 v35, v35
  v_exp_f32 v36, v36
  v_cvt_pk_bf16_f32 v49, v34, v35
  v_mfma_f32_16x16x32_bf16 v[40:43], a[136:139], v[104:107], v[40:43]
  v_exp_f32 v37, v37
  v_exp_f32 v38, v38
  v_cvt_pk_bf16_f32 v50, v36, v37
  v_exp_f32 v39, v39
  s_nop 0
  v_cvt_pk_bf16_f32 v51, v38, v39
  s_waitcnt lgkmcnt(0)
  v_lshlrev_b32 v240, 16, v112
  v_and_b32 v241, s46, v112
  v_lshlrev_b32 v242, 16, v113
  v_and_b32 v243, s46, v113
  v_lshlrev_b32 v244, 16, v114
  v_and_b32 v245, s46, v114
  v_lshlrev_b32 v246, 16, v115
  v_and_b32 v247, s46, v115
  v_pk_mul_f32 v[240:241], v[240:241], s[44:45]
  v_pk_mul_f32 v[242:243], v[242:243], s[44:45]
  v_pk_mul_f32 v[244:245], v[244:245], s[44:45]
  v_pk_mul_f32 v[246:247], v[246:247], s[44:45]
  v_mfma_f32_16x16x32_bf16 v[40:43], a[140:143], v[108:111], v[40:43]
  v_cvt_pk_bf16_f32 v112, v240, v241
  v_cvt_pk_bf16_f32 v113, v242, v243
  v_cvt_pk_bf16_f32 v114, v244, v245
  v_cvt_pk_bf16_f32 v115, v246, v247
  v_lshlrev_b32 v240, 16, v116
  v_and_b32 v241, s46, v116
  v_lshlrev_b32 v242, 16, v117
  v_and_b32 v243, s46, v117
  v_lshlrev_b32 v244, 16, v118
  v_and_b32 v245, s46, v118
  v_lshlrev_b32 v246, 16, v119
  v_and_b32 v247, s46, v119
  v_pk_mul_f32 v[240:241], v[240:241], s[44:45]
  v_pk_mul_f32 v[242:243], v[242:243], s[44:45]
  v_pk_mul_f32 v[244:245], v[244:245], s[44:45]
  v_pk_mul_f32 v[246:247], v[246:247], s[44:45]
  v_mfma_f32_16x16x32_bf16 v[44:47], a[144:147], v[96:99], 0
  v_cvt_pk_bf16_f32 v116, v240, v241
  v_cvt_pk_bf16_f32 v117, v242, v243
  v_cvt_pk_bf16_f32 v118, v244, v245
  v_cvt_pk_bf16_f32 v119, v246, v247
  v_lshlrev_b32 v240, 16, v120
  v_and_b32 v241, s46, v120
  v_lshlrev_b32 v242, 16, v121
  v_and_b32 v243, s46, v121
  v_lshlrev_b32 v244, 16, v122
  v_and_b32 v245, s46, v122
  v_lshlrev_b32 v246, 16, v123
  v_and_b32 v247, s46, v123
  v_pk_mul_f32 v[240:241], v[240:241], s[44:45]
  v_pk_mul_f32 v[242:243], v[242:243], s[44:45]
  v_pk_mul_f32 v[244:245], v[244:245], s[44:45]
  v_pk_mul_f32 v[246:247], v[246:247], s[44:45]
  v_mfma_f32_16x16x32_bf16 v[44:47], a[148:151], v[100:103], v[44:47]
  v_cvt_pk_bf16_f32 v120, v240, v241
  v_cvt_pk_bf16_f32 v121, v242, v243
  v_cvt_pk_bf16_f32 v122, v244, v245
  v_cvt_pk_bf16_f32 v123, v246, v247
  v_lshlrev_b32 v240, 16, v124
  v_and_b32 v241, s46, v124
  v_lshlrev_b32 v242, 16, v125
  v_and_b32 v243, s46, v125
  v_lshlrev_b32 v244, 16, v126
  v_and_b32 v245, s46, v126
  v_lshlrev_b32 v246, 16, v127
  v_and_b32 v247, s46, v127
  v_pk_mul_f32 v[240:241], v[240:241], s[44:45]
  v_pk_mul_f32 v[242:243], v[242:243], s[44:45]
  v_pk_mul_f32 v[244:245], v[244:245], s[44:45]
  v_pk_mul_f32 v[246:247], v[246:247], s[44:45]
  v_mfma_f32_16x16x32_bf16 v[44:47], a[152:155], v[104:107], v[44:47]
  v_cvt_pk_bf16_f32 v124, v240, v241
  v_cvt_pk_bf16_f32 v125, v242, v243
  v_cvt_pk_bf16_f32 v126, v244, v245
  v_cvt_pk_bf16_f32 v127, v246, v247
  s_waitcnt vmcnt(8)
  s_barrier
  ds_read_b64_tr_b16 a[160:161], v5 offset:0
  ds_read_b64_tr_b16 a[162:163], v5 offset:4096
  ds_read_b64_tr_b16 a[164:165], v6 offset:0
  ds_read_b64_tr_b16 a[166:167], v6 offset:4096
  ds_read_b64_tr_b16 a[168:169], v7 offset:0
  ds_read_b64_tr_b16 a[170:171], v7 offset:4096
  ds_read_b64_tr_b16 a[172:173], v8 offset:0
  ds_read_b64_tr_b16 a[174:175], v8 offset:4096
  ds_read_b64_tr_b16 a[176:177], v9 offset:0
  ds_read_b64_tr_b16 a[178:179], v9 offset:4096
  v_mfma_f32_16x16x32_bf16 v[44:47], a[156:159], v[108:111], v[44:47]
  ds_read_b64_tr_b16 a[180:181], v10 offset:0
  ds_read_b64_tr_b16 a[182:183], v10 offset:4096
  ds_read_b64_tr_b16 a[184:185], v11 offset:0
  ds_read_b64_tr_b16 a[186:187], v11 offset:4096
  ds_read_b64_tr_b16 a[188:189], v12 offset:0
  ds_read_b64_tr_b16 a[190:191], v12 offset:4096
  s_add_u32 s33, s62, 12288
  s_add_u32 m0, s65, 0
  s_nop 0
  buffer_load_dwordx4 v13, s[8:11], s33 offen offset:0 nt lds
  buffer_load_dwordx4 v14, s[8:11], s33 offen offset:1024 nt lds
  buffer_load_dwordx4 v15, s[8:11], s33 offen offset:2048 nt lds
  buffer_load_dwordx4 v16, s[8:11], s33 offen offset:3072 nt lds
  v_mfma_f32_16x16x32_bf16 v[32:35], a[128:131], v[112:115], 0
  ds_read_b128 a[128:131], v1 offset:8192
  v_max3_f32 v63, v40, v41, v63
  v_max3_f32 v63, v42, v43, v63
  v_max3_f32 v63, v44, v45, v63
  v_mfma_f32_16x16x32_bf16 v[32:35], a[132:135], v[116:119], v[32:35]
  ds_read_b128 a[132:135], v2 offset:8192
  v_max3_f32 v63, v46, v47, v63
  v_mov_b32 v23, v63
  v_mfma_f32_16x16x32_bf16 v[32:35], a[136:139], v[120:123], v[32:35]
  ds_read_b128 a[136:139], v3 offset:8192
  v_permlane32_swap_b32 v23, v63
  v_max_f32 v63, v23, v63
  v_mov_b32 v23, v63
  v_mfma_f32_16x16x32_bf16 v[32:35], a[140:143], v[124:127], v[32:35]
  ds_read_b128 a[140:143], v4 offset:8192
  v_permlane16_swap_b32 v23, v63
  v_max_f32 v23, v23, v63
  v_mfma_f32_16x16x32_bf16 v[36:39], a[144:147], v[112:115], 0
  ds_read_b128 a[144:147], v1 offset:12288
  v_sub_f32 v40, v40, v23
  v_sub_f32 v41, v41, v23
  v_sub_f32 v42, v42, v23
  v_mfma_f32_16x16x32_bf16 v[36:39], a[148:151], v[116:119], v[36:39]
  ds_read_b128 a[148:151], v2 offset:12288
  v_sub_f32 v43, v43, v23
  v_sub_f32 v44, v44, v23
  v_mfma_f32_16x16x32_bf16 v[36:39], a[152:155], v[120:123], v[36:39]
  ds_read_b128 a[152:155], v3 offset:12288
  v_sub_f32 v45, v45, v23
  v_sub_f32 v46, v46, v23
  v_sub_f32 v47, v47, v23
  v_mfma_f32_16x16x32_bf16 v[36:39], a[156:159], v[124:127], v[36:39]
  ds_read_b128 a[156:159], v4 offset:12288
  v_sub_f32 v60, 0, v23
  v_sub_f32 v61, 0, v23
  s_waitcnt lgkmcnt(8)
  v_mfma_f32_16x16x32_bf16 a[0:3], a[160:163], v[48:51], 0
  v_sub_f32 v62, 0, v23
  v_sub_f32 v63, 0, v23
  v_exp_f32 v40, v40
  v_mfma_f32_16x16x32_bf16 a[4:7], a[164:167], v[48:51], 0
  v_exp_f32 v41, v41
  v_mfma_f32_16x16x32_bf16 a[8:11], a[168:171], v[48:51], 0
  v_exp_f32 v42, v42
  v_mfma_f32_16x16x32_bf16 a[12:15], a[172:175], v[48:51], 0
  v_cvt_pk_bf16_f32 v52, v40, v41
  v_exp_f32 v43, v43
  v_mfma_f32_16x16x32_bf16 a[16:19], a[176:179], v[48:51], 0
  v_exp_f32 v44, v44
  v_mfma_f32_16x16x32_bf16 a[20:23], a[180:183], v[48:51], 0
  v_cvt_pk_bf16_f32 v53, v42, v43
  v_exp_f32 v45, v45
  v_mfma_f32_16x16x32_bf16 a[24:27], a[184:187], v[48:51], 0
  v_exp_f32 v46, v46
  v_mfma_f32_16x16x32_bf16 a[28:31], a[188:191], v[48:51], 0
  v_cvt_pk_bf16_f32 v54, v44, v45
  v_exp_f32 v47, v47
  v_mfma_f32_16x16x32_bf16 a[192:195], a[216:219], v[48:51], 0
  v_cvt_pk_bf16_f32 v55, v46, v47
  s_waitcnt lgkmcnt(0)
  v_mfma_f32_16x16x32_bf16 v[40:43], a[128:131], v[80:83], v[56:59]
  v_max3_f32 v67, v32, v33, v67
  v_max3_f32 v67, v34, v35, v67
  v_max3_f32 v67, v36, v37, v67
  v_max3_f32 v67, v38, v39, v67
  v_mfma_f32_16x16x32_bf16 v[40:43], a[132:135], v[84:87], v[40:43]
  v_mov_b32 v22, v67
  s_nop 1
  v_permlane32_swap_b32 v22, v67
  v_max_f32 v67, v22, v67
  v_mfma_f32_16x16x32_bf16 v[40:43], a[136:139], v[88:91], v[40:43]
  v_mov_b32 v22, v67
  s_nop 1
  v_permlane16_swap_b32 v22, v67
  v_max_f32 v22, v22, v67
  v_mfma_f32_16x16x32_bf16 v[40:43], a[140:143], v[92:95], v[40:43]
  v_sub_f32 v32, v32, v22
  v_sub_f32 v33, v33, v22
  v_sub_f32 v34, v34, v22
  v_mfma_f32_16x16x32_bf16 v[44:47], a[144:147], v[80:83], v[56:59]
  v_sub_f32 v35, v35, v22
  v_sub_f32 v36, v36, v22
  v_sub_f32 v37, v37, v22
  v_mfma_f32_16x16x32_bf16 v[44:47], a[148:151], v[84:87], v[44:47]
  v_sub_f32 v38, v38, v22
  v_sub_f32 v39, v39, v22
  v_sub_f32 v64, 0, v22
  v_mfma_f32_16x16x32_bf16 v[44:47], a[152:155], v[88:91], v[44:47]
  v_sub_f32 v65, 0, v22
  v_sub_f32 v66, 0, v22
  v_sub_f32 v67, 0, v22
  v_mfma_f32_16x16x32_bf16 v[44:47], a[156:159], v[92:95], v[44:47]
  v_exp_f32 v32, v32
  v_exp_f32 v33, v33
  v_mfma_f32_16x16x32_bf16 a[32:35], a[160:163], v[52:55], 0
  v_exp_f32 v34, v34
  v_cvt_pk_bf16_f32 v48, v32, v33
  v_mfma_f32_16x16x32_bf16 a[36:39], a[164:167], v[52:55], 0
  v_exp_f32 v35, v35
  v_exp_f32 v36, v36
  v_mfma_f32_16x16x32_bf16 a[40:43], a[168:171], v[52:55], 0
  v_cvt_pk_bf16_f32 v49, v34, v35
  v_exp_f32 v37, v37
  v_mfma_f32_16x16x32_bf16 a[44:47], a[172:175], v[52:55], 0
  v_exp_f32 v38, v38
  v_mfma_f32_16x16x32_bf16 a[48:51], a[176:179], v[52:55], 0
  v_cvt_pk_bf16_f32 v50, v36, v37
  v_exp_f32 v39, v39
  v_mfma_f32_16x16x32_bf16 a[52:55], a[180:183], v[52:55], 0
  v_cvt_pk_bf16_f32 v51, v38, v39
  s_waitcnt vmcnt(8)
  s_add_u32 s33, s62, 16384
  v_mfma_f32_16x16x32_bf16 a[56:59], a[184:187], v[52:55], 0
  s_add_u32 m0, s65, 4096
  s_nop 0
  buffer_load_dwordx4 v13, s[8:11], s33 offen offset:0 nt lds
  v_mfma_f32_16x16x32_bf16 a[60:63], a[188:191], v[52:55], 0
  buffer_load_dwordx4 v14, s[8:11], s33 offen offset:1024 nt lds
  buffer_load_dwordx4 v15, s[8:11], s33 offen offset:2048 nt lds
  v_mfma_f32_16x16x32_bf16 a[196:199], a[216:219], v[52:55], 0
  buffer_load_dwordx4 v16, s[8:11], s33 offen offset:3072 nt lds
  v_mfma_f32_16x16x32_bf16 v[32:35], a[128:131], v[96:99], v[60:63]
  v_exp_f32 v40, v40
  v_mfma_f32_16x16x32_bf16 v[32:35], a[132:135], v[100:103], v[32:35]
  v_exp_f32 v41, v41
  v_mfma_f32_16x16x32_bf16 v[32:35], a[136:139], v[104:107], v[32:35]
  v_exp_f32 v42, v42
  v_mfma_f32_16x16x32_bf16 v[32:35], a[140:143], v[108:111], v[32:35]
  v_exp_f32 v43, v43
  v_mfma_f32_16x16x32_bf16 v[36:39], a[144:147], v[96:99], v[60:63]
  v_cvt_pk_bf16_f32 v52, v40, v41
  v_cvt_pk_bf16_f32 v53, v42, v43
  v_mfma_f32_16x16x32_bf16 v[36:39], a[148:151], v[100:103], v[36:39]
  v_exp_f32 v44, v44
  v_mfma_f32_16x16x32_bf16 v[36:39], a[152:155], v[104:107], v[36:39]
  v_exp_f32 v45, v45
  v_mfma_f32_16x16x32_bf16 v[36:39], a[156:159], v[108:111], v[36:39]
  v_exp_f32 v46, v46
  v_mfma_f32_16x16x32_bf16 a[64:67], a[160:163], v[48:51], 0
  ds_read_b64_tr_b16 a[160:161], v5 offset:8192
  ds_read_b64_tr_b16 a[162:163], v5 offset:12288
  v_mfma_f32_16x16x32_bf16 a[68:71], a[164:167], v[48:51], 0
  ds_read_b64_tr_b16 a[164:165], v6 offset:8192
  ds_read_b64_tr_b16 a[166:167], v6 offset:12288
  v_mfma_f32_16x16x32_bf16 a[72:75], a[168:171], v[48:51], 0
  ds_read_b64_tr_b16 a[168:169], v7 offset:8192
  ds_read_b64_tr_b16 a[170:171], v7 offset:12288
  v_mfma_f32_16x16x32_bf16 a[76:79], a[172:175], v[48:51], 0
  ds_read_b64_tr_b16 a[172:173], v8 offset:8192
  ds_read_b64_tr_b16 a[174:175], v8 offset:12288
  v_mfma_f32_16x16x32_bf16 a[80:83], a[176:179], v[48:51], 0
  ds_read_b64_tr_b16 a[176:177], v9 offset:8192
  ds_read_b64_tr_b16 a[178:179], v9 offset:12288
  v_mfma_f32_16x16x32_bf16 a[84:87], a[180:183], v[48:51], 0
  ds_read_b64_tr_b16 a[180:181], v10 offset:8192
  ds_read_b64_tr_b16 a[182:183], v10 offset:12288
  v_mfma_f32_16x16x32_bf16 a[88:91], a[184:187], v[48:51], 0
  ds_read_b64_tr_b16 a[184:185], v11 offset:8192
  ds_read_b64_tr_b16 a[186:187], v11 offset:12288
  v_mfma_f32_16x16x32_bf16 a[92:95], a[188:191], v[48:51], 0
  ds_read_b64_tr_b16 a[188:189], v12 offset:8192
  ds_read_b64_tr_b16 a[190:191], v12 offset:12288
  v_mfma_f32_16x16x32_bf16 a[200:203], a[216:219], v[48:51], 0
  v_exp_f32 v47, v47
  v_cvt_pk_bf16_f32 v54, v44, v45
  v_cvt_pk_bf16_f32 v55, v46, v47
  s_waitcnt vmcnt(8)
  s_barrier
  v_mfma_f32_16x16x32_bf16 v[40:43], a[128:131], v[112:115], v[64:67]
  v_exp_f32 v32, v32
  v_mfma_f32_16x16x32_bf16 v[40:43], a[132:135], v[116:119], v[40:43]
  ds_read_b128 a[128:131], v1 offset:16384
  ds_read_b128 a[132:135], v2 offset:16384
  v_mfma_f32_16x16x32_bf16 v[40:43], a[136:139], v[120:123], v[40:43]
  s_add_u32 s33, s62, 20480
  s_add_u32 m0, s25, 49152
  s_nop 0
  buffer_load_dwordx4 v13, s[8:11], s33 offen offset:0 nt lds
  v_mfma_f32_16x16x32_bf16 v[40:43], a[140:143], v[124:127], v[40:43]
  ds_read_b128 a[136:139], v3 offset:16384
  ds_read_b128 a[140:143], v4 offset:16384
  v_mfma_f32_16x16x32_bf16 v[44:47], a[144:147], v[112:115], v[64:67]
  buffer_load_dwordx4 v14, s[8:11], s33 offen offset:1024 nt lds
  v_mfma_f32_16x16x32_bf16 v[44:47], a[148:151], v[116:119], v[44:47]
  ds_read_b128 a[144:147], v1 offset:20480
  ds_read_b128 a[148:151], v2 offset:20480
  v_mfma_f32_16x16x32_bf16 v[44:47], a[152:155], v[120:123], v[44:47]
  s_waitcnt lgkmcnt(6)
  v_mfma_f32_16x16x32_bf16 v[44:47], a[156:159], v[124:127], v[44:47]
  buffer_load_dwordx4 v15, s[8:11], s33 offen offset:2048 nt lds
  v_mfma_f32_16x16x32_bf16 a[0:3], a[160:163], v[52:55], a[0:3]
  ds_read_b128 a[152:155], v3 offset:20480
  ds_read_b128 a[156:159], v4 offset:20480
  v_mfma_f32_16x16x32_bf16 a[4:7], a[164:167], v[52:55], a[4:7]
  buffer_load_dwordx4 v16, s[8:11], s33 offen offset:3072 nt lds
  v_mfma_f32_16x16x32_bf16 a[8:11], a[168:171], v[52:55], a[8:11]
  v_exp_f32 v33, v33
  v_mfma_f32_16x16x32_bf16 a[12:15], a[172:175], v[52:55], a[12:15]
  v_exp_f32 v34, v34
  v_mfma_f32_16x16x32_bf16 a[16:19], a[176:179], v[52:55], a[16:19]
  v_exp_f32 v35, v35
  v_mfma_f32_16x16x32_bf16 a[20:23], a[180:183], v[52:55], a[20:23]
  v_cvt_pk_bf16_f32 v48, v32, v33
  v_cvt_pk_bf16_f32 v49, v34, v35
  v_mfma_f32_16x16x32_bf16 a[24:27], a[184:187], v[52:55], a[24:27]
  v_exp_f32 v36, v36
  v_mfma_f32_16x16x32_bf16 a[28:31], a[188:191], v[52:55], a[28:31]
  v_exp_f32 v37, v37
  v_mfma_f32_16x16x32_bf16 a[192:195], a[216:219], v[52:55], a[192:195]
  v_exp_f32 v38, v38
  v_exp_f32 v39, v39
  v_cvt_pk_bf16_f32 v50, v36, v37
  v_cvt_pk_bf16_f32 v51, v38, v39
  s_waitcnt lgkmcnt(0)
  v_mfma_f32_16x16x32_bf16 v[32:35], a[128:131], v[80:83], v[56:59]
  v_exp_f32 v40, v40
  v_mfma_f32_16x16x32_bf16 v[32:35], a[132:135], v[84:87], v[32:35]
  v_exp_f32 v41, v41
  v_mfma_f32_16x16x32_bf16 v[32:35], a[136:139], v[88:91], v[32:35]
  v_exp_f32 v42, v42
  v_mfma_f32_16x16x32_bf16 v[32:35], a[140:143], v[92:95], v[32:35]
  v_exp_f32 v43, v43
  v_mfma_f32_16x16x32_bf16 v[36:39], a[144:147], v[80:83], v[56:59]
  v_cvt_pk_bf16_f32 v52, v40, v41
  v_cvt_pk_bf16_f32 v53, v42, v43
  v_mfma_f32_16x16x32_bf16 v[36:39], a[148:151], v[84:87], v[36:39]
  v_exp_f32 v44, v44
  v_mfma_f32_16x16x32_bf16 v[36:39], a[152:155], v[88:91], v[36:39]
  v_exp_f32 v45, v45
  v_mfma_f32_16x16x32_bf16 v[36:39], a[156:159], v[92:95], v[36:39]
  v_exp_f32 v46, v46
  v_mfma_f32_16x16x32_bf16 a[32:35], a[160:163], v[48:51], a[32:35]
  v_exp_f32 v47, v47
  v_mfma_f32_16x16x32_bf16 a[36:39], a[164:167], v[48:51], a[36:39]
  v_cvt_pk_bf16_f32 v54, v44, v45
  v_cvt_pk_bf16_f32 v55, v46, v47
  v_mfma_f32_16x16x32_bf16 a[40:43], a[168:171], v[48:51], a[40:43]
  v_exp_f32 v32, v32
  v_mfma_f32_16x16x32_bf16 a[44:47], a[172:175], v[48:51], a[44:47]
  v_exp_f32 v33, v33
  v_mfma_f32_16x16x32_bf16 a[48:51], a[176:179], v[48:51], a[48:51]
  v_mfma_f32_16x16x32_bf16 a[52:55], a[180:183], v[48:51], a[52:55]
  v_mfma_f32_16x16x32_bf16 a[56:59], a[184:187], v[48:51], a[56:59]
  v_mfma_f32_16x16x32_bf16 a[60:63], a[188:191], v[48:51], a[60:63]
  v_mfma_f32_16x16x32_bf16 a[196:199], a[216:219], v[48:51], a[196:199]
  v_mfma_f32_16x16x32_bf16 v[40:43], a[128:131], v[96:99], v[60:63]
  v_exp_f32 v34, v34
  v_mfma_f32_16x16x32_bf16 v[40:43], a[132:135], v[100:103], v[40:43]
  v_exp_f32 v35, v35
  v_mfma_f32_16x16x32_bf16 v[40:43], a[136:139], v[104:107], v[40:43]
  v_cvt_pk_bf16_f32 v48, v32, v33
  v_cvt_pk_bf16_f32 v49, v34, v35
  v_mfma_f32_16x16x32_bf16 v[40:43], a[140:143], v[108:111], v[40:43]
  v_exp_f32 v36, v36
  v_mfma_f32_16x16x32_bf16 v[44:47], a[144:147], v[96:99], v[60:63]
  v_exp_f32 v37, v37
  v_mfma_f32_16x16x32_bf16 v[44:47], a[148:151], v[100:103], v[44:47]
  v_exp_f32 v38, v38
  v_mfma_f32_16x16x32_bf16 v[44:47], a[152:155], v[104:107], v[44:47]
  v_exp_f32 v39, v39
  v_mfma_f32_16x16x32_bf16 v[44:47], a[156:159], v[108:111], v[44:47]
  v_cvt_pk_bf16_f32 v50, v36, v37
  v_cvt_pk_bf16_f32 v51, v38, v39
  v_mfma_f32_16x16x32_bf16 a[64:67], a[160:163], v[52:55], a[64:67]
  ds_read_b64_tr_b16 a[160:161], v5 offset:16384
  ds_read_b64_tr_b16 a[162:163], v5 offset:20480
  v_mfma_f32_16x16x32_bf16 a[68:71], a[164:167], v[52:55], a[68:71]
  ds_read_b64_tr_b16 a[164:165], v6 offset:16384
  ds_read_b64_tr_b16 a[166:167], v6 offset:20480
  v_mfma_f32_16x16x32_bf16 a[72:75], a[168:171], v[52:55], a[72:75]
  ds_read_b64_tr_b16 a[168:169], v7 offset:16384
  ds_read_b64_tr_b16 a[170:171], v7 offset:20480
  v_mfma_f32_16x16x32_bf16 a[76:79], a[172:175], v[52:55], a[76:79]
  ds_read_b64_tr_b16 a[172:173], v8 offset:16384
  ds_read_b64_tr_b16 a[174:175], v8 offset:20480
  v_mfma_f32_16x16x32_bf16 a[80:83], a[176:179], v[52:55], a[80:83]
  ds_read_b64_tr_b16 a[176:177], v9 offset:16384
  ds_read_b64_tr_b16 a[178:179], v9 offset:20480
  v_mfma_f32_16x16x32_bf16 a[84:87], a[180:183], v[52:55], a[84:87]
  ds_read_b64_tr_b16 a[180:181], v10 offset:16384
  ds_read_b64_tr_b16 a[182:183], v10 offset:20480
  v_mfma_f32_16x16x32_bf16 a[88:91], a[184:187], v[52:55], a[88:91]
  ds_read_b64_tr_b16 a[184:185], v11 offset:16384
  ds_read_b64_tr_b16 a[186:187], v11 offset:20480
  v_mfma_f32_16x16x32_bf16 a[92:95], a[188:191], v[52:55], a[92:95]
  ds_read_b64_tr_b16 a[188:189], v12 offset:16384
  ds_read_b64_tr_b16 a[190:191], v12 offset:20480
  v_mfma_f32_16x16x32_bf16 a[200:203], a[216:219], v[52:55], a[200:203]
  v_mfma_f32_16x16x32_bf16 v[32:35], a[128:131], v[112:115], v[64:67]
  v_exp_f32 v40, v40
  v_mfma_f32_16x16x32_bf16 v[32:35], a[132:135], v[116:119], v[32:35]
  ds_read_b128 a[128:131], v1 offset:24576
  ds_read_b128 a[132:135], v2 offset:24576
  v_mfma_f32_16x16x32_bf16 v[32:35], a[136:139], v[120:123], v[32:35]
  s_waitcnt vmcnt(8)
  s_add_u32 m0, s25, 32768
  s_nop 0
  buffer_load_dwordx4 v13, s[12:15], s28 offen offset:0 nt lds
  v_mfma_f32_16x16x32_bf16 v[32:35], a[140:143], v[124:127], v[32:35]
  ds_read_b128 a[136:139], v3 offset:24576
  ds_read_b128 a[140:143], v4 offset:24576
  v_mfma_f32_16x16x32_bf16 v[36:39], a[144:147], v[112:115], v[64:67]
  buffer_load_dwordx4 v14, s[12:15], s28 offen offset:1024 nt lds
  v_mfma_f32_16x16x32_bf16 v[36:39], a[148:151], v[116:119], v[36:39]
  ds_read_b128 a[144:147], v1 offset:28672
  ds_read_b128 a[148:151], v2 offset:28672
  v_mfma_f32_16x16x32_bf16 v[36:39], a[152:155], v[120:123], v[36:39]
  s_waitcnt lgkmcnt(6)
  v_mfma_f32_16x16x32_bf16 v[36:39], a[156:159], v[124:127], v[36:39]
  buffer_load_dwordx4 v15, s[12:15], s28 offen offset:2048 nt lds
  v_mfma_f32_16x16x32_bf16 a[0:3], a[160:163], v[48:51], a[0:3]
  ds_read_b128 a[152:155], v3 offset:28672
  ds_read_b128 a[156:159], v4 offset:28672
  v_mfma_f32_16x16x32_bf16 a[4:7], a[164:167], v[48:51], a[4:7]
  buffer_load_dwordx4 v16, s[12:15], s28 offen offset:3072 nt lds
  v_mfma_f32_16x16x32_bf16 a[8:11], a[168:171], v[48:51], a[8:11]
  v_exp_f32 v41, v41
  v_mfma_f32_16x16x32_bf16 a[12:15], a[172:175], v[48:51], a[12:15]
  v_exp_f32 v42, v42
  v_mfma_f32_16x16x32_bf16 a[16:19], a[176:179], v[48:51], a[16:19]
  v_exp_f32 v43, v43
  v_mfma_f32_16x16x32_bf16 a[20:23], a[180:183], v[48:51], a[20:23]
  v_cvt_pk_bf16_f32 v52, v40, v41
  v_cvt_pk_bf16_f32 v53, v42, v43
  v_mfma_f32_16x16x32_bf16 a[24:27], a[184:187], v[48:51], a[24:27]
  v_exp_f32 v44, v44
  v_mfma_f32_16x16x32_bf16 a[28:31], a[188:191], v[48:51], a[28:31]
  v_exp_f32 v45, v45
  v_mfma_f32_16x16x32_bf16 a[192:195], a[216:219], v[48:51], a[192:195]
  v_exp_f32 v46, v46
  v_exp_f32 v47, v47
  v_cvt_pk_bf16_f32 v54, v44, v45
  v_cvt_pk_bf16_f32 v55, v46, v47
  s_waitcnt lgkmcnt(0)
  v_mfma_f32_16x16x32_bf16 v[40:43], a[128:131], v[80:83], v[56:59]
  v_exp_f32 v32, v32
  v_mfma_f32_16x16x32_bf16 v[40:43], a[132:135], v[84:87], v[40:43]
  v_exp_f32 v33, v33
  v_mfma_f32_16x16x32_bf16 v[40:43], a[136:139], v[88:91], v[40:43]
  v_exp_f32 v34, v34
  v_mfma_f32_16x16x32_bf16 v[40:43], a[140:143], v[92:95], v[40:43]
  v_exp_f32 v35, v35
  v_mfma_f32_16x16x32_bf16 v[44:47], a[144:147], v[80:83], v[56:59]
  v_cvt_pk_bf16_f32 v48, v32, v33
  v_cvt_pk_bf16_f32 v49, v34, v35
  v_mfma_f32_16x16x32_bf16 v[44:47], a[148:151], v[84:87], v[44:47]
  v_exp_f32 v36, v36
  v_mfma_f32_16x16x32_bf16 v[44:47], a[152:155], v[88:91], v[44:47]
  v_exp_f32 v37, v37
  v_mfma_f32_16x16x32_bf16 v[44:47], a[156:159], v[92:95], v[44:47]
  v_exp_f32 v38, v38
  v_mfma_f32_16x16x32_bf16 a[32:35], a[160:163], v[52:55], a[32:35]
  v_exp_f32 v39, v39
  v_mfma_f32_16x16x32_bf16 a[36:39], a[164:167], v[52:55], a[36:39]
  v_cvt_pk_bf16_f32 v50, v36, v37
  v_cvt_pk_bf16_f32 v51, v38, v39
  v_mfma_f32_16x16x32_bf16 a[40:43], a[168:171], v[52:55], a[40:43]
  v_mfma_f32_16x16x32_bf16 a[44:47], a[172:175], v[52:55], a[44:47]
  v_mfma_f32_16x16x32_bf16 a[48:51], a[176:179], v[52:55], a[48:51]
  v_mfma_f32_16x16x32_bf16 a[52:55], a[180:183], v[52:55], a[52:55]
  v_mfma_f32_16x16x32_bf16 a[56:59], a[184:187], v[52:55], a[56:59]
  v_mfma_f32_16x16x32_bf16 a[60:63], a[188:191], v[52:55], a[60:63]
  v_mfma_f32_16x16x32_bf16 a[196:199], a[216:219], v[52:55], a[196:199]
  v_mfma_f32_16x16x32_bf16 v[32:35], a[128:131], v[96:99], v[60:63]
  s_waitcnt vmcnt(12)
  s_add_u32 s48, s65, 0
  v_add_u32 v240, s48, v1
  v_mfma_f32_16x16x32_bf16 v[32:35], a[132:135], v[100:103], v[32:35]
  v_add_u32 v241, s48, v2
  v_add_u32 v242, s48, v3
  v_mfma_f32_16x16x32_bf16 v[32:35], a[136:139], v[104:107], v[32:35]
  v_add_u32 v243, s48, v4
  ds_read_b128 v[128:131], v240 offset:0
  ds_read_b128 v[132:135], v241 offset:0
  v_mfma_f32_16x16x32_bf16 v[32:35], a[140:143], v[108:111], v[32:35]
  ds_read_b128 v[136:139], v242 offset:0
  ds_read_b128 v[140:143], v243 offset:0
  v_mfma_f32_16x16x32_bf16 v[36:39], a[144:147], v[96:99], v[60:63]
  v_exp_f32 v40, v40
  v_mfma_f32_16x16x32_bf16 v[36:39], a[148:151], v[100:103], v[36:39]
  v_exp_f32 v41, v41
  v_exp_f32 v42, v42
  v_mfma_f32_16x16x32_bf16 v[36:39], a[152:155], v[104:107], v[36:39]
  v_cvt_pk_bf16_f32 v52, v40, v41
  v_mfma_f32_16x16x32_bf16 v[36:39], a[156:159], v[108:111], v[36:39]
  v_exp_f32 v43, v43
  v_mfma_f32_16x16x32_bf16 a[64:67], a[160:163], v[48:51], a[64:67]
  ds_read_b64_tr_b16 a[160:161], v5 offset:24576
  ds_read_b64_tr_b16 a[162:163], v5 offset:28672
  v_exp_f32 v44, v44
  v_cvt_pk_bf16_f32 v53, v42, v43
  v_mfma_f32_16x16x32_bf16 a[68:71], a[164:167], v[48:51], a[68:71]
  ds_read_b64_tr_b16 a[164:165], v6 offset:24576
  ds_read_b64_tr_b16 a[166:167], v6 offset:28672
  v_exp_f32 v45, v45
  v_mfma_f32_16x16x32_bf16 a[72:75], a[168:171], v[48:51], a[72:75]
  ds_read_b64_tr_b16 a[168:169], v7 offset:24576
  ds_read_b64_tr_b16 a[170:171], v7 offset:28672
  v_exp_f32 v46, v46
  v_mfma_f32_16x16x32_bf16 a[76:79], a[172:175], v[48:51], a[76:79]
  ds_read_b64_tr_b16 a[172:173], v8 offset:24576
  ds_read_b64_tr_b16 a[174:175], v8 offset:28672
  v_cvt_pk_bf16_f32 v54, v44, v45
  v_exp_f32 v47, v47
  v_mfma_f32_16x16x32_bf16 a[80:83], a[176:179], v[48:51], a[80:83]
  ds_read_b64_tr_b16 a[176:177], v9 offset:24576
  ds_read_b64_tr_b16 a[178:179], v9 offset:28672
  v_cvt_pk_bf16_f32 v55, v46, v47
  s_add_u32 m0, s25, 98304
  v_mfma_f32_16x16x32_bf16 a[84:87], a[180:183], v[48:51], a[84:87]
  ds_read_b64_tr_b16 a[180:181], v10 offset:24576
  ds_read_b64_tr_b16 a[182:183], v10 offset:28672
  buffer_load_dwordx4 v17, s[16:19], s28 offen offset:0 nt lds
  v_mfma_f32_16x16x32_bf16 a[88:91], a[184:187], v[48:51], a[88:91]
  ds_read_b64_tr_b16 a[184:185], v11 offset:24576
  ds_read_b64_tr_b16 a[186:187], v11 offset:28672
  buffer_load_dwordx4 v18, s[16:19], s28 offen offset:1024 nt lds
  buffer_load_dwordx4 v17, s[16:19], s28 offen offset:2048 nt lds
  v_mfma_f32_16x16x32_bf16 a[92:95], a[188:191], v[48:51], a[92:95]
  ds_read_b64_tr_b16 a[188:189], v12 offset:24576
  ds_read_b64_tr_b16 a[190:191], v12 offset:28672
  buffer_load_dwordx4 v18, s[16:19], s28 offen offset:3072 nt lds
  v_mfma_f32_16x16x32_bf16 a[200:203], a[216:219], v[48:51], a[200:203]
  s_add_u32 s28, s28, 16384
  v_mfma_f32_16x16x32_bf16 v[40:43], a[128:131], v[112:115], v[64:67]
  ds_read_b128 a[128:131], v1 offset:0
  s_waitcnt vmcnt(12)
  s_add_u32 s48, s65, 4096
  v_add_u32 v240, s48, v1
  v_add_u32 v241, s48, v2
  v_add_u32 v242, s48, v3
  v_add_u32 v243, s48, v4
  v_mfma_f32_16x16x32_bf16 v[40:43], a[132:135], v[116:119], v[40:43]
  ds_read_b128 a[132:135], v2 offset:0
  ds_read_b128 v[144:147], v240 offset:0
  ds_read_b128 v[148:151], v241 offset:0
  ds_read_b128 v[152:155], v242 offset:0
  ds_read_b128 v[156:159], v243 offset:0
  v_exp_f32 v32, v32
  v_mfma_f32_16x16x32_bf16 v[40:43], a[136:139], v[120:123], v[40:43]
  ds_read_b128 a[136:139], v3 offset:0
  v_exp_f32 v33, v33
  v_exp_f32 v34, v34
  v_cvt_pk_bf16_f32 v48, v32, v33
  v_mfma_f32_16x16x32_bf16 v[40:43], a[140:143], v[124:127], v[40:43]
  ds_read_b128 a[140:143], v4 offset:0
  v_exp_f32 v35, v35
  v_exp_f32 v36, v36
  v_cvt_pk_bf16_f32 v49, v34, v35
  v_exp_f32 v37, v37
  v_mfma_f32_16x16x32_bf16 v[44:47], a[144:147], v[112:115], v[64:67]
  ds_read_b128 a[144:147], v1 offset:4096
  v_exp_f32 v38, v38
  v_cvt_pk_bf16_f32 v50, v36, v37
  v_exp_f32 v39, v39
  v_mfma_f32_16x16x32_bf16 v[44:47], a[148:151], v[116:119], v[44:47]
  ds_read_b128 a[148:151], v2 offset:4096
  v_cvt_pk_bf16_f32 v51, v38, v39
  s_waitcnt lgkmcnt(15)
  v_lshlrev_b32 v240, 16, v128
  v_and_b32 v241, s46, v128
  v_lshlrev_b32 v242, 16, v129
  v_mfma_f32_16x16x32_bf16 v[44:47], a[152:155], v[120:123], v[44:47]
  ds_read_b128 a[152:155], v3 offset:4096
  v_and_b32 v243, s46, v129
  v_lshlrev_b32 v244, 16, v130
  v_and_b32 v245, s46, v130
  v_lshlrev_b32 v246, 16, v131
  v_and_b32 v247, s46, v131
  v_pk_mul_f32 v[240:241], v[240:241], s[44:45]
  v_pk_mul_f32 v[242:243], v[242:243], s[44:45]
  v_pk_mul_f32 v[244:245], v[244:245], s[44:45]
  v_pk_mul_f32 v[246:247], v[246:247], s[44:45]
  v_mfma_f32_16x16x32_bf16 v[44:47], a[156:159], v[124:127], v[44:47]
  ds_read_b128 a[156:159], v4 offset:4096
  v_cvt_pk_bf16_f32 v128, v240, v241
  v_cvt_pk_bf16_f32 v129, v242, v243
  s_waitcnt lgkmcnt(12)
  v_mfma_f32_16x16x32_bf16 a[0:3], a[160:163], v[52:55], a[0:3]
  v_cvt_pk_bf16_f32 v130, v244, v245
  v_cvt_pk_bf16_f32 v131, v246, v247
  v_lshlrev_b32 v240, 16, v132
  v_and_b32 v241, s46, v132
  v_lshlrev_b32 v242, 16, v133
  v_and_b32 v243, s46, v133
  v_mfma_f32_16x16x32_bf16 a[4:7], a[164:167], v[52:55], a[4:7]
  v_lshlrev_b32 v244, 16, v134
  v_and_b32 v245, s46, v134
  v_lshlrev_b32 v246, 16, v135
  v_and_b32 v247, s46, v135
  v_pk_mul_f32 v[240:241], v[240:241], s[44:45]
  v_pk_mul_f32 v[242:243], v[242:243], s[44:45]
  v_pk_mul_f32 v[244:245], v[244:245], s[44:45]
  v_pk_mul_f32 v[246:247], v[246:247], s[44:45]
  v_mfma_f32_16x16x32_bf16 a[8:11], a[168:171], v[52:55], a[8:11]
  v_cvt_pk_bf16_f32 v132, v240, v241
  v_cvt_pk_bf16_f32 v133, v242, v243
  v_cvt_pk_bf16_f32 v134, v244, v245
  v_mfma_f32_16x16x32_bf16 a[12:15], a[172:175], v[52:55], a[12:15]
  v_cvt_pk_bf16_f32 v135, v246, v247
  v_lshlrev_b32 v240, 16, v136
  v_and_b32 v241, s46, v136
  v_lshlrev_b32 v242, 16, v137
  v_and_b32 v243, s46, v137
  v_lshlrev_b32 v244, 16, v138
  v_mfma_f32_16x16x32_bf16 a[16:19], a[176:179], v[52:55], a[16:19]
  v_and_b32 v245, s46, v138
  v_lshlrev_b32 v246, 16, v139
  v_and_b32 v247, s46, v139
  v_pk_mul_f32 v[240:241], v[240:241], s[44:45]
  v_pk_mul_f32 v[242:243], v[242:243], s[44:45]
  v_pk_mul_f32 v[244:245], v[244:245], s[44:45]
  v_pk_mul_f32 v[246:247], v[246:247], s[44:45]
  v_mfma_f32_16x16x32_bf16 a[20:23], a[180:183], v[52:55], a[20:23]
  v_cvt_pk_bf16_f32 v136, v240, v241
  v_cvt_pk_bf16_f32 v137, v242, v243
  v_cvt_pk_bf16_f32 v138, v244, v245
  v_cvt_pk_bf16_f32 v139, v246, v247
  v_mfma_f32_16x16x32_bf16 a[24:27], a[184:187], v[52:55], a[24:27]
  v_lshlrev_b32 v240, 16, v140
  v_and_b32 v241, s46, v140
  v_lshlrev_b32 v242, 16, v141
  v_and_b32 v243, s46, v141
  v_lshlrev_b32 v244, 16, v142
  v_mfma_f32_16x16x32_bf16 a[28:31], a[188:191], v[52:55], a[28:31]
  v_and_b32 v245, s46, v142
  v_lshlrev_b32 v246, 16, v143
  v_and_b32 v247, s46, v143
  v_pk_mul_f32 v[240:241], v[240:241], s[44:45]
  v_pk_mul_f32 v[242:243], v[242:243], s[44:45]
  v_pk_mul_f32 v[244:245], v[244:245], s[44:45]
  v_pk_mul_f32 v[246:247], v[246:247], s[44:45]
  v_mfma_f32_16x16x32_bf16 a[192:195], a[216:219], v[52:55], a[192:195]
  v_cvt_pk_bf16_f32 v140, v240, v241
  v_cvt_pk_bf16_f32 v141, v242, v243
  v_cvt_pk_bf16_f32 v142, v244, v245
  v_cvt_pk_bf16_f32 v143, v246, v247
  s_waitcnt lgkmcnt(0)
  v_mfma_f32_16x16x32_bf16 v[32:35], a[128:131], v[128:131], 0
  s_waitcnt vmcnt(8)
  s_add_u32 s48, s25, 49152
  v_add_u32 v240, s48, v1
  v_add_u32 v241, s48, v2
  v_add_u32 v242, s48, v3
  v_add_u32 v243, s48, v4
  v_mfma_f32_16x16x32_bf16 v[32:35], a[132:135], v[132:135], v[32:35]
  ds_read_b128 v[160:163], v240 offset:0
  ds_read_b128 v[164:167], v241 offset:0
  ds_read_b128 v[168:171], v242 offset:0
  ds_read_b128 v[172:175], v243 offset:0
  v_exp_f32 v40, v40
  v_mfma_f32_16x16x32_bf16 v[32:35], a[136:139], v[136:139], v[32:35]
  v_exp_f32 v41, v41
  v_exp_f32 v42, v42
  v_cvt_pk_bf16_f32 v52, v40, v41
  v_mfma_f32_16x16x32_bf16 v[32:35], a[140:143], v[140:143], v[32:35]
  v_exp_f32 v43, v43
  v_exp_f32 v44, v44
  v_cvt_pk_bf16_f32 v53, v42, v43
  v_exp_f32 v45, v45
  v_mfma_f32_16x16x32_bf16 v[36:39], a[144:147], v[128:131], 0
  v_exp_f32 v46, v46
  v_cvt_pk_bf16_f32 v54, v44, v45
  v_exp_f32 v47, v47
  v_mfma_f32_16x16x32_bf16 v[36:39], a[148:151], v[132:135], v[36:39]
  v_cvt_pk_bf16_f32 v55, v46, v47
  s_waitcnt lgkmcnt(10)
  v_lshlrev_b32 v240, 16, v144
  v_and_b32 v241, s46, v144
  v_lshlrev_b32 v242, 16, v145
  v_mfma_f32_16x16x32_bf16 v[36:39], a[152:155], v[136:139], v[36:39]
  v_and_b32 v243, s46, v145
  v_lshlrev_b32 v244, 16, v146
  v_and_b32 v245, s46, v146
  v_lshlrev_b32 v246, 16, v147
  v_and_b32 v247, s46, v147
  v_pk_mul_f32 v[240:241], v[240:241], s[44:45]
  v_pk_mul_f32 v[242:243], v[242:243], s[44:45]
  v_pk_mul_f32 v[244:245], v[244:245], s[44:45]
  v_pk_mul_f32 v[246:247], v[246:247], s[44:45]
  v_mfma_f32_16x16x32_bf16 v[36:39], a[156:159], v[140:143], v[36:39]
  v_cvt_pk_bf16_f32 v144, v240, v241
  v_cvt_pk_bf16_f32 v145, v242, v243
  v_mfma_f32_16x16x32_bf16 a[32:35], a[160:163], v[48:51], a[32:35]
  v_cvt_pk_bf16_f32 v146, v244, v245
  v_cvt_pk_bf16_f32 v147, v246, v247
  v_lshlrev_b32 v240, 16, v148
  v_and_b32 v241, s46, v148
  v_lshlrev_b32 v242, 16, v149
  v_and_b32 v243, s46, v149
  v_mfma_f32_16x16x32_bf16 a[36:39], a[164:167], v[48:51], a[36:39]
  v_lshlrev_b32 v244, 16, v150
  v_and_b32 v245, s46, v150
  v_lshlrev_b32 v246, 16, v151
  v_and_b32 v247, s46, v151
  v_pk_mul_f32 v[240:241], v[240:241], s[44:45]
  v_pk_mul_f32 v[242:243], v[242:243], s[44:45]
  v_pk_mul_f32 v[244:245], v[244:245], s[44:45]
  v_pk_mul_f32 v[246:247], v[246:247], s[44:45]
  v_mfma_f32_16x16x32_bf16 a[40:43], a[168:171], v[48:51], a[40:43]
  v_cvt_pk_bf16_f32 v148, v240, v241
  v_cvt_pk_bf16_f32 v149, v242, v243
  v_cvt_pk_bf16_f32 v150, v244, v245
  v_mfma_f32_16x16x32_bf16 a[44:47], a[172:175], v[48:51], a[44:47]
  v_cvt_pk_bf16_f32 v151, v246, v247
  v_lshlrev_b32 v240, 16, v152
  v_and_b32 v241, s46, v152
  v_lshlrev_b32 v242, 16, v153
  v_and_b32 v243, s46, v153
  v_lshlrev_b32 v244, 16, v154
  v_mfma_f32_16x16x32_bf16 a[48:51], a[176:179], v[48:51], a[48:51]
  v_and_b32 v245, s46, v154
  v_lshlrev_b32 v246, 16, v155
  v_and_b32 v247, s46, v155
  v_pk_mul_f32 v[240:241], v[240:241], s[44:45]
  v_pk_mul_f32 v[242:243], v[242:243], s[44:45]
  v_pk_mul_f32 v[244:245], v[244:245], s[44:45]
  v_pk_mul_f32 v[246:247], v[246:247], s[44:45]
  v_mfma_f32_16x16x32_bf16 a[52:55], a[180:183], v[48:51], a[52:55]
  v_cvt_pk_bf16_f32 v152, v240, v241
  v_cvt_pk_bf16_f32 v153, v242, v243
  v_cvt_pk_bf16_f32 v154, v244, v245
  v_cvt_pk_bf16_f32 v155, v246, v247
  v_mfma_f32_16x16x32_bf16 a[56:59], a[184:187], v[48:51], a[56:59]
  v_lshlrev_b32 v240, 16, v156
  v_and_b32 v241, s46, v156
  v_lshlrev_b32 v242, 16, v157
  v_and_b32 v243, s46, v157
  v_lshlrev_b32 v244, 16, v158
  v_mfma_f32_16x16x32_bf16 a[60:63], a[188:191], v[48:51], a[60:63]
  v_and_b32 v245, s46, v158
  v_lshlrev_b32 v246, 16, v159
  v_and_b32 v247, s46, v159
  v_pk_mul_f32 v[240:241], v[240:241], s[44:45]
  v_pk_mul_f32 v[242:243], v[242:243], s[44:45]
  v_pk_mul_f32 v[244:245], v[244:245], s[44:45]
  v_pk_mul_f32 v[246:247], v[246:247], s[44:45]
  v_mfma_f32_16x16x32_bf16 a[196:199], a[216:219], v[48:51], a[196:199]
  v_cvt_pk_bf16_f32 v156, v240, v241
  v_cvt_pk_bf16_f32 v157, v242, v243
  v_cvt_pk_bf16_f32 v158, v244, v245
  v_cvt_pk_bf16_f32 v159, v246, v247
  v_mfma_f32_16x16x32_bf16 v[40:43], a[128:131], v[144:147], 0
  v_max3_f32 v71, v32, v33, v71
  v_max3_f32 v71, v34, v35, v71
  v_max3_f32 v71, v36, v37, v71
  v_max3_f32 v71, v38, v39, v71
  v_mov_b32 v23, v71
  s_nop 1
  v_permlane32_swap_b32 v23, v71
  v_max_f32 v71, v23, v71
  v_mfma_f32_16x16x32_bf16 v[40:43], a[132:135], v[148:151], v[40:43]
  v_mov_b32 v23, v71
  s_nop 1
  v_permlane16_swap_b32 v23, v71
  v_max_f32 v23, v23, v71
  v_sub_f32 v32, v32, v23
  v_sub_f32 v33, v33, v23
  v_sub_f32 v34, v34, v23
  v_sub_f32 v35, v35, v23
  v_mfma_f32_16x16x32_bf16 v[40:43], a[136:139], v[152:155], v[40:43]
  v_sub_f32 v36, v36, v23
  v_sub_f32 v37, v37, v23
  v_sub_f32 v38, v38, v23
  v_sub_f32 v39, v39, v23
  v_sub_f32 v68, 0, v23
  v_sub_f32 v69, 0, v23
  v_sub_f32 v70, 0, v23
  v_mfma_f32_16x16x32_bf16 v[40:43], a[140:143], v[156:159], v[40:43]
  v_sub_f32 v71, 0, v23
  v_exp_f32 v32, v32
  v_exp_f32 v33, v33
  v_exp_f32 v34, v34
  v_mfma_f32_16x16x32_bf16 v[44:47], a[144:147], v[144:147], 0
  v_cvt_pk_bf16_f32 v48, v32, v33
  v_exp_f32 v35, v35
  v_exp_f32 v36, v36
  v_cvt_pk_bf16_f32 v49, v34, v35
  v_exp_f32 v37, v37
  v_mfma_f32_16x16x32_bf16 v[44:47], a[148:151], v[148:151], v[44:47]
  v_exp_f32 v38, v38
  v_cvt_pk_bf16_f32 v50, v36, v37
  v_exp_f32 v39, v39
  v_mfma_f32_16x16x32_bf16 v[44:47], a[152:155], v[152:155], v[44:47]
  v_cvt_pk_bf16_f32 v51, v38, v39
  s_waitcnt lgkmcnt(0)
  v_lshlrev_b32 v240, 16, v160
  v_and_b32 v241, s46, v160
  v_lshlrev_b32 v242, 16, v161
  v_and_b32 v243, s46, v161
  v_lshlrev_b32 v244, 16, v162
  v_mfma_f32_16x16x32_bf16 v[44:47], a[156:159], v[156:159], v[44:47]
  v_and_b32 v245, s46, v162
  v_lshlrev_b32 v246, 16, v163
  v_and_b32 v247, s46, v163
  v_pk_mul_f32 v[240:241], v[240:241], s[44:45]
  v_pk_mul_f32 v[242:243], v[242:243], s[44:45]
  v_pk_mul_f32 v[244:245], v[244:245], s[44:45]
  v_pk_mul_f32 v[246:247], v[246:247], s[44:45]
  v_mfma_f32_16x16x32_bf16 a[64:67], a[160:163], v[52:55], a[64:67]
  ds_read_b64_tr_b16 a[160:161], v5 offset:0
  ds_read_b64_tr_b16 a[162:163], v5 offset:4096
  v_cvt_pk_bf16_f32 v160, v240, v241
  v_cvt_pk_bf16_f32 v161, v242, v243
  v_cvt_pk_bf16_f32 v162, v244, v245
  v_cvt_pk_bf16_f32 v163, v246, v247
  v_lshlrev_b32 v240, 16, v164
  v_and_b32 v241, s46, v164
  v_lshlrev_b32 v242, 16, v165
  v_mfma_f32_16x16x32_bf16 a[68:71], a[164:167], v[52:55], a[68:71]
  ds_read_b64_tr_b16 a[164:165], v6 offset:0
  ds_read_b64_tr_b16 a[166:167], v6 offset:4096
  v_and_b32 v243, s46, v165
  v_lshlrev_b32 v244, 16, v166
  v_and_b32 v245, s46, v166
  v_lshlrev_b32 v246, 16, v167
  v_and_b32 v247, s46, v167
  v_pk_mul_f32 v[240:241], v[240:241], s[44:45]
  v_pk_mul_f32 v[242:243], v[242:243], s[44:45]
  v_pk_mul_f32 v[244:245], v[244:245], s[44:45]
  v_pk_mul_f32 v[246:247], v[246:247], s[44:45]
  v_mfma_f32_16x16x32_bf16 a[72:75], a[168:171], v[52:55], a[72:75]
  ds_read_b64_tr_b16 a[168:169], v7 offset:0
  ds_read_b64_tr_b16 a[170:171], v7 offset:4096
  v_cvt_pk_bf16_f32 v164, v240, v241
  v_cvt_pk_bf16_f32 v165, v242, v243
  v_cvt_pk_bf16_f32 v166, v244, v245
  v_cvt_pk_bf16_f32 v167, v246, v247
  v_lshlrev_b32 v240, 16, v168
  v_mfma_f32_16x16x32_bf16 a[76:79], a[172:175], v[52:55], a[76:79]
  ds_read_b64_tr_b16 a[172:173], v8 offset:0
  ds_read_b64_tr_b16 a[174:175], v8 offset:4096
  v_and_b32 v241, s46, v168
  v_lshlrev_b32 v242, 16, v169
  v_and_b32 v243, s46, v169
  v_lshlrev_b32 v244, 16, v170
  v_and_b32 v245, s46, v170
  v_lshlrev_b32 v246, 16, v171
  v_and_b32 v247, s46, v171
  v_pk_mul_f32 v[240:241], v[240:241], s[44:45]
  v_pk_mul_f32 v[242:243], v[242:243], s[44:45]
  v_pk_mul_f32 v[244:245], v[244:245], s[44:45]
  v_pk_mul_f32 v[246:247], v[246:247], s[44:45]
  v_mfma_f32_16x16x32_bf16 a[80:83], a[176:179], v[52:55], a[80:83]
  ds_read_b64_tr_b16 a[176:177], v9 offset:0
  ds_read_b64_tr_b16 a[178:179], v9 offset:4096
  v_cvt_pk_bf16_f32 v168, v240, v241
  v_cvt_pk_bf16_f32 v169, v242, v243
  v_mfma_f32_16x16x32_bf16 a[84:87], a[180:183], v[52:55], a[84:87]
  ds_read_b64_tr_b16 a[180:181], v10 offset:0
  ds_read_b64_tr_b16 a[182:183], v10 offset:4096
  v_cvt_pk_bf16_f32 v170, v244, v245
  v_cvt_pk_bf16_f32 v171, v246, v247
  v_lshlrev_b32 v240, 16, v172
  v_and_b32 v241, s46, v172
  v_lshlrev_b32 v242, 16, v173
  v_and_b32 v243, s46, v173
  v_lshlrev_b32 v244, 16, v174
  v_mfma_f32_16x16x32_bf16 a[88:91], a[184:187], v[52:55], a[88:91]
  ds_read_b64_tr_b16 a[184:185], v11 offset:0
  ds_read_b64_tr_b16 a[186:187], v11 offset:4096
  v_and_b32 v245, s46, v174
  v_lshlrev_b32 v246, 16, v175
  v_and_b32 v247, s46, v175
  v_pk_mul_f32 v[240:241], v[240:241], s[44:45]
  v_pk_mul_f32 v[242:243], v[242:243], s[44:45]
  v_pk_mul_f32 v[244:245], v[244:245], s[44:45]
  v_pk_mul_f32 v[246:247], v[246:247], s[44:45]
  v_mfma_f32_16x16x32_bf16 a[92:95], a[188:191], v[52:55], a[92:95]
  ds_read_b64_tr_b16 a[188:189], v12 offset:0
  ds_read_b64_tr_b16 a[190:191], v12 offset:4096
  v_cvt_pk_bf16_f32 v172, v240, v241
  v_cvt_pk_bf16_f32 v173, v242, v243
  v_cvt_pk_bf16_f32 v174, v244, v245
  v_cvt_pk_bf16_f32 v175, v246, v247
  s_add_u32 m0, s25, 49152
  s_nop 0
  buffer_load_dwordx4 v13, s[12:15], s28 offen offset:0 nt lds
  v_mfma_f32_16x16x32_bf16 a[200:203], a[216:219], v[52:55], a[200:203]
  buffer_load_dwordx4 v14, s[12:15], s28 offen offset:1024 nt lds
  buffer_load_dwordx4 v15, s[12:15], s28 offen offset:2048 nt lds
  buffer_load_dwordx4 v16, s[12:15], s28 offen offset:3072 nt lds
  v_mfma_f32_16x16x32_bf16 v[32:35], a[128:131], v[160:163], 0
  ds_read_b128 a[128:131], v1 offset:8192
  v_max3_f32 v75, v40, v41, v75
  v_max3_f32 v75, v42, v43, v75
  v_max3_f32 v75, v44, v45, v75
  v_mfma_f32_16x16x32_bf16 v[32:35], a[132:135], v[164:167], v[32:35]
  ds_read_b128 a[132:135], v2 offset:8192
  v_max3_f32 v75, v46, v47, v75
  v_mov_b32 v22, v75
  v_mfma_f32_16x16x32_bf16 v[32:35], a[136:139], v[168:171], v[32:35]
  ds_read_b128 a[136:139], v3 offset:8192
  v_permlane32_swap_b32 v22, v75
  v_max_f32 v75, v22, v75
  v_mov_b32 v22, v75
  v_mfma_f32_16x16x32_bf16 v[32:35], a[140:143], v[172:175], v[32:35]
  ds_read_b128 a[140:143], v4 offset:8192
  v_permlane16_swap_b32 v22, v75
  v_max_f32 v22, v22, v75
  v_mfma_f32_16x16x32_bf16 v[36:39], a[144:147], v[160:163], 0
  ds_read_b128 a[144:147], v1 offset:12288
  v_sub_f32 v40, v40, v22
  v_sub_f32 v41, v41, v22
  v_sub_f32 v42, v42, v22
  v_mfma_f32_16x16x32_bf16 v[36:39], a[148:151], v[164:167], v[36:39]
  ds_read_b128 a[148:151], v2 offset:12288
  v_sub_f32 v43, v43, v22
  v_sub_f32 v44, v44, v22
  v_mfma_f32_16x16x32_bf16 v[36:39], a[152:155], v[168:171], v[36:39]
  ds_read_b128 a[152:155], v3 offset:12288
  v_sub_f32 v45, v45, v22
  v_sub_f32 v46, v46, v22
  v_sub_f32 v47, v47, v22
  v_mfma_f32_16x16x32_bf16 v[36:39], a[156:159], v[172:175], v[36:39]
  ds_read_b128 a[156:159], v4 offset:12288
  v_sub_f32 v72, 0, v22
  v_sub_f32 v73, 0, v22
  s_waitcnt lgkmcnt(8)
  v_mfma_f32_16x16x32_bf16 a[96:99], a[160:163], v[48:51], 0
  v_sub_f32 v74, 0, v22
  v_sub_f32 v75, 0, v22
  v_exp_f32 v40, v40
  v_mfma_f32_16x16x32_bf16 a[100:103], a[164:167], v[48:51], 0
  v_exp_f32 v41, v41
  v_mfma_f32_16x16x32_bf16 a[104:107], a[168:171], v[48:51], 0
  v_exp_f32 v42, v42
  v_mfma_f32_16x16x32_bf16 a[108:111], a[172:175], v[48:51], 0
  v_cvt_pk_bf16_f32 v52, v40, v41
  v_exp_f32 v43, v43
  v_mfma_f32_16x16x32_bf16 a[112:115], a[176:179], v[48:51], 0
  v_exp_f32 v44, v44
  v_mfma_f32_16x16x32_bf16 a[116:119], a[180:183], v[48:51], 0
  v_cvt_pk_bf16_f32 v53, v42, v43
  v_exp_f32 v45, v45
  v_mfma_f32_16x16x32_bf16 a[120:123], a[184:187], v[48:51], 0
  v_exp_f32 v46, v46
  v_mfma_f32_16x16x32_bf16 a[124:127], a[188:191], v[48:51], 0
  v_cvt_pk_bf16_f32 v54, v44, v45
  v_exp_f32 v47, v47
  v_mfma_f32_16x16x32_bf16 a[204:207], a[216:219], v[48:51], 0
  v_cvt_pk_bf16_f32 v55, v46, v47
  s_waitcnt lgkmcnt(0)
  v_mfma_f32_16x16x32_bf16 v[40:43], a[128:131], v[128:131], v[68:71]
  v_max3_f32 v79, v32, v33, v79
  v_max3_f32 v79, v34, v35, v79
  v_max3_f32 v79, v36, v37, v79
  v_max3_f32 v79, v38, v39, v79
  v_mfma_f32_16x16x32_bf16 v[40:43], a[132:135], v[132:135], v[40:43]
  v_mov_b32 v23, v79
  s_nop 1
  v_permlane32_swap_b32 v23, v79
  v_max_f32 v79, v23, v79
  v_mfma_f32_16x16x32_bf16 v[40:43], a[136:139], v[136:139], v[40:43]
  v_mov_b32 v23, v79
  s_nop 1
  v_permlane16_swap_b32 v23, v79
  v_max_f32 v23, v23, v79
  v_mfma_f32_16x16x32_bf16 v[40:43], a[140:143], v[140:143], v[40:43]
  v_sub_f32 v32, v32, v23
  v_sub_f32 v33, v33, v23
  v_sub_f32 v34, v34, v23
  v_mfma_f32_16x16x32_bf16 v[44:47], a[144:147], v[128:131], v[68:71]
  v_sub_f32 v35, v35, v23
  v_sub_f32 v36, v36, v23
  v_sub_f32 v37, v37, v23
  v_mfma_f32_16x16x32_bf16 v[44:47], a[148:151], v[132:135], v[44:47]
  v_sub_f32 v38, v38, v23
  v_sub_f32 v39, v39, v23
  v_sub_f32 v76, 0, v23
  v_mfma_f32_16x16x32_bf16 v[44:47], a[152:155], v[136:139], v[44:47]
  v_sub_f32 v77, 0, v23
  v_sub_f32 v78, 0, v23
  v_sub_f32 v79, 0, v23
  v_mfma_f32_16x16x32_bf16 v[44:47], a[156:159], v[140:143], v[44:47]
  v_exp_f32 v32, v32
  v_exp_f32 v33, v33
  v_mfma_f32_16x16x32_bf16 v[176:179], a[160:163], v[52:55], 0
  v_exp_f32 v34, v34
  v_mfma_f32_16x16x32_bf16 v[180:183], a[164:167], v[52:55], 0
  v_cvt_pk_bf16_f32 v48, v32, v33
  v_exp_f32 v35, v35
  v_mfma_f32_16x16x32_bf16 v[184:187], a[168:171], v[52:55], 0
  v_exp_f32 v36, v36
  v_cvt_pk_bf16_f32 v49, v34, v35
  v_mfma_f32_16x16x32_bf16 v[188:191], a[172:175], v[52:55], 0
  v_exp_f32 v37, v37
  v_exp_f32 v38, v38
  v_mfma_f32_16x16x32_bf16 v[192:195], a[176:179], v[52:55], 0
  v_cvt_pk_bf16_f32 v50, v36, v37
  v_exp_f32 v39, v39
  v_mfma_f32_16x16x32_bf16 v[196:199], a[180:183], v[52:55], 0
  v_cvt_pk_bf16_f32 v51, v38, v39
  s_add_u32 m0, s25, 114688
  v_mfma_f32_16x16x32_bf16 v[200:203], a[184:187], v[52:55], 0
  buffer_load_dwordx4 v17, s[16:19], s28 offen offset:0 nt lds
  buffer_load_dwordx4 v18, s[16:19], s28 offen offset:1024 nt lds
  v_mfma_f32_16x16x32_bf16 v[204:207], a[188:191], v[52:55], 0
  buffer_load_dwordx4 v17, s[16:19], s28 offen offset:2048 nt lds
  v_mfma_f32_16x16x32_bf16 a[208:211], a[216:219], v[52:55], 0
  buffer_load_dwordx4 v18, s[16:19], s28 offen offset:3072 nt lds
  s_add_u32 s28, s28, 16384
  v_mfma_f32_16x16x32_bf16 v[32:35], a[128:131], v[144:147], v[72:75]
  v_exp_f32 v40, v40
  v_mfma_f32_16x16x32_bf16 v[32:35], a[132:135], v[148:151], v[32:35]
  v_exp_f32 v41, v41
  v_mfma_f32_16x16x32_bf16 v[32:35], a[136:139], v[152:155], v[32:35]
  v_exp_f32 v42, v42
  v_mfma_f32_16x16x32_bf16 v[32:35], a[140:143], v[156:159], v[32:35]
  v_exp_f32 v43, v43
  v_mfma_f32_16x16x32_bf16 v[36:39], a[144:147], v[144:147], v[72:75]
  v_cvt_pk_bf16_f32 v52, v40, v41
  v_cvt_pk_bf16_f32 v53, v42, v43
  v_mfma_f32_16x16x32_bf16 v[36:39], a[148:151], v[148:151], v[36:39]
  v_exp_f32 v44, v44
  v_mfma_f32_16x16x32_bf16 v[36:39], a[152:155], v[152:155], v[36:39]
  v_exp_f32 v45, v45
  v_mfma_f32_16x16x32_bf16 v[36:39], a[156:159], v[156:159], v[36:39]
  v_exp_f32 v46, v46
  v_mfma_f32_16x16x32_bf16 v[208:211], a[160:163], v[48:51], 0
  ds_read_b64_tr_b16 a[160:161], v5 offset:8192
  ds_read_b64_tr_b16 a[162:163], v5 offset:12288
  v_mfma_f32_16x16x32_bf16 v[212:215], a[164:167], v[48:51], 0
  ds_read_b64_tr_b16 a[164:165], v6 offset:8192
  ds_read_b64_tr_b16 a[166:167], v6 offset:12288
  v_mfma_f32_16x16x32_bf16 v[216:219], a[168:171], v[48:51], 0
  ds_read_b64_tr_b16 a[168:169], v7 offset:8192
  ds_read_b64_tr_b16 a[170:171], v7 offset:12288
  v_mfma_f32_16x16x32_bf16 v[220:223], a[172:175], v[48:51], 0
  ds_read_b64_tr_b16 a[172:173], v8 offset:8192
  ds_read_b64_tr_b16 a[174:175], v8 offset:12288
  v_mfma_f32_16x16x32_bf16 v[224:227], a[176:179], v[48:51], 0
  ds_read_b64_tr_b16 a[176:177], v9 offset:8192
  ds_read_b64_tr_b16 a[178:179], v9 offset:12288
  v_mfma_f32_16x16x32_bf16 v[228:231], a[180:183], v[48:51], 0
  ds_read_b64_tr_b16 a[180:181], v10 offset:8192
  ds_read_b64_tr_b16 a[182:183], v10 offset:12288
  v_mfma_f32_16x16x32_bf16 v[232:235], a[184:187], v[48:51], 0
  ds_read_b64_tr_b16 a[184:185], v11 offset:8192
  ds_read_b64_tr_b16 a[186:187], v11 offset:12288
  v_mfma_f32_16x16x32_bf16 v[236:239], a[188:191], v[48:51], 0
  ds_read_b64_tr_b16 a[188:189], v12 offset:8192
  ds_read_b64_tr_b16 a[190:191], v12 offset:12288
  v_mfma_f32_16x16x32_bf16 a[212:215], a[216:219], v[48:51], 0
  v_exp_f32 v47, v47
  v_cvt_pk_bf16_f32 v54, v44, v45
  v_cvt_pk_bf16_f32 v55, v46, v47
  v_mfma_f32_16x16x32_bf16 v[40:43], a[128:131], v[160:163], v[76:79]
  v_exp_f32 v32, v32
  v_mfma_f32_16x16x32_bf16 v[40:43], a[132:135], v[164:167], v[40:43]
  ds_read_b128 a[128:131], v1 offset:16384
  ds_read_b128 a[132:135], v2 offset:16384
  v_mfma_f32_16x16x32_bf16 v[40:43], a[136:139], v[168:171], v[40:43]
  v_exp_f32 v33, v33
  v_mfma_f32_16x16x32_bf16 v[40:43], a[140:143], v[172:175], v[40:43]
  ds_read_b128 a[136:139], v3 offset:16384
  ds_read_b128 a[140:143], v4 offset:16384
  v_mfma_f32_16x16x32_bf16 v[44:47], a[144:147], v[160:163], v[76:79]
  v_exp_f32 v34, v34
  v_mfma_f32_16x16x32_bf16 v[44:47], a[148:151], v[164:167], v[44:47]
  ds_read_b128 a[144:147], v1 offset:20480
  ds_read_b128 a[148:151], v2 offset:20480
  v_mfma_f32_16x16x32_bf16 v[44:47], a[152:155], v[168:171], v[44:47]
  s_waitcnt lgkmcnt(6)
  v_cvt_pk_bf16_f32 v48, v32, v33
  v_mfma_f32_16x16x32_bf16 v[44:47], a[156:159], v[172:175], v[44:47]
  ds_read_b128 a[152:155], v3 offset:20480
  ds_read_b128 a[156:159], v4 offset:20480
  v_mfma_f32_16x16x32_bf16 a[96:99], a[160:163], v[52:55], a[96:99]
  v_exp_f32 v35, v35
  v_mfma_f32_16x16x32_bf16 a[100:103], a[164:167], v[52:55], a[100:103]
  v_exp_f32 v36, v36
  v_mfma_f32_16x16x32_bf16 a[104:107], a[168:171], v[52:55], a[104:107]
  v_exp_f32 v37, v37
  v_mfma_f32_16x16x32_bf16 a[108:111], a[172:175], v[52:55], a[108:111]
  v_cvt_pk_bf16_f32 v49, v34, v35
  v_cvt_pk_bf16_f32 v50, v36, v37
  v_mfma_f32_16x16x32_bf16 a[112:115], a[176:179], v[52:55], a[112:115]
  v_exp_f32 v38, v38
  v_mfma_f32_16x16x32_bf16 a[116:119], a[180:183], v[52:55], a[116:119]
  v_exp_f32 v39, v39
  v_mfma_f32_16x16x32_bf16 a[120:123], a[184:187], v[52:55], a[120:123]
  v_cvt_pk_bf16_f32 v51, v38, v39
  v_mfma_f32_16x16x32_bf16 a[124:127], a[188:191], v[52:55], a[124:127]
  v_mfma_f32_16x16x32_bf16 a[204:207], a[216:219], v[52:55], a[204:207]
  s_waitcnt lgkmcnt(0)
  v_mfma_f32_16x16x32_bf16 v[32:35], a[128:131], v[128:131], v[68:71]
  v_exp_f32 v40, v40
  v_mfma_f32_16x16x32_bf16 v[32:35], a[132:135], v[132:135], v[32:35]
  v_exp_f32 v41, v41
  v_mfma_f32_16x16x32_bf16 v[32:35], a[136:139], v[136:139], v[32:35]
  v_exp_f32 v42, v42
  v_mfma_f32_16x16x32_bf16 v[32:35], a[140:143], v[140:143], v[32:35]
  v_exp_f32 v43, v43
  v_mfma_f32_16x16x32_bf16 v[36:39], a[144:147], v[128:131], v[68:71]
  v_cvt_pk_bf16_f32 v52, v40, v41
  v_cvt_pk_bf16_f32 v53, v42, v43
  v_mfma_f32_16x16x32_bf16 v[36:39], a[148:151], v[132:135], v[36:39]
  v_exp_f32 v44, v44
  v_mfma_f32_16x16x32_bf16 v[36:39], a[152:155], v[136:139], v[36:39]
  v_exp_f32 v45, v45
  v_mfma_f32_16x16x32_bf16 v[36:39], a[156:159], v[140:143], v[36:39]
  v_exp_f32 v46, v46
  v_mfma_f32_16x16x32_bf16 v[176:179], a[160:163], v[48:51], v[176:179]
  v_exp_f32 v47, v47
  v_mfma_f32_16x16x32_bf16 v[180:183], a[164:167], v[48:51], v[180:183]
  v_cvt_pk_bf16_f32 v54, v44, v45
  v_cvt_pk_bf16_f32 v55, v46, v47
  v_mfma_f32_16x16x32_bf16 v[184:187], a[168:171], v[48:51], v[184:187]
  v_exp_f32 v32, v32
  v_mfma_f32_16x16x32_bf16 v[188:191], a[172:175], v[48:51], v[188:191]
  v_exp_f32 v33, v33
  v_mfma_f32_16x16x32_bf16 v[192:195], a[176:179], v[48:51], v[192:195]
  v_mfma_f32_16x16x32_bf16 v[196:199], a[180:183], v[48:51], v[196:199]
  v_mfma_f32_16x16x32_bf16 v[200:203], a[184:187], v[48:51], v[200:203]
  v_mfma_f32_16x16x32_bf16 v[204:207], a[188:191], v[48:51], v[204:207]
  v_mfma_f32_16x16x32_bf16 a[208:211], a[216:219], v[48:51], a[208:211]
  v_mfma_f32_16x16x32_bf16 v[40:43], a[128:131], v[144:147], v[72:75]
  v_exp_f32 v34, v34
  v_mfma_f32_16x16x32_bf16 v[40:43], a[132:135], v[148:151], v[40:43]
  v_exp_f32 v35, v35
  v_mfma_f32_16x16x32_bf16 v[40:43], a[136:139], v[152:155], v[40:43]
  v_cvt_pk_bf16_f32 v48, v32, v33
  v_cvt_pk_bf16_f32 v49, v34, v35
  v_mfma_f32_16x16x32_bf16 v[40:43], a[140:143], v[156:159], v[40:43]
  v_exp_f32 v36, v36
  v_mfma_f32_16x16x32_bf16 v[44:47], a[144:147], v[144:147], v[72:75]
  v_exp_f32 v37, v37
  v_mfma_f32_16x16x32_bf16 v[44:47], a[148:151], v[148:151], v[44:47]
  v_exp_f32 v38, v38
  v_mfma_f32_16x16x32_bf16 v[44:47], a[152:155], v[152:155], v[44:47]
  v_exp_f32 v39, v39
  v_mfma_f32_16x16x32_bf16 v[44:47], a[156:159], v[156:159], v[44:47]
  v_cvt_pk_bf16_f32 v50, v36, v37
  v_cvt_pk_bf16_f32 v51, v38, v39
  v_mfma_f32_16x16x32_bf16 v[208:211], a[160:163], v[52:55], v[208:211]
  ds_read_b64_tr_b16 a[160:161], v5 offset:16384
  ds_read_b64_tr_b16 a[162:163], v5 offset:20480
  v_mfma_f32_16x16x32_bf16 v[212:215], a[164:167], v[52:55], v[212:215]
  ds_read_b64_tr_b16 a[164:165], v6 offset:16384
  ds_read_b64_tr_b16 a[166:167], v6 offset:20480
  v_mfma_f32_16x16x32_bf16 v[216:219], a[168:171], v[52:55], v[216:219]
  ds_read_b64_tr_b16 a[168:169], v7 offset:16384
  ds_read_b64_tr_b16 a[170:171], v7 offset:20480
  v_mfma_f32_16x16x32_bf16 v[220:223], a[172:175], v[52:55], v[220:223]
  ds_read_b64_tr_b16 a[172:173], v8 offset:16384
  ds_read_b64_tr_b16 a[174:175], v8 offset:20480
  v_mfma_f32_16x16x32_bf16 v[224:227], a[176:179], v[52:55], v[224:227]
  ds_read_b64_tr_b16 a[176:177], v9 offset:16384
  ds_read_b64_tr_b16 a[178:179], v9 offset:20480
  v_mfma_f32_16x16x32_bf16 v[228:231], a[180:183], v[52:55], v[228:231]
  ds_read_b64_tr_b16 a[180:181], v10 offset:16384
  ds_read_b64_tr_b16 a[182:183], v10 offset:20480
  v_mfma_f32_16x16x32_bf16 v[232:235], a[184:187], v[52:55], v[232:235]
  ds_read_b64_tr_b16 a[184:185], v11 offset:16384
  ds_read_b64_tr_b16 a[186:187], v11 offset:20480
  v_mfma_f32_16x16x32_bf16 v[236:239], a[188:191], v[52:55], v[236:239]
  ds_read_b64_tr_b16 a[188:189], v12 offset:16384
  ds_read_b64_tr_b16 a[190:191], v12 offset:20480
  v_mfma_f32_16x16x32_bf16 a[212:215], a[216:219], v[52:55], a[212:215]
  v_mfma_f32_16x16x32_bf16 v[32:35], a[128:131], v[160:163], v[76:79]
  v_exp_f32 v40, v40
  v_mfma_f32_16x16x32_bf16 v[32:35], a[132:135], v[164:167], v[32:35]
  ds_read_b128 a[128:131], v1 offset:24576
  ds_read_b128 a[132:135], v2 offset:24576
  v_mfma_f32_16x16x32_bf16 v[32:35], a[136:139], v[168:171], v[32:35]
  v_exp_f32 v41, v41
  v_mfma_f32_16x16x32_bf16 v[32:35], a[140:143], v[172:175], v[32:35]
  ds_read_b128 a[136:139], v3 offset:24576
  ds_read_b128 a[140:143], v4 offset:24576
  v_mfma_f32_16x16x32_bf16 v[36:39], a[144:147], v[160:163], v[76:79]
  v_exp_f32 v42, v42
  v_mfma_f32_16x16x32_bf16 v[36:39], a[148:151], v[164:167], v[36:39]
  ds_read_b128 a[144:147], v1 offset:28672
  ds_read_b128 a[148:151], v2 offset:28672
  v_mfma_f32_16x16x32_bf16 v[36:39], a[152:155], v[168:171], v[36:39]
  s_waitcnt lgkmcnt(6)
  v_cvt_pk_bf16_f32 v52, v40, v41
  v_mfma_f32_16x16x32_bf16 v[36:39], a[156:159], v[172:175], v[36:39]
  ds_read_b128 a[152:155], v3 offset:28672
  ds_read_b128 a[156:159], v4 offset:28672
  v_mfma_f32_16x16x32_bf16 a[96:99], a[160:163], v[48:51], a[96:99]
  v_exp_f32 v43, v43
  v_mfma_f32_16x16x32_bf16 a[100:103], a[164:167], v[48:51], a[100:103]
  v_exp_f32 v44, v44
  v_mfma_f32_16x16x32_bf16 a[104:107], a[168:171], v[48:51], a[104:107]
  v_exp_f32 v45, v45
  v_mfma_f32_16x16x32_bf16 a[108:111], a[172:175], v[48:51], a[108:111]
  v_cvt_pk_bf16_f32 v53, v42, v43
  v_cvt_pk_bf16_f32 v54, v44, v45
  v_mfma_f32_16x16x32_bf16 a[112:115], a[176:179], v[48:51], a[112:115]
  v_exp_f32 v46, v46
  v_mfma_f32_16x16x32_bf16 a[116:119], a[180:183], v[48:51], a[116:119]
  v_exp_f32 v47, v47
  v_mfma_f32_16x16x32_bf16 a[120:123], a[184:187], v[48:51], a[120:123]
  v_cvt_pk_bf16_f32 v55, v46, v47
  v_mfma_f32_16x16x32_bf16 a[124:127], a[188:191], v[48:51], a[124:127]
  v_mfma_f32_16x16x32_bf16 a[204:207], a[216:219], v[48:51], a[204:207]
  s_waitcnt lgkmcnt(0)
  v_mfma_f32_16x16x32_bf16 v[40:43], a[128:131], v[128:131], v[68:71]
  v_exp_f32 v32, v32
  v_mfma_f32_16x16x32_bf16 v[40:43], a[132:135], v[132:135], v[40:43]
  v_exp_f32 v33, v33
  v_mfma_f32_16x16x32_bf16 v[40:43], a[136:139], v[136:139], v[40:43]
  v_exp_f32 v34, v34
  v_mfma_f32_16x16x32_bf16 v[40:43], a[140:143], v[140:143], v[40:43]
  v_exp_f32 v35, v35
  v_mfma_f32_16x16x32_bf16 v[44:47], a[144:147], v[128:131], v[68:71]
  v_cvt_pk_bf16_f32 v48, v32, v33
  v_cvt_pk_bf16_f32 v49, v34, v35
  v_mfma_f32_16x16x32_bf16 v[44:47], a[148:151], v[132:135], v[44:47]
  v_exp_f32 v36, v36
  v_mfma_f32_16x16x32_bf16 v[44:47], a[152:155], v[136:139], v[44:47]
  v_exp_f32 v37, v37
  v_mfma_f32_16x16x32_bf16 v[44:47], a[156:159], v[140:143], v[44:47]
  v_exp_f32 v38, v38
  v_mfma_f32_16x16x32_bf16 v[176:179], a[160:163], v[52:55], v[176:179]
  v_exp_f32 v39, v39
  v_mfma_f32_16x16x32_bf16 v[180:183], a[164:167], v[52:55], v[180:183]
  v_cvt_pk_bf16_f32 v50, v36, v37
  v_cvt_pk_bf16_f32 v51, v38, v39
  v_mfma_f32_16x16x32_bf16 v[184:187], a[168:171], v[52:55], v[184:187]
  v_exp_f32 v40, v40
  v_mfma_f32_16x16x32_bf16 v[188:191], a[172:175], v[52:55], v[188:191]
  v_exp_f32 v41, v41
  v_mfma_f32_16x16x32_bf16 v[192:195], a[176:179], v[52:55], v[192:195]
  v_mfma_f32_16x16x32_bf16 v[196:199], a[180:183], v[52:55], v[196:199]
  v_mfma_f32_16x16x32_bf16 v[200:203], a[184:187], v[52:55], v[200:203]
  v_mfma_f32_16x16x32_bf16 v[204:207], a[188:191], v[52:55], v[204:207]
  v_mfma_f32_16x16x32_bf16 a[208:211], a[216:219], v[52:55], a[208:211]
  v_mfma_f32_16x16x32_bf16 v[32:35], a[128:131], v[144:147], v[72:75]
  v_exp_f32 v42, v42
  v_mfma_f32_16x16x32_bf16 v[32:35], a[132:135], v[148:151], v[32:35]
  v_exp_f32 v43, v43
  v_mfma_f32_16x16x32_bf16 v[32:35], a[136:139], v[152:155], v[32:35]
  v_cvt_pk_bf16_f32 v52, v40, v41
  v_cvt_pk_bf16_f32 v53, v42, v43
  v_mfma_f32_16x16x32_bf16 v[32:35], a[140:143], v[156:159], v[32:35]
  v_exp_f32 v44, v44
  v_mfma_f32_16x16x32_bf16 v[36:39], a[144:147], v[144:147], v[72:75]
  v_exp_f32 v45, v45
  v_mfma_f32_16x16x32_bf16 v[36:39], a[148:151], v[148:151], v[36:39]
  v_exp_f32 v46, v46
  v_mfma_f32_16x16x32_bf16 v[36:39], a[152:155], v[152:155], v[36:39]
  v_exp_f32 v47, v47
  v_mfma_f32_16x16x32_bf16 v[36:39], a[156:159], v[156:159], v[36:39]
  v_cvt_pk_bf16_f32 v54, v44, v45
  v_cvt_pk_bf16_f32 v55, v46, v47
  v_mfma_f32_16x16x32_bf16 v[208:211], a[160:163], v[48:51], v[208:211]
  ds_read_b64_tr_b16 a[160:161], v5 offset:24576
  ds_read_b64_tr_b16 a[162:163], v5 offset:28672
  v_mfma_f32_16x16x32_bf16 v[212:215], a[164:167], v[48:51], v[212:215]
  ds_read_b64_tr_b16 a[164:165], v6 offset:24576
  ds_read_b64_tr_b16 a[166:167], v6 offset:28672
  v_mfma_f32_16x16x32_bf16 v[216:219], a[168:171], v[48:51], v[216:219]
  ds_read_b64_tr_b16 a[168:169], v7 offset:24576
  ds_read_b64_tr_b16 a[170:171], v7 offset:28672
  v_mfma_f32_16x16x32_bf16 v[220:223], a[172:175], v[48:51], v[220:223]
  ds_read_b64_tr_b16 a[172:173], v8 offset:24576
  ds_read_b64_tr_b16 a[174:175], v8 offset:28672
  v_mfma_f32_16x16x32_bf16 v[224:227], a[176:179], v[48:51], v[224:227]
  ds_read_b64_tr_b16 a[176:177], v9 offset:24576
  ds_read_b64_tr_b16 a[178:179], v9 offset:28672
  v_mfma_f32_16x16x32_bf16 v[228:231], a[180:183], v[48:51], v[228:231]
  ds_read_b64_tr_b16 a[180:181], v10 offset:24576
  ds_read_b64_tr_b16 a[182:183], v10 offset:28672
  v_mfma_f32_16x16x32_bf16 v[232:235], a[184:187], v[48:51], v[232:235]
  ds_read_b64_tr_b16 a[184:185], v11 offset:24576
  ds_read_b64_tr_b16 a[186:187], v11 offset:28672
  v_mfma_f32_16x16x32_bf16 v[236:239], a[188:191], v[48:51], v[236:239]
  ds_read_b64_tr_b16 a[188:189], v12 offset:24576
  ds_read_b64_tr_b16 a[190:191], v12 offset:28672
  v_mfma_f32_16x16x32_bf16 a[212:215], a[216:219], v[48:51], a[212:215]
  s_waitcnt lgkmcnt(0)
  s_waitcnt vmcnt(8)
  s_barrier
  v_mfma_f32_16x16x32_bf16 v[40:43], a[128:131], v[160:163], v[76:79]
  v_exp_f32 v32, v32
  v_mfma_f32_16x16x32_bf16 v[40:43], a[132:135], v[164:167], v[40:43]
  ds_read_b128 a[128:131], v1 offset:32768
  ds_read_b128 a[132:135], v2 offset:32768
  v_mfma_f32_16x16x32_bf16 v[40:43], a[136:139], v[168:171], v[40:43]
  s_add_u32 m0, s25, 0
  s_nop 0
  buffer_load_dwordx4 v13, s[12:15], s28 offen offset:0 nt lds
  v_mfma_f32_16x16x32_bf16 v[40:43], a[140:143], v[172:175], v[40:43]
  ds_read_b128 a[136:139], v3 offset:32768
  ds_read_b128 a[140:143], v4 offset:32768
  v_mfma_f32_16x16x32_bf16 v[44:47], a[144:147], v[160:163], v[76:79]
  buffer_load_dwordx4 v14, s[12:15], s28 offen offset:1024 nt lds
  v_mfma_f32_16x16x32_bf16 v[44:47], a[148:151], v[164:167], v[44:47]
  ds_read_b128 a[144:147], v1 offset:36864
  ds_read_b128 a[148:151], v2 offset:36864
  v_mfma_f32_16x16x32_bf16 v[44:47], a[152:155], v[168:171], v[44:47]
  buffer_load_dwordx4 v15, s[12:15], s28 offen offset:2048 nt lds
  v_mfma_f32_16x16x32_bf16 v[44:47], a[156:159], v[172:175], v[44:47]
  ds_read_b128 a[152:155], v3 offset:36864
  ds_read_b128 a[156:159], v4 offset:36864
  v_mfma_f32_16x16x32_bf16 a[96:99], a[160:163], v[52:55], a[96:99]
  buffer_load_dwordx4 v16, s[12:15], s28 offen offset:3072 nt lds
  v_mfma_f32_16x16x32_bf16 a[100:103], a[164:167], v[52:55], a[100:103]
  v_exp_f32 v33, v33
  v_mfma_f32_16x16x32_bf16 a[104:107], a[168:171], v[52:55], a[104:107]
  v_exp_f32 v34, v34
  v_mfma_f32_16x16x32_bf16 a[108:111], a[172:175], v[52:55], a[108:111]
  v_exp_f32 v35, v35
  v_mfma_f32_16x16x32_bf16 a[112:115], a[176:179], v[52:55], a[112:115]
  v_cvt_pk_bf16_f32 v48, v32, v33
  v_cvt_pk_bf16_f32 v49, v34, v35
  v_mfma_f32_16x16x32_bf16 a[116:119], a[180:183], v[52:55], a[116:119]
  v_exp_f32 v36, v36
  v_mfma_f32_16x16x32_bf16 a[120:123], a[184:187], v[52:55], a[120:123]
  v_exp_f32 v37, v37
  v_mfma_f32_16x16x32_bf16 a[124:127], a[188:191], v[52:55], a[124:127]
  v_exp_f32 v38, v38
  v_mfma_f32_16x16x32_bf16 a[204:207], a[216:219], v[52:55], a[204:207]
  v_exp_f32 v39, v39
  v_cvt_pk_bf16_f32 v50, v36, v37
  v_cvt_pk_bf16_f32 v51, v38, v39
  s_waitcnt lgkmcnt(0)
  v_mfma_f32_16x16x32_bf16 v[32:35], a[128:131], v[80:83], v[56:59]
  v_exp_f32 v40, v40
  v_mfma_f32_16x16x32_bf16 v[32:35], a[132:135], v[84:87], v[32:35]
  v_exp_f32 v41, v41
  v_mfma_f32_16x16x32_bf16 v[32:35], a[136:139], v[88:91], v[32:35]
  s_add_u32 m0, s25, 65536
  s_nop 0
  buffer_load_dwordx4 v17, s[16:19], s28 offen offset:0 nt lds
  v_mfma_f32_16x16x32_bf16 v[32:35], a[140:143], v[92:95], v[32:35]
  v_exp_f32 v42, v42
  v_mfma_f32_16x16x32_bf16 v[36:39], a[144:147], v[80:83], v[56:59]
  buffer_load_dwordx4 v18, s[16:19], s28 offen offset:1024 nt lds
  v_mfma_f32_16x16x32_bf16 v[36:39], a[148:151], v[84:87], v[36:39]
  v_exp_f32 v43, v43
  v_mfma_f32_16x16x32_bf16 v[36:39], a[152:155], v[88:91], v[36:39]
  buffer_load_dwordx4 v17, s[16:19], s28 offen offset:2048 nt lds
  v_mfma_f32_16x16x32_bf16 v[36:39], a[156:159], v[92:95], v[36:39]
  v_cvt_pk_bf16_f32 v52, v40, v41
  v_cvt_pk_bf16_f32 v53, v42, v43
  v_mfma_f32_16x16x32_bf16 v[176:179], a[160:163], v[48:51], v[176:179]
  buffer_load_dwordx4 v18, s[16:19], s28 offen offset:3072 nt lds
  v_mfma_f32_16x16x32_bf16 v[180:183], a[164:167], v[48:51], v[180:183]
  v_exp_f32 v44, v44
  v_mfma_f32_16x16x32_bf16 v[184:187], a[168:171], v[48:51], v[184:187]
  s_add_u32 s28, s28, 16384
  s_add_u32 m0, s25, 16384
  s_nop 0
  buffer_load_dwordx4 v13, s[12:15], s28 offen offset:0 nt lds
  v_mfma_f32_16x16x32_bf16 v[188:191], a[172:175], v[48:51], v[188:191]
  v_exp_f32 v45, v45
  v_mfma_f32_16x16x32_bf16 v[192:195], a[176:179], v[48:51], v[192:195]
  v_exp_f32 v46, v46
  v_mfma_f32_16x16x32_bf16 v[196:199], a[180:183], v[48:51], v[196:199]
  v_exp_f32 v47, v47
  v_mfma_f32_16x16x32_bf16 v[200:203], a[184:187], v[48:51], v[200:203]
  v_cvt_pk_bf16_f32 v54, v44, v45
  v_cvt_pk_bf16_f32 v55, v46, v47
  v_mfma_f32_16x16x32_bf16 v[204:207], a[188:191], v[48:51], v[204:207]
  v_mfma_f32_16x16x32_bf16 a[208:211], a[216:219], v[48:51], a[208:211]
  v_exp_f32 v32, v32
  v_exp_f32 v33, v33
  s_mul_i32 s62, s27, 98304
  s_mul_i32 s49, s24, 20480
  s_add_u32 s62, s62, s49
  s_branch L_body2
L_fuse:
  s_mov_b32 s30, 0
  v_mfma_f32_16x16x32_bf16 v[208:211], a[160:163], v[52:55], v[208:211]
  ds_read_b64_tr_b16 a[160:161], v5 offset:0
  ds_read_b64_tr_b16 a[162:163], v5 offset:4096
  v_accvgpr_read_b32 v80, a220
  v_accvgpr_read_b32 v81, a221
  v_accvgpr_read_b32 v82, a222
  v_accvgpr_read_b32 v83, a223
  v_accvgpr_read_b32 v84, a224
  v_accvgpr_read_b32 v85, a225
  v_accvgpr_read_b32 v86, a226
  v_accvgpr_read_b32 v87, a227
  v_accvgpr_read_b32 v88, a228
  v_accvgpr_read_b32 v89, a229
  v_accvgpr_read_b32 v90, a230
  v_accvgpr_read_b32 v91, a231
  v_accvgpr_read_b32 v92, a232
  v_accvgpr_read_b32 v93, a233
  v_accvgpr_read_b32 v94, a234
  v_accvgpr_read_b32 v95, a235
  v_lshlrev_b32 v240, 16, v80
  v_and_b32 v241, s46, v80
  v_lshlrev_b32 v242, 16, v81
  v_and_b32 v243, s46, v81
  v_lshlrev_b32 v244, 16, v82
  v_and_b32 v245, s46, v82
  v_lshlrev_b32 v246, 16, v83
  v_and_b32 v247, s46, v83
  v_pk_mul_f32 v[240:241], v[240:241], s[44:45]
  v_pk_mul_f32 v[242:243], v[242:243], s[44:45]
  v_pk_mul_f32 v[244:245], v[244:245], s[44:45]
  v_pk_mul_f32 v[246:247], v[246:247], s[44:45]
  v_cvt_pk_bf16_f32 v80, v240, v241
  v_cvt_pk_bf16_f32 v81, v242, v243
  v_cvt_pk_bf16_f32 v82, v244, v245
  v_mfma_f32_16x16x32_bf16 v[212:215], a[164:167], v[52:55], v[212:215]
  ds_read_b64_tr_b16 a[164:165], v6 offset:0
  ds_read_b64_tr_b16 a[166:167], v6 offset:4096
  v_cvt_pk_bf16_f32 v83, v246, v247
  v_lshlrev_b32 v240, 16, v84
  v_and_b32 v241, s46, v84
  v_lshlrev_b32 v242, 16, v85
  v_and_b32 v243, s46, v85
  v_lshlrev_b32 v244, 16, v86
  v_and_b32 v245, s46, v86
  v_lshlrev_b32 v246, 16, v87
  v_and_b32 v247, s46, v87
  v_pk_mul_f32 v[240:241], v[240:241], s[44:45]
  v_pk_mul_f32 v[242:243], v[242:243], s[44:45]
  v_pk_mul_f32 v[244:245], v[244:245], s[44:45]
  v_pk_mul_f32 v[246:247], v[246:247], s[44:45]
  v_cvt_pk_bf16_f32 v84, v240, v241
  v_mfma_f32_16x16x32_bf16 v[216:219], a[168:171], v[52:55], v[216:219]
  ds_read_b64_tr_b16 a[168:169], v7 offset:0
  ds_read_b64_tr_b16 a[170:171], v7 offset:4096
  v_cvt_pk_bf16_f32 v85, v242, v243
  v_cvt_pk_bf16_f32 v86, v244, v245
  v_cvt_pk_bf16_f32 v87, v246, v247
  v_lshlrev_b32 v240, 16, v88
  v_and_b32 v241, s46, v88
  v_lshlrev_b32 v242, 16, v89
  v_and_b32 v243, s46, v89
  v_lshlrev_b32 v244, 16, v90
  v_and_b32 v245, s46, v90
  v_lshlrev_b32 v246, 16, v91
  v_and_b32 v247, s46, v91
  v_pk_mul_f32 v[240:241], v[240:241], s[44:45]
  v_pk_mul_f32 v[242:243], v[242:243], s[44:45]
  v_pk_mul_f32 v[244:245], v[244:245], s[44:45]
  v_pk_mul_f32 v[246:247], v[246:247], s[44:45]
  v_mfma_f32_16x16x32_bf16 v[220:223], a[172:175], v[52:55], v[220:223]
  ds_read_b64_tr_b16 a[172:173], v8 offset:0
  ds_read_b64_tr_b16 a[174:175], v8 offset:4096
  v_cvt_pk_bf16_f32 v88, v240, v241
  v_cvt_pk_bf16_f32 v89, v242, v243
  v_cvt_pk_bf16_f32 v90, v244, v245
  v_cvt_pk_bf16_f32 v91, v246, v247
  v_lshlrev_b32 v240, 16, v92
  v_and_b32 v241, s46, v92
  v_lshlrev_b32 v242, 16, v93
  v_and_b32 v243, s46, v93
  v_lshlrev_b32 v244, 16, v94
  v_and_b32 v245, s46, v94
  v_lshlrev_b32 v246, 16, v95
  v_and_b32 v247, s46, v95
  v_pk_mul_f32 v[240:241], v[240:241], s[44:45]
  v_pk_mul_f32 v[242:243], v[242:243], s[44:45]
  v_pk_mul_f32 v[244:245], v[244:245], s[44:45]
  v_pk_mul_f32 v[246:247], v[246:247], s[44:45]
  v_mfma_f32_16x16x32_bf16 v[224:227], a[176:179], v[52:55], v[224:227]
  ds_read_b64_tr_b16 a[176:177], v9 offset:0
  ds_read_b64_tr_b16 a[178:179], v9 offset:4096
  v_cvt_pk_bf16_f32 v92, v240, v241
  v_cvt_pk_bf16_f32 v93, v242, v243
  v_cvt_pk_bf16_f32 v94, v244, v245
  v_cvt_pk_bf16_f32 v95, v246, v247
  v_accvgpr_read_b32 v96, a236
  v_accvgpr_read_b32 v97, a237
  v_accvgpr_read_b32 v98, a238
  v_accvgpr_read_b32 v99, a239
  v_accvgpr_read_b32 v100, a240
  v_accvgpr_read_b32 v101, a241
  v_accvgpr_read_b32 v102, a242
  v_accvgpr_read_b32 v103, a243
  v_accvgpr_read_b32 v104, a244
  v_accvgpr_read_b32 v105, a245
  v_accvgpr_read_b32 v106, a246
  v_accvgpr_read_b32 v107, a247
  v_accvgpr_read_b32 v108, a248
  v_accvgpr_read_b32 v109, a249
  v_accvgpr_read_b32 v110, a250
  v_accvgpr_read_b32 v111, a251
  v_lshlrev_b32 v240, 16, v96
  v_and_b32 v241, s46, v96
  v_lshlrev_b32 v242, 16, v97
  v_and_b32 v243, s46, v97
  v_lshlrev_b32 v244, 16, v98
  v_and_b32 v245, s46, v98
  v_lshlrev_b32 v246, 16, v99
  v_and_b32 v247, s46, v99
  v_pk_mul_f32 v[240:241], v[240:241], s[44:45]
  v_pk_mul_f32 v[242:243], v[242:243], s[44:45]
  v_pk_mul_f32 v[244:245], v[244:245], s[44:45]
  v_pk_mul_f32 v[246:247], v[246:247], s[44:45]
  v_mfma_f32_16x16x32_bf16 v[228:231], a[180:183], v[52:55], v[228:231]
  ds_read_b64_tr_b16 a[180:181], v10 offset:0
  ds_read_b64_tr_b16 a[182:183], v10 offset:4096
  v_cvt_pk_bf16_f32 v96, v240, v241
  v_cvt_pk_bf16_f32 v97, v242, v243
  v_cvt_pk_bf16_f32 v98, v244, v245
  v_cvt_pk_bf16_f32 v99, v246, v247
  v_lshlrev_b32 v240, 16, v100
  v_and_b32 v241, s46, v100
  v_lshlrev_b32 v242, 16, v101
  v_and_b32 v243, s46, v101
  v_lshlrev_b32 v244, 16, v102
  v_and_b32 v245, s46, v102
  v_lshlrev_b32 v246, 16, v103
  v_and_b32 v247, s46, v103
  v_pk_mul_f32 v[240:241], v[240:241], s[44:45]
  v_pk_mul_f32 v[242:243], v[242:243], s[44:45]
  v_pk_mul_f32 v[244:245], v[244:245], s[44:45]
  v_pk_mul_f32 v[246:247], v[246:247], s[44:45]
  v_mfma_f32_16x16x32_bf16 v[232:235], a[184:187], v[52:55], v[232:235]
  ds_read_b64_tr_b16 a[184:185], v11 offset:0
  ds_read_b64_tr_b16 a[186:187], v11 offset:4096
  v_cvt_pk_bf16_f32 v100, v240, v241
  v_cvt_pk_bf16_f32 v101, v242, v243
  v_cvt_pk_bf16_f32 v102, v244, v245
  v_cvt_pk_bf16_f32 v103, v246, v247
  v_lshlrev_b32 v240, 16, v104
  v_and_b32 v241, s46, v104
  v_lshlrev_b32 v242, 16, v105
  v_and_b32 v243, s46, v105
  v_mfma_f32_16x16x32_bf16 v[236:239], a[188:191], v[52:55], v[236:239]
  ds_read_b64_tr_b16 a[188:189], v12 offset:0
  ds_read_b64_tr_b16 a[190:191], v12 offset:4096
  v_lshlrev_b32 v244, 16, v106
  v_and_b32 v245, s46, v106
  v_lshlrev_b32 v246, 16, v107
  v_and_b32 v247, s46, v107
  v_pk_mul_f32 v[240:241], v[240:241], s[44:45]
  v_pk_mul_f32 v[242:243], v[242:243], s[44:45]
  v_pk_mul_f32 v[244:245], v[244:245], s[44:45]
  v_pk_mul_f32 v[246:247], v[246:247], s[44:45]
  v_cvt_pk_bf16_f32 v104, v240, v241
  v_cvt_pk_bf16_f32 v105, v242, v243
  v_cvt_pk_bf16_f32 v106, v244, v245
  v_cvt_pk_bf16_f32 v107, v246, v247
  v_lshlrev_b32 v240, 16, v108
  v_and_b32 v241, s46, v108
  v_mfma_f32_16x16x32_bf16 a[212:215], a[216:219], v[52:55], a[212:215]
  v_lshlrev_b32 v242, 16, v109
  v_and_b32 v243, s46, v109
  v_lshlrev_b32 v244, 16, v110
  v_and_b32 v245, s46, v110
  v_lshlrev_b32 v246, 16, v111
  v_and_b32 v247, s46, v111
  v_pk_mul_f32 v[240:241], v[240:241], s[44:45]
  v_pk_mul_f32 v[242:243], v[242:243], s[44:45]
  v_pk_mul_f32 v[244:245], v[244:245], s[44:45]
  v_pk_mul_f32 v[246:247], v[246:247], s[44:45]
  v_cvt_pk_bf16_f32 v108, v240, v241
  v_cvt_pk_bf16_f32 v109, v242, v243
  v_cvt_pk_bf16_f32 v110, v244, v245
  v_cvt_pk_bf16_f32 v111, v246, v247
  s_waitcnt lgkmcnt(15)
  v_mfma_f32_16x16x32_bf16 v[32:35], a[128:131], v[80:83], 0
  s_waitcnt vmcnt(17)
  s_add_u32 s48, s65, 0
  v_add_u32 v240, s48, v1
  v_add_u32 v241, s48, v2
  v_add_u32 v242, s48, v3
  v_add_u32 v243, s48, v4
  ds_read_b128 v[112:115], v240 offset:0
  ds_read_b128 v[116:119], v241 offset:0
  ds_read_b128 v[120:123], v242 offset:0
  v_mfma_f32_16x16x32_bf16 v[32:35], a[132:135], v[84:87], v[32:35]
  ds_read_b128 v[124:127], v243 offset:0
  ds_read_b128 v[128:131], v240 offset:4096
  ds_read_b128 v[132:135], v241 offset:4096
  ds_read_b128 v[136:139], v242 offset:4096
  ds_read_b128 v[140:143], v243 offset:4096
  s_waitcnt lgkmcnt(4)
  v_lshlrev_b32 v240, 16, v112
  v_and_b32 v241, s46, v112
  v_lshlrev_b32 v242, 16, v113
  v_mfma_f32_16x16x32_bf16 v[32:35], a[136:139], v[88:91], v[32:35]
  v_and_b32 v243, s46, v113
  v_lshlrev_b32 v244, 16, v114
  v_and_b32 v245, s46, v114
  v_lshlrev_b32 v246, 16, v115
  v_and_b32 v247, s46, v115
  v_pk_mul_f32 v[240:241], v[240:241], s[44:45]
  v_pk_mul_f32 v[242:243], v[242:243], s[44:45]
  v_pk_mul_f32 v[244:245], v[244:245], s[44:45]
  v_pk_mul_f32 v[246:247], v[246:247], s[44:45]
  v_mfma_f32_16x16x32_bf16 v[32:35], a[140:143], v[92:95], v[32:35]
  v_cvt_pk_bf16_f32 v112, v240, v241
  v_cvt_pk_bf16_f32 v113, v242, v243
  v_cvt_pk_bf16_f32 v114, v244, v245
  v_cvt_pk_bf16_f32 v115, v246, v247
  v_lshlrev_b32 v240, 16, v116
  v_and_b32 v241, s46, v116
  v_lshlrev_b32 v242, 16, v117
  v_and_b32 v243, s46, v117
  v_lshlrev_b32 v244, 16, v118
  v_mfma_f32_16x16x32_bf16 v[36:39], a[144:147], v[80:83], 0
  v_and_b32 v245, s46, v118
  v_lshlrev_b32 v246, 16, v119
  v_and_b32 v247, s46, v119
  v_pk_mul_f32 v[240:241], v[240:241], s[44:45]
  v_pk_mul_f32 v[242:243], v[242:243], s[44:45]
  v_pk_mul_f32 v[244:245], v[244:245], s[44:45]
  v_pk_mul_f32 v[246:247], v[246:247], s[44:45]
  v_cvt_pk_bf16_f32 v116, v240, v241
  v_cvt_pk_bf16_f32 v117, v242, v243
  v_mfma_f32_16x16x32_bf16 v[36:39], a[148:151], v[84:87], v[36:39]
  v_cvt_pk_bf16_f32 v118, v244, v245
  v_cvt_pk_bf16_f32 v119, v246, v247
  v_lshlrev_b32 v240, 16, v120
  v_and_b32 v241, s46, v120
  v_lshlrev_b32 v242, 16, v121
  v_and_b32 v243, s46, v121
  v_lshlrev_b32 v244, 16, v122
  v_and_b32 v245, s46, v122
  v_lshlrev_b32 v246, 16, v123
  v_and_b32 v247, s46, v123
  v_pk_mul_f32 v[240:241], v[240:241], s[44:45]
  v_pk_mul_f32 v[242:243], v[242:243], s[44:45]
  v_pk_mul_f32 v[244:245], v[244:245], s[44:45]
  v_pk_mul_f32 v[246:247], v[246:247], s[44:45]
  v_mfma_f32_16x16x32_bf16 v[36:39], a[152:155], v[88:91], v[36:39]
  v_cvt_pk_bf16_f32 v120, v240, v241
  v_cvt_pk_bf16_f32 v121, v242, v243
  v_cvt_pk_bf16_f32 v122, v244, v245
  v_cvt_pk_bf16_f32 v123, v246, v247
  v_mfma_f32_16x16x32_bf16 v[36:39], a[156:159], v[92:95], v[36:39]
  v_lshlrev_b32 v240, 16, v124
  v_and_b32 v241, s46, v124
  v_lshlrev_b32 v242, 16, v125
  v_and_b32 v243, s46, v125
  v_lshlrev_b32 v244, 16, v126
  v_and_b32 v245, s46, v126
  v_lshlrev_b32 v246, 16, v127
  v_and_b32 v247, s46, v127
  v_pk_mul_f32 v[240:241], v[240:241], s[44:45]
  v_pk_mul_f32 v[242:243], v[242:243], s[44:45]
  v_pk_mul_f32 v[244:245], v[244:245], s[44:45]
  v_pk_mul_f32 v[246:247], v[246:247], s[44:45]
  v_mfma_f32_16x16x32_bf16 v[248:251], a[128:131], v[96:99], 0
  v_cvt_pk_bf16_f32 v124, v240, v241
  v_cvt_pk_bf16_f32 v125, v242, v243
  v_cvt_pk_bf16_f32 v126, v244, v245
  v_cvt_pk_bf16_f32 v127, v246, v247
  s_waitcnt lgkmcnt(0)
  v_lshlrev_b32 v240, 16, v128
  v_mfma_f32_16x16x32_bf16 v[248:251], a[132:135], v[100:103], v[248:251]
  v_and_b32 v241, s46, v128
  v_lshlrev_b32 v242, 16, v129
  v_and_b32 v243, s46, v129
  v_lshlrev_b32 v244, 16, v130
  v_and_b32 v245, s46, v130
  v_lshlrev_b32 v246, 16, v131
  v_and_b32 v247, s46, v131
  v_pk_mul_f32 v[240:241], v[240:241], s[44:45]
  v_pk_mul_f32 v[242:243], v[242:243], s[44:45]
  v_pk_mul_f32 v[244:245], v[244:245], s[44:45]
  v_pk_mul_f32 v[246:247], v[246:247], s[44:45]
  v_mfma_f32_16x16x32_bf16 v[248:251], a[136:139], v[104:107], v[248:251]
  v_cvt_pk_bf16_f32 v128, v240, v241
  v_cvt_pk_bf16_f32 v129, v242, v243
  v_cvt_pk_bf16_f32 v130, v244, v245
  v_cvt_pk_bf16_f32 v131, v246, v247
  v_lshlrev_b32 v240, 16, v132
  v_and_b32 v241, s46, v132
  v_lshlrev_b32 v242, 16, v133
  v_mfma_f32_16x16x32_bf16 v[248:251], a[140:143], v[108:111], v[248:251]
  v_and_b32 v243, s46, v133
  v_lshlrev_b32 v244, 16, v134
  v_and_b32 v245, s46, v134
  v_lshlrev_b32 v246, 16, v135
  v_and_b32 v247, s46, v135
  v_pk_mul_f32 v[240:241], v[240:241], s[44:45]
  v_pk_mul_f32 v[242:243], v[242:243], s[44:45]
  v_pk_mul_f32 v[244:245], v[244:245], s[44:45]
  v_pk_mul_f32 v[246:247], v[246:247], s[44:45]
  v_mfma_f32_16x16x32_bf16 v[252:255], a[144:147], v[96:99], 0
  v_cvt_pk_bf16_f32 v132, v240, v241
  v_cvt_pk_bf16_f32 v133, v242, v243
  v_cvt_pk_bf16_f32 v134, v244, v245
  v_cvt_pk_bf16_f32 v135, v246, v247
  v_lshlrev_b32 v240, 16, v136
  v_and_b32 v241, s46, v136
  v_lshlrev_b32 v242, 16, v137
  v_and_b32 v243, s46, v137
  v_lshlrev_b32 v244, 16, v138
  v_mfma_f32_16x16x32_bf16 v[252:255], a[148:151], v[100:103], v[252:255]
  v_and_b32 v245, s46, v138
  v_lshlrev_b32 v246, 16, v139
  v_and_b32 v247, s46, v139
  v_pk_mul_f32 v[240:241], v[240:241], s[44:45]
  v_pk_mul_f32 v[242:243], v[242:243], s[44:45]
  v_pk_mul_f32 v[244:245], v[244:245], s[44:45]
  v_pk_mul_f32 v[246:247], v[246:247], s[44:45]
  v_cvt_pk_bf16_f32 v136, v240, v241
  v_cvt_pk_bf16_f32 v137, v242, v243
  v_mfma_f32_16x16x32_bf16 v[252:255], a[152:155], v[104:107], v[252:255]
  v_cvt_pk_bf16_f32 v138, v244, v245
  v_cvt_pk_bf16_f32 v139, v246, v247
  v_lshlrev_b32 v240, 16, v140
  v_and_b32 v241, s46, v140
  v_lshlrev_b32 v242, 16, v141
  v_and_b32 v243, s46, v141
  v_lshlrev_b32 v244, 16, v142
  v_and_b32 v245, s46, v142
  v_lshlrev_b32 v246, 16, v143
  v_and_b32 v247, s46, v143
  v_pk_mul_f32 v[240:241], v[240:241], s[44:45]
  v_pk_mul_f32 v[242:243], v[242:243], s[44:45]
  v_pk_mul_f32 v[244:245], v[244:245], s[44:45]
  v_pk_mul_f32 v[246:247], v[246:247], s[44:45]
  v_mfma_f32_16x16x32_bf16 v[252:255], a[156:159], v[108:111], v[252:255]
  v_cvt_pk_bf16_f32 v140, v240, v241
  v_cvt_pk_bf16_f32 v141, v242, v243
  v_cvt_pk_bf16_f32 v142, v244, v245
  v_cvt_pk_bf16_f32 v143, v246, v247
  v_mfma_f32_16x16x32_bf16 v[40:43], a[128:131], v[112:115], 0
  v_max3_f32 v59, v32, v33, v59
  v_max3_f32 v59, v34, v35, v59
  v_max3_f32 v59, v36, v37, v59
  v_max3_f32 v59, v38, v39, v59
  v_mov_b32 v22, v59
  s_nop 1
  v_permlane32_swap_b32 v22, v59
  v_max_f32 v59, v22, v59
  v_mov_b32 v22, v59
  s_nop 1
  v_permlane16_swap_b32 v22, v59
  v_max_f32 v22, v22, v59
  v_sub_f32 v32, v32, v22
  v_mfma_f32_16x16x32_bf16 v[40:43], a[132:135], v[116:119], v[40:43]
  v_sub_f32 v33, v33, v22
  v_sub_f32 v34, v34, v22
  v_sub_f32 v35, v35, v22
  v_sub_f32 v36, v36, v22
  v_sub_f32 v37, v37, v22
  v_sub_f32 v38, v38, v22
  v_sub_f32 v39, v39, v22
  v_sub_f32 v56, 0, v22
  v_sub_f32 v57, 0, v22
  v_sub_f32 v58, 0, v22
  v_mfma_f32_16x16x32_bf16 v[40:43], a[136:139], v[120:123], v[40:43]
  v_sub_f32 v59, 0, v22
  v_exp_f32 v32, v32
  v_exp_f32 v33, v33
  v_exp_f32 v34, v34
  v_cvt_pk_bf16_f32 v48, v32, v33
  v_exp_f32 v35, v35
  v_exp_f32 v36, v36
  v_mfma_f32_16x16x32_bf16 v[40:43], a[140:143], v[124:127], v[40:43]
  v_cvt_pk_bf16_f32 v49, v34, v35
  v_exp_f32 v37, v37
  v_exp_f32 v38, v38
  v_cvt_pk_bf16_f32 v50, v36, v37
  v_exp_f32 v39, v39
  s_nop 0
  v_cvt_pk_bf16_f32 v51, v38, v39
  v_mfma_f32_16x16x32_bf16 v[44:47], a[144:147], v[112:115], 0
  v_max3_f32 v63, v248, v249, v63
  v_max3_f32 v63, v250, v251, v63
  v_max3_f32 v63, v252, v253, v63
  v_max3_f32 v63, v254, v255, v63
  v_mov_b32 v23, v63
  s_nop 1
  v_permlane32_swap_b32 v23, v63
  v_max_f32 v63, v23, v63
  v_mov_b32 v23, v63
  s_nop 1
  v_permlane16_swap_b32 v23, v63
  v_max_f32 v23, v23, v63
  v_sub_f32 v248, v248, v23
  v_mfma_f32_16x16x32_bf16 v[44:47], a[148:151], v[116:119], v[44:47]
  v_sub_f32 v249, v249, v23
  v_sub_f32 v250, v250, v23
  v_sub_f32 v251, v251, v23
  v_sub_f32 v252, v252, v23
  v_sub_f32 v253, v253, v23
  v_sub_f32 v254, v254, v23
  v_sub_f32 v255, v255, v23
  v_sub_f32 v60, 0, v23
  v_sub_f32 v61, 0, v23
  v_sub_f32 v62, 0, v23
  v_mfma_f32_16x16x32_bf16 v[44:47], a[152:155], v[120:123], v[44:47]
  v_sub_f32 v63, 0, v23
  v_exp_f32 v248, v248
  v_exp_f32 v249, v249
  v_exp_f32 v250, v250
  v_cvt_pk_bf16_f32 v52, v248, v249
  v_exp_f32 v251, v251
  v_exp_f32 v252, v252
  v_mfma_f32_16x16x32_bf16 v[44:47], a[156:159], v[124:127], v[44:47]
  v_cvt_pk_bf16_f32 v53, v250, v251
  v_exp_f32 v253, v253
  v_exp_f32 v254, v254
  v_cvt_pk_bf16_f32 v54, v252, v253
  v_exp_f32 v255, v255
  s_nop 0
  v_cvt_pk_bf16_f32 v55, v254, v255
L_epi0:
  v_accvgpr_read_b32 v23, a192
  v_rcp_f32 v22, v23
  v_mov_b32 v21, v23
  v_accvgpr_read_b32 v23, a254
  v_accvgpr_read_b32 v240, a0
  v_accvgpr_read_b32 v241, a1
  v_accvgpr_read_b32 v242, a2
  v_accvgpr_read_b32 v243, a3
  v_accvgpr_read_b32 v244, a4
  v_accvgpr_read_b32 v245, a5
  v_accvgpr_read_b32 v246, a6
  v_accvgpr_read_b32 v247, a7
  v_pk_mul_f32 v[240:241], v[240:241], v[22:23] op_sel_hi:[1,0]
  v_pk_mul_f32 v[242:243], v[242:243], v[22:23] op_sel_hi:[1,0]
  v_pk_mul_f32 v[244:245], v[244:245], v[22:23] op_sel_hi:[1,0]
  v_pk_mul_f32 v[246:247], v[246:247], v[22:23] op_sel_hi:[1,0]
  v_cvt_pk_bf16_f32 v24, v240, v241
  v_cvt_pk_bf16_f32 v25, v242, v243
  v_cvt_pk_bf16_f32 v26, v244, v245
  v_cvt_pk_bf16_f32 v27, v246, v247
  ds_write_b64 v23, v[24:25] offset:0
  v_xor_b32 v23, 32, v23
  ds_write_b64 v23, v[26:27] offset:0
  v_xor_b32 v23, 96, v23
  v_accvgpr_read_b32 v240, a8
  v_accvgpr_read_b32 v241, a9
  v_accvgpr_read_b32 v242, a10
  v_accvgpr_read_b32 v243, a11
  v_accvgpr_read_b32 v244, a12
  v_accvgpr_read_b32 v245, a13
  v_accvgpr_read_b32 v246, a14
  v_accvgpr_read_b32 v247, a15
  v_pk_mul_f32 v[240:241], v[240:241], v[22:23] op_sel_hi:[1,0]
  v_pk_mul_f32 v[242:243], v[242:243], v[22:23] op_sel_hi:[1,0]
  v_pk_mul_f32 v[244:245], v[244:245], v[22:23] op_sel_hi:[1,0]
  v_pk_mul_f32 v[246:247], v[246:247], v[22:23] op_sel_hi:[1,0]
  v_cvt_pk_bf16_f32 v28, v240, v241
  v_cvt_pk_bf16_f32 v29, v242, v243
  v_cvt_pk_bf16_f32 v30, v244, v245
  v_cvt_pk_bf16_f32 v31, v246, v247
  ds_write_b64 v23, v[28:29] offset:0
  v_xor_b32 v23, 32, v23
  ds_write_b64 v23, v[30:31] offset:0
  v_xor_b32 v23, 224, v23
  v_accvgpr_read_b32 v240, a16
  v_accvgpr_read_b32 v241, a17
  v_accvgpr_read_b32 v242, a18
  v_accvgpr_read_b32 v243, a19
  v_accvgpr_read_b32 v244, a20
  v_accvgpr_read_b32 v245, a21
  v_accvgpr_read_b32 v246, a22
  v_accvgpr_read_b32 v247, a23
  v_pk_mul_f32 v[240:241], v[240:241], v[22:23] op_sel_hi:[1,0]
  v_pk_mul_f32 v[242:243], v[242:243], v[22:23] op_sel_hi:[1,0]
  v_pk_mul_f32 v[244:245], v[244:245], v[22:23] op_sel_hi:[1,0]
  v_pk_mul_f32 v[246:247], v[246:247], v[22:23] op_sel_hi:[1,0]
  v_cvt_pk_bf16_f32 v24, v240, v241
  v_cvt_pk_bf16_f32 v25, v242, v243
  v_cvt_pk_bf16_f32 v26, v244, v245
  v_cvt_pk_bf16_f32 v27, v246, v247
  ds_write_b64 v23, v[24:25] offset:0
  v_xor_b32 v23, 32, v23
  ds_write_b64 v23, v[26:27] offset:0
  v_xor_b32 v23, 96, v23
  v_accvgpr_read_b32 v240, a24
  v_accvgpr_read_b32 v241, a25
  v_accvgpr_read_b32 v242, a26
  v_accvgpr_read_b32 v243, a27
  v_accvgpr_read_b32 v244, a28
  v_accvgpr_read_b32 v245, a29
  v_accvgpr_read_b32 v246, a30
  v_accvgpr_read_b32 v247, a31
  v_pk_mul_f32 v[240:241], v[240:241], v[22:23] op_sel_hi:[1,0]
  v_pk_mul_f32 v[242:243], v[242:243], v[22:23] op_sel_hi:[1,0]
  v_pk_mul_f32 v[244:245], v[244:245], v[22:23] op_sel_hi:[1,0]
  v_pk_mul_f32 v[246:247], v[246:247], v[22:23] op_sel_hi:[1,0]
  v_cvt_pk_bf16_f32 v28, v240, v241
  v_cvt_pk_bf16_f32 v29, v242, v243
  v_cvt_pk_bf16_f32 v30, v244, v245
  v_cvt_pk_bf16_f32 v31, v246, v247
  ds_write_b64 v23, v[28:29] offset:0
  v_xor_b32 v23, 32, v23
  ds_write_b64 v23, v[30:31] offset:0
  v_accvgpr_read_b32 v23, a255
  ds_read_b128 a[0:3], v23 offset:0
  v_xor_b32 v23, 64, v23
  ds_read_b128 a[4:7], v23 offset:1024
  v_xor_b32 v23, 192, v23
  ds_read_b128 a[8:11], v23 offset:2048
  v_xor_b32 v23, 64, v23
  ds_read_b128 a[12:15], v23 offset:3072
  v_accvgpr_read_b32 v23, a196
  v_rcp_f32 v22, v23
  v_add_f32 v21, v21, v23
  v_accvgpr_read_b32 v23, a254
  v_accvgpr_read_b32 v240, a32
  v_accvgpr_read_b32 v241, a33
  v_accvgpr_read_b32 v242, a34
  v_accvgpr_read_b32 v243, a35
  v_accvgpr_read_b32 v244, a36
  v_accvgpr_read_b32 v245, a37
  v_accvgpr_read_b32 v246, a38
  v_accvgpr_read_b32 v247, a39
  v_pk_mul_f32 v[240:241], v[240:241], v[22:23] op_sel_hi:[1,0]
  v_pk_mul_f32 v[242:243], v[242:243], v[22:23] op_sel_hi:[1,0]
  v_pk_mul_f32 v[244:245], v[244:245], v[22:23] op_sel_hi:[1,0]
  v_pk_mul_f32 v[246:247], v[246:247], v[22:23] op_sel_hi:[1,0]
  v_cvt_pk_bf16_f32 v24, v240, v241
  v_cvt_pk_bf16_f32 v25, v242, v243
  v_cvt_pk_bf16_f32 v26, v244, v245
  v_cvt_pk_bf16_f32 v27, v246, v247
  ds_write_b64 v23, v[24:25] offset:4096
  v_xor_b32 v23, 32, v23
  ds_write_b64 v23, v[26:27] offset:4096
  v_xor_b32 v23, 96, v23
  v_accvgpr_read_b32 v240, a40
  v_accvgpr_read_b32 v241, a41
  v_accvgpr_read_b32 v242, a42
  v_accvgpr_read_b32 v243, a43
  v_accvgpr_read_b32 v244, a44
  v_accvgpr_read_b32 v245, a45
  v_accvgpr_read_b32 v246, a46
  v_accvgpr_read_b32 v247, a47
  v_pk_mul_f32 v[240:241], v[240:241], v[22:23] op_sel_hi:[1,0]
  v_pk_mul_f32 v[242:243], v[242:243], v[22:23] op_sel_hi:[1,0]
  v_pk_mul_f32 v[244:245], v[244:245], v[22:23] op_sel_hi:[1,0]
  v_pk_mul_f32 v[246:247], v[246:247], v[22:23] op_sel_hi:[1,0]
  v_cvt_pk_bf16_f32 v28, v240, v241
  v_cvt_pk_bf16_f32 v29, v242, v243
  v_cvt_pk_bf16_f32 v30, v244, v245
  v_cvt_pk_bf16_f32 v31, v246, v247
  ds_write_b64 v23, v[28:29] offset:4096
  v_xor_b32 v23, 32, v23
  ds_write_b64 v23, v[30:31] offset:4096
  v_xor_b32 v23, 224, v23
  v_accvgpr_read_b32 v240, a48
  v_accvgpr_read_b32 v241, a49
  v_accvgpr_read_b32 v242, a50
  v_accvgpr_read_b32 v243, a51
  v_accvgpr_read_b32 v244, a52
  v_accvgpr_read_b32 v245, a53
  v_accvgpr_read_b32 v246, a54
  v_accvgpr_read_b32 v247, a55
  v_pk_mul_f32 v[240:241], v[240:241], v[22:23] op_sel_hi:[1,0]
  v_pk_mul_f32 v[242:243], v[242:243], v[22:23] op_sel_hi:[1,0]
  v_pk_mul_f32 v[244:245], v[244:245], v[22:23] op_sel_hi:[1,0]
  v_pk_mul_f32 v[246:247], v[246:247], v[22:23] op_sel_hi:[1,0]
  v_cvt_pk_bf16_f32 v24, v240, v241
  v_cvt_pk_bf16_f32 v25, v242, v243
  v_cvt_pk_bf16_f32 v26, v244, v245
  v_cvt_pk_bf16_f32 v27, v246, v247
  ds_write_b64 v23, v[24:25] offset:4096
  v_xor_b32 v23, 32, v23
  ds_write_b64 v23, v[26:27] offset:4096
  v_xor_b32 v23, 96, v23
  v_accvgpr_read_b32 v240, a56
  v_accvgpr_read_b32 v241, a57
  v_accvgpr_read_b32 v242, a58
  v_accvgpr_read_b32 v243, a59
  v_accvgpr_read_b32 v244, a60
  v_accvgpr_read_b32 v245, a61
  v_accvgpr_read_b32 v246, a62
  v_accvgpr_read_b32 v247, a63
  v_pk_mul_f32 v[240:241], v[240:241], v[22:23] op_sel_hi:[1,0]
  v_pk_mul_f32 v[242:243], v[242:243], v[22:23] op_sel_hi:[1,0]
  v_pk_mul_f32 v[244:245], v[244:245], v[22:23] op_sel_hi:[1,0]
  v_pk_mul_f32 v[246:247], v[246:247], v[22:23] op_sel_hi:[1,0]
  v_cvt_pk_bf16_f32 v28, v240, v241
  v_cvt_pk_bf16_f32 v29, v242, v243
  v_cvt_pk_bf16_f32 v30, v244, v245
  v_cvt_pk_bf16_f32 v31, v246, v247
  ds_write_b64 v23, v[28:29] offset:4096
  v_xor_b32 v23, 32, v23
  ds_write_b64 v23, v[30:31] offset:4096
  v_accvgpr_read_b32 v23, a255
  ds_read_b128 a[32:35], v23 offset:4096
  v_xor_b32 v23, 64, v23
  ds_read_b128 a[36:39], v23 offset:5120
  v_xor_b32 v23, 192, v23
  ds_read_b128 a[40:43], v23 offset:6144
  v_xor_b32 v23, 64, v23
  ds_read_b128 a[44:47], v23 offset:7168
  s_add_u32 s64, s51, 0
  s_waitcnt lgkmcnt(12)
  buffer_store_dwordx4 a[0:3], v20, s[20:23], s64 offen offset:0 nt
  buffer_store_dwordx4 a[4:7], v20, s[20:23], s64 offen offset:1024 nt
  buffer_store_dwordx4 a[8:11], v20, s[20:23], s64 offen offset:2048 nt
  buffer_store_dwordx4 a[12:15], v20, s[20:23], s64 offen offset:3072 nt
  s_cmp_lg_u32 s68, 0
  s_cbranch_scc1 L_epi1
L_epx0:
  s_waitcnt lgkmcnt(15)
  v_mfma_f32_16x16x32_bf16 v[32:35], a[128:131], v[128:131], 0
  s_waitcnt vmcnt(8)
  s_add_u32 s48, s25, 114688
  v_add_u32 v240, s48, v1
  v_add_u32 v241, s48, v2
  v_add_u32 v242, s48, v3
  v_add_u32 v243, s48, v4
  v_mfma_f32_16x16x32_bf16 v[32:35], a[132:135], v[132:135], v[32:35]
  ds_read_b128 v[144:147], v240 offset:0
  ds_read_b128 v[148:151], v241 offset:0
  ds_read_b128 v[152:155], v242 offset:0
  ds_read_b128 v[156:159], v243 offset:0
  v_max3_f32 v67, v40, v41, v67
  v_max3_f32 v67, v42, v43, v67
  v_mfma_f32_16x16x32_bf16 v[32:35], a[136:139], v[136:139], v[32:35]
  v_max3_f32 v67, v44, v45, v67
  v_max3_f32 v67, v46, v47, v67
  v_mov_b32 v22, v67
  s_nop 1
  v_permlane32_swap_b32 v22, v67
  v_max_f32 v67, v22, v67
  v_mov_b32 v22, v67
  v_mfma_f32_16x16x32_bf16 v[32:35], a[140:143], v[140:143], v[32:35]
  s_nop 0
  v_permlane16_swap_b32 v22, v67
  v_max_f32 v22, v22, v67
  v_sub_f32 v40, v40, v22
  v_sub_f32 v41, v41, v22
  v_sub_f32 v42, v42, v22
  v_mfma_f32_16x16x32_bf16 v[36:39], a[144:147], v[128:131], 0
  v_sub_f32 v43, v43, v22
  v_sub_f32 v44, v44, v22
  v_sub_f32 v45, v45, v22
  v_sub_f32 v46, v46, v22
  v_sub_f32 v47, v47, v22
  v_sub_f32 v64, 0, v22
  v_mfma_f32_16x16x32_bf16 v[36:39], a[148:151], v[132:135], v[36:39]
  v_sub_f32 v65, 0, v22
  v_sub_f32 v66, 0, v22
  v_sub_f32 v67, 0, v22
  s_waitcnt lgkmcnt(0)
  v_lshlrev_b32 v240, 16, v144
  v_and_b32 v241, s46, v144
  v_mfma_f32_16x16x32_bf16 v[36:39], a[152:155], v[136:139], v[36:39]
  v_lshlrev_b32 v242, 16, v145
  v_and_b32 v243, s46, v145
  v_lshlrev_b32 v244, 16, v146
  v_and_b32 v245, s46, v146
  v_lshlrev_b32 v246, 16, v147
  v_and_b32 v247, s46, v147
  v_pk_mul_f32 v[240:241], v[240:241], s[44:45]
  v_pk_mul_f32 v[242:243], v[242:243], s[44:45]
  v_pk_mul_f32 v[244:245], v[244:245], s[44:45]
  v_pk_mul_f32 v[246:247], v[246:247], s[44:45]
  v_mfma_f32_16x16x32_bf16 v[36:39], a[156:159], v[140:143], v[36:39]
  v_cvt_pk_bf16_f32 v144, v240, v241
  v_mfma_f32_16x16x32_bf16 a[0:3], a[160:163], v[48:51], 0
  v_cvt_pk_bf16_f32 v145, v242, v243
  v_cvt_pk_bf16_f32 v146, v244, v245
  v_cvt_pk_bf16_f32 v147, v246, v247
  v_lshlrev_b32 v240, 16, v148
  v_and_b32 v241, s46, v148
  v_lshlrev_b32 v242, 16, v149
  v_mfma_f32_16x16x32_bf16 a[4:7], a[164:167], v[48:51], 0
  v_and_b32 v243, s46, v149
  v_lshlrev_b32 v244, 16, v150
  v_and_b32 v245, s46, v150
  v_lshlrev_b32 v246, 16, v151
  v_and_b32 v247, s46, v151
  v_pk_mul_f32 v[240:241], v[240:241], s[44:45]
  v_pk_mul_f32 v[242:243], v[242:243], s[44:45]
  v_pk_mul_f32 v[244:245], v[244:245], s[44:45]
  v_pk_mul_f32 v[246:247], v[246:247], s[44:45]
  v_mfma_f32_16x16x32_bf16 a[8:11], a[168:171], v[48:51], 0
  v_cvt_pk_bf16_f32 v148, v240, v241
  v_cvt_pk_bf16_f32 v149, v242, v243
  v_mfma_f32_16x16x32_bf16 a[12:15], a[172:175], v[48:51], 0
  v_cvt_pk_bf16_f32 v150, v244, v245
  v_cvt_pk_bf16_f32 v151, v246, v247
  v_lshlrev_b32 v240, 16, v152
  v_and_b32 v241, s46, v152
  v_lshlrev_b32 v242, 16, v153
  v_and_b32 v243, s46, v153
  v_mfma_f32_16x16x32_bf16 a[16:19], a[176:179], v[48:51], 0
  v_lshlrev_b32 v244, 16, v154
  v_and_b32 v245, s46, v154
  v_lshlrev_b32 v246, 16, v155
  v_and_b32 v247, s46, v155
  v_pk_mul_f32 v[240:241], v[240:241], s[44:45]
  v_pk_mul_f32 v[242:243], v[242:243], s[44:45]
  v_pk_mul_f32 v[244:245], v[244:245], s[44:45]
  v_pk_mul_f32 v[246:247], v[246:247], s[44:45]
  v_mfma_f32_16x16x32_bf16 a[20:23], a[180:183], v[48:51], 0
  v_cvt_pk_bf16_f32 v152, v240, v241
  v_cvt_pk_bf16_f32 v153, v242, v243
  v_cvt_pk_bf16_f32 v154, v244, v245
  v_mfma_f32_16x16x32_bf16 a[24:27], a[184:187], v[48:51], 0
  v_cvt_pk_bf16_f32 v155, v246, v247
  v_lshlrev_b32 v240, 16, v156
  v_and_b32 v241, s46, v156
  v_lshlrev_b32 v242, 16, v157
  v_and_b32 v243, s46, v157
  v_lshlrev_b32 v244, 16, v158
  v_mfma_f32_16x16x32_bf16 a[28:31], a[188:191], v[48:51], 0
  v_and_b32 v245, s46, v158
  v_lshlrev_b32 v246, 16, v159
  v_and_b32 v247, s46, v159
  v_pk_mul_f32 v[240:241], v[240:241], s[44:45]
  v_pk_mul_f32 v[242:243], v[242:243], s[44:45]
  v_pk_mul_f32 v[244:245], v[244:245], s[44:45]
  v_pk_mul_f32 v[246:247], v[246:247], s[44:45]
  v_mfma_f32_16x16x32_bf16 a[192:195], a[216:219], v[48:51], 0
  v_cvt_pk_bf16_f32 v156, v240, v241
  v_cvt_pk_bf16_f32 v157, v242, v243
  v_cvt_pk_bf16_f32 v158, v244, v245
  v_cvt_pk_bf16_f32 v159, v246, v247
L_epi1:
  v_accvgpr_read_b32 v23, a200
  v_rcp_f32 v22, v23
  v_add_f32 v21, v21, v23
  v_accvgpr_read_b32 v23, a254
  v_accvgpr_read_b32 v240, a64
  v_accvgpr_read_b32 v241, a65
  v_accvgpr_read_b32 v242, a66
  v_accvgpr_read_b32 v243, a67
  v_accvgpr_read_b32 v244, a68
  v_accvgpr_read_b32 v245, a69
  v_accvgpr_read_b32 v246, a70
  v_accvgpr_read_b32 v247, a71
  v_pk_mul_f32 v[240:241], v[240:241], v[22:23] op_sel_hi:[1,0]
  v_pk_mul_f32 v[242:243], v[242:243], v[22:23] op_sel_hi:[1,0]
  v_pk_mul_f32 v[244:245], v[244:245], v[22:23] op_sel_hi:[1,0]
  v_pk_mul_f32 v[246:247], v[246:247], v[22:23] op_sel_hi:[1,0]
  v_cvt_pk_bf16_f32 v24, v240, v241
  v_cvt_pk_bf16_f32 v25, v242, v243
  v_cvt_pk_bf16_f32 v26, v244, v245
  v_cvt_pk_bf16_f32 v27, v246, v247
  ds_write_b64 v23, v[24:25] offset:0
  v_xor_b32 v23, 32, v23
  ds_write_b64 v23, v[26:27] offset:0
  v_xor_b32 v23, 96, v23
  v_accvgpr_read_b32 v240, a72
  v_accvgpr_read_b32 v241, a73
  v_accvgpr_read_b32 v242, a74
  v_accvgpr_read_b32 v243, a75
  v_accvgpr_read_b32 v244, a76
  v_accvgpr_read_b32 v245, a77
  v_accvgpr_read_b32 v246, a78
  v_accvgpr_read_b32 v247, a79
  v_pk_mul_f32 v[240:241], v[240:241], v[22:23] op_sel_hi:[1,0]
  v_pk_mul_f32 v[242:243], v[242:243], v[22:23] op_sel_hi:[1,0]
  v_pk_mul_f32 v[244:245], v[244:245], v[22:23] op_sel_hi:[1,0]
  v_pk_mul_f32 v[246:247], v[246:247], v[22:23] op_sel_hi:[1,0]
  v_cvt_pk_bf16_f32 v28, v240, v241
  v_cvt_pk_bf16_f32 v29, v242, v243
  v_cvt_pk_bf16_f32 v30, v244, v245
  v_cvt_pk_bf16_f32 v31, v246, v247
  ds_write_b64 v23, v[28:29] offset:0
  v_xor_b32 v23, 32, v23
  ds_write_b64 v23, v[30:31] offset:0
  v_xor_b32 v23, 224, v23
  v_accvgpr_read_b32 v240, a80
  v_accvgpr_read_b32 v241, a81
  v_accvgpr_read_b32 v242, a82
  v_accvgpr_read_b32 v243, a83
  v_accvgpr_read_b32 v244, a84
  v_accvgpr_read_b32 v245, a85
  v_accvgpr_read_b32 v246, a86
  v_accvgpr_read_b32 v247, a87
  v_pk_mul_f32 v[240:241], v[240:241], v[22:23] op_sel_hi:[1,0]
  v_pk_mul_f32 v[242:243], v[242:243], v[22:23] op_sel_hi:[1,0]
  v_pk_mul_f32 v[244:245], v[244:245], v[22:23] op_sel_hi:[1,0]
  v_pk_mul_f32 v[246:247], v[246:247], v[22:23] op_sel_hi:[1,0]
  v_cvt_pk_bf16_f32 v24, v240, v241
  v_cvt_pk_bf16_f32 v25, v242, v243
  v_cvt_pk_bf16_f32 v26, v244, v245
  v_cvt_pk_bf16_f32 v27, v246, v247
  ds_write_b64 v23, v[24:25] offset:0
  v_xor_b32 v23, 32, v23
  ds_write_b64 v23, v[26:27] offset:0
  v_xor_b32 v23, 96, v23
  v_accvgpr_read_b32 v240, a88
  v_accvgpr_read_b32 v241, a89
  v_accvgpr_read_b32 v242, a90
  v_accvgpr_read_b32 v243, a91
  v_accvgpr_read_b32 v244, a92
  v_accvgpr_read_b32 v245, a93
  v_accvgpr_read_b32 v246, a94
  v_accvgpr_read_b32 v247, a95
  v_pk_mul_f32 v[240:241], v[240:241], v[22:23] op_sel_hi:[1,0]
  v_pk_mul_f32 v[242:243], v[242:243], v[22:23] op_sel_hi:[1,0]
  v_pk_mul_f32 v[244:245], v[244:245], v[22:23] op_sel_hi:[1,0]
  v_pk_mul_f32 v[246:247], v[246:247], v[22:23] op_sel_hi:[1,0]
  v_cvt_pk_bf16_f32 v28, v240, v241
  v_cvt_pk_bf16_f32 v29, v242, v243
  v_cvt_pk_bf16_f32 v30, v244, v245
  v_cvt_pk_bf16_f32 v31, v246, v247
  ds_write_b64 v23, v[28:29] offset:0
  v_xor_b32 v23, 32, v23
  ds_write_b64 v23, v[30:31] offset:0
  v_accvgpr_read_b32 v23, a255
  ds_read_b128 a[64:67], v23 offset:0
  v_xor_b32 v23, 64, v23
  ds_read_b128 a[68:71], v23 offset:1024
  v_xor_b32 v23, 192, v23
  ds_read_b128 a[72:75], v23 offset:2048
  v_xor_b32 v23, 64, v23
  ds_read_b128 a[76:79], v23 offset:3072
  s_add_u32 s64, s51, 4096
  s_waitcnt lgkmcnt(15)
  buffer_store_dwordx4 a[32:35], v20, s[20:23], s64 offen offset:0 nt
  buffer_store_dwordx4 a[36:39], v20, s[20:23], s64 offen offset:1024 nt
  buffer_store_dwordx4 a[40:43], v20, s[20:23], s64 offen offset:2048 nt
  buffer_store_dwordx4 a[44:47], v20, s[20:23], s64 offen offset:3072 nt
  s_cmp_lg_u32 s68, 0
  s_cbranch_scc1 L_epi2
L_epx1:
  v_mfma_f32_16x16x32_bf16 v[248:251], a[128:131], v[144:147], 0
  s_waitcnt vmcnt(8)
  s_add_u32 s48, s25, 49152
  v_add_u32 v240, s48, v1
  v_add_u32 v241, s48, v2
  v_add_u32 v242, s48, v3
  v_add_u32 v243, s48, v4
  ds_read_b128 v[160:163], v240 offset:0
  v_mfma_f32_16x16x32_bf16 v[248:251], a[132:135], v[148:151], v[248:251]
  ds_read_b128 v[164:167], v241 offset:0
  ds_read_b128 v[168:171], v242 offset:0
  ds_read_b128 v[172:175], v243 offset:0
  v_exp_f32 v40, v40
  v_exp_f32 v41, v41
  v_mfma_f32_16x16x32_bf16 v[248:251], a[136:139], v[152:155], v[248:251]
  v_exp_f32 v42, v42
  v_cvt_pk_bf16_f32 v48, v40, v41
  v_exp_f32 v43, v43
  v_exp_f32 v44, v44
  v_mfma_f32_16x16x32_bf16 v[248:251], a[140:143], v[156:159], v[248:251]
  v_cvt_pk_bf16_f32 v49, v42, v43
  v_exp_f32 v45, v45
  v_exp_f32 v46, v46
  v_cvt_pk_bf16_f32 v50, v44, v45
  v_exp_f32 v47, v47
  v_mfma_f32_16x16x32_bf16 v[252:255], a[144:147], v[144:147], 0
  v_cvt_pk_bf16_f32 v51, v46, v47
  s_waitcnt lgkmcnt(0)
  v_lshlrev_b32 v240, 16, v160
  v_and_b32 v241, s46, v160
  v_lshlrev_b32 v242, 16, v161
  v_and_b32 v243, s46, v161
  v_mfma_f32_16x16x32_bf16 v[252:255], a[148:151], v[148:151], v[252:255]
  v_lshlrev_b32 v244, 16, v162
  v_and_b32 v245, s46, v162
  v_lshlrev_b32 v246, 16, v163
  v_and_b32 v247, s46, v163
  v_pk_mul_f32 v[240:241], v[240:241], s[44:45]
  v_pk_mul_f32 v[242:243], v[242:243], s[44:45]
  v_pk_mul_f32 v[244:245], v[244:245], s[44:45]
  v_pk_mul_f32 v[246:247], v[246:247], s[44:45]
  v_mfma_f32_16x16x32_bf16 v[252:255], a[152:155], v[152:155], v[252:255]
  v_cvt_pk_bf16_f32 v160, v240, v241
  v_cvt_pk_bf16_f32 v161, v242, v243
  v_cvt_pk_bf16_f32 v162, v244, v245
  v_cvt_pk_bf16_f32 v163, v246, v247
  v_lshlrev_b32 v240, 16, v164
  v_and_b32 v241, s46, v164
  v_mfma_f32_16x16x32_bf16 v[252:255], a[156:159], v[156:159], v[252:255]
  v_lshlrev_b32 v242, 16, v165
  v_and_b32 v243, s46, v165
  v_lshlrev_b32 v244, 16, v166
  v_and_b32 v245, s46, v166
  v_lshlrev_b32 v246, 16, v167
  v_and_b32 v247, s46, v167
  v_pk_mul_f32 v[240:241], v[240:241], s[44:45]
  v_pk_mul_f32 v[242:243], v[242:243], s[44:45]
  v_pk_mul_f32 v[244:245], v[244:245], s[44:45]
  v_pk_mul_f32 v[246:247], v[246:247], s[44:45]
  v_mfma_f32_16x16x32_bf16 a[32:35], a[160:163], v[52:55], 0
  v_cvt_pk_bf16_f32 v164, v240, v241
  v_cvt_pk_bf16_f32 v165, v242, v243
  v_cvt_pk_bf16_f32 v166, v244, v245
  v_mfma_f32_16x16x32_bf16 a[36:39], a[164:167], v[52:55], 0
  v_cvt_pk_bf16_f32 v167, v246, v247
  v_lshlrev_b32 v240, 16, v168
  v_and_b32 v241, s46, v168
  v_lshlrev_b32 v242, 16, v169
  v_and_b32 v243, s46, v169
  v_lshlrev_b32 v244, 16, v170
  v_and_b32 v245, s46, v170
  v_lshlrev_b32 v246, 16, v171
  v_and_b32 v247, s46, v171
  v_pk_mul_f32 v[240:241], v[240:241], s[44:45]
  v_pk_mul_f32 v[242:243], v[242:243], s[44:45]
  v_pk_mul_f32 v[244:245], v[244:245], s[44:45]
  v_pk_mul_f32 v[246:247], v[246:247], s[44:45]
  v_mfma_f32_16x16x32_bf16 a[40:43], a[168:171], v[52:55], 0
  v_cvt_pk_bf16_f32 v168, v240, v241
  v_mfma_f32_16x16x32_bf16 a[44:47], a[172:175], v[52:55], 0
  v_cvt_pk_bf16_f32 v169, v242, v243
  v_cvt_pk_bf16_f32 v170, v244, v245
  v_cvt_pk_bf16_f32 v171, v246, v247
  v_lshlrev_b32 v240, 16, v172
  v_and_b32 v241, s46, v172
  v_lshlrev_b32 v242, 16, v173
  v_and_b32 v243, s46, v173
  v_mfma_f32_16x16x32_bf16 a[48:51], a[176:179], v[52:55], 0
  v_lshlrev_b32 v244, 16, v174
  v_and_b32 v245, s46, v174
  v_lshlrev_b32 v246, 16, v175
  v_and_b32 v247, s46, v175
  v_pk_mul_f32 v[240:241], v[240:241], s[44:45]
  v_pk_mul_f32 v[242:243], v[242:243], s[44:45]
  v_pk_mul_f32 v[244:245], v[244:245], s[44:45]
  v_pk_mul_f32 v[246:247], v[246:247], s[44:45]
  v_mfma_f32_16x16x32_bf16 a[52:55], a[180:183], v[52:55], 0
  v_cvt_pk_bf16_f32 v172, v240, v241
  v_cvt_pk_bf16_f32 v173, v242, v243
  v_cvt_pk_bf16_f32 v174, v244, v245
  v_cvt_pk_bf16_f32 v175, v246, v247
  v_max3_f32 v71, v32, v33, v71
  v_max3_f32 v71, v34, v35, v71
  v_mfma_f32_16x16x32_bf16 a[56:59], a[184:187], v[52:55], 0
  v_max3_f32 v71, v36, v37, v71
  v_max3_f32 v71, v38, v39, v71
  v_mov_b32 v23, v71
  s_nop 1
  v_permlane32_swap_b32 v23, v71
  v_max_f32 v71, v23, v71
  v_mov_b32 v23, v71
  s_nop 1
  v_permlane16_swap_b32 v23, v71
  v_mfma_f32_16x16x32_bf16 a[60:63], a[188:191], v[52:55], 0
  v_max_f32 v23, v23, v71
  v_sub_f32 v32, v32, v23
  v_sub_f32 v33, v33, v23
  v_sub_f32 v34, v34, v23
  v_sub_f32 v35, v35, v23
  v_sub_f32 v36, v36, v23
  v_sub_f32 v37, v37, v23
  v_mfma_f32_16x16x32_bf16 a[196:199], a[216:219], v[52:55], 0
  v_sub_f32 v38, v38, v23
  v_sub_f32 v39, v39, v23
  v_sub_f32 v68, 0, v23
  v_sub_f32 v69, 0, v23
  v_sub_f32 v70, 0, v23
  v_sub_f32 v71, 0, v23
L_epi2:
  v_accvgpr_read_b32 v23, a204
  v_rcp_f32 v22, v23
  v_add_f32 v21, v21, v23
  v_accvgpr_read_b32 v23, a254
  v_accvgpr_read_b32 v240, a96
  v_accvgpr_read_b32 v241, a97
  v_accvgpr_read_b32 v242, a98
  v_accvgpr_read_b32 v243, a99
  v_accvgpr_read_b32 v244, a100
  v_accvgpr_read_b32 v245, a101
  v_accvgpr_read_b32 v246, a102
  v_accvgpr_read_b32 v247, a103
  v_pk_mul_f32 v[240:241], v[240:241], v[22:23] op_sel_hi:[1,0]
  v_pk_mul_f32 v[242:243], v[242:243], v[22:23] op_sel_hi:[1,0]
  v_pk_mul_f32 v[244:245], v[244:245], v[22:23] op_sel_hi:[1,0]
  v_pk_mul_f32 v[246:247], v[246:247], v[22:23] op_sel_hi:[1,0]
  v_cvt_pk_bf16_f32 v24, v240, v241
  v_cvt_pk_bf16_f32 v25, v242, v243
  v_cvt_pk_bf16_f32 v26, v244, v245
  v_cvt_pk_bf16_f32 v27, v246, v247
  ds_write_b64 v23, v[24:25] offset:4096
  v_xor_b32 v23, 32, v23
  ds_write_b64 v23, v[26:27] offset:4096
  v_xor_b32 v23, 96, v23
  v_accvgpr_read_b32 v240, a104
  v_accvgpr_read_b32 v241, a105
  v_accvgpr_read_b32 v242, a106
  v_accvgpr_read_b32 v243, a107
  v_accvgpr_read_b32 v244, a108
  v_accvgpr_read_b32 v245, a109
  v_accvgpr_read_b32 v246, a110
  v_accvgpr_read_b32 v247, a111
  v_pk_mul_f32 v[240:241], v[240:241], v[22:23] op_sel_hi:[1,0]
  v_pk_mul_f32 v[242:243], v[242:243], v[22:23] op_sel_hi:[1,0]
  v_pk_mul_f32 v[244:245], v[244:245], v[22:23] op_sel_hi:[1,0]
  v_pk_mul_f32 v[246:247], v[246:247], v[22:23] op_sel_hi:[1,0]
  v_cvt_pk_bf16_f32 v28, v240, v241
  v_cvt_pk_bf16_f32 v29, v242, v243
  v_cvt_pk_bf16_f32 v30, v244, v245
  v_cvt_pk_bf16_f32 v31, v246, v247
  ds_write_b64 v23, v[28:29] offset:4096
  v_xor_b32 v23, 32, v23
  ds_write_b64 v23, v[30:31] offset:4096
  v_xor_b32 v23, 224, v23
  v_accvgpr_read_b32 v240, a112
  v_accvgpr_read_b32 v241, a113
  v_accvgpr_read_b32 v242, a114
  v_accvgpr_read_b32 v243, a115
  v_accvgpr_read_b32 v244, a116
  v_accvgpr_read_b32 v245, a117
  v_accvgpr_read_b32 v246, a118
  v_accvgpr_read_b32 v247, a119
  v_pk_mul_f32 v[240:241], v[240:241], v[22:23] op_sel_hi:[1,0]
  v_pk_mul_f32 v[242:243], v[242:243], v[22:23] op_sel_hi:[1,0]
  v_pk_mul_f32 v[244:245], v[244:245], v[22:23] op_sel_hi:[1,0]
  v_pk_mul_f32 v[246:247], v[246:247], v[22:23] op_sel_hi:[1,0]
  v_cvt_pk_bf16_f32 v24, v240, v241
  v_cvt_pk_bf16_f32 v25, v242, v243
  v_cvt_pk_bf16_f32 v26, v244, v245
  v_cvt_pk_bf16_f32 v27, v246, v247
  ds_write_b64 v23, v[24:25] offset:4096
  v_xor_b32 v23, 32, v23
  ds_write_b64 v23, v[26:27] offset:4096
  v_xor_b32 v23, 96, v23
  v_accvgpr_read_b32 v240, a120
  v_accvgpr_read_b32 v241, a121
  v_accvgpr_read_b32 v242, a122
  v_accvgpr_read_b32 v243, a123
  v_accvgpr_read_b32 v244, a124
  v_accvgpr_read_b32 v245, a125
  v_accvgpr_read_b32 v246, a126
  v_accvgpr_read_b32 v247, a127
  v_pk_mul_f32 v[240:241], v[240:241], v[22:23] op_sel_hi:[1,0]
  v_pk_mul_f32 v[242:243], v[242:243], v[22:23] op_sel_hi:[1,0]
  v_pk_mul_f32 v[244:245], v[244:245], v[22:23] op_sel_hi:[1,0]
  v_pk_mul_f32 v[246:247], v[246:247], v[22:23] op_sel_hi:[1,0]
  v_cvt_pk_bf16_f32 v28, v240, v241
  v_cvt_pk_bf16_f32 v29, v242, v243
  v_cvt_pk_bf16_f32 v30, v244, v245
  v_cvt_pk_bf16_f32 v31, v246, v247
  ds_write_b64 v23, v[28:29] offset:4096
  v_xor_b32 v23, 32, v23
  ds_write_b64 v23, v[30:31] offset:4096
  v_accvgpr_read_b32 v23, a255
  ds_read_b128 a[96:99], v23 offset:4096
  v_xor_b32 v23, 64, v23
  ds_read_b128 a[100:103], v23 offset:5120
  v_xor_b32 v23, 192, v23
  ds_read_b128 a[104:107], v23 offset:6144
  v_xor_b32 v23, 64, v23
  ds_read_b128 a[108:111], v23 offset:7168
  s_add_u32 s64, s51, 8192
  s_waitcnt lgkmcnt(12)
  buffer_store_dwordx4 a[64:67], v20, s[20:23], s64 offen offset:0 nt
  buffer_store_dwordx4 a[68:71], v20, s[20:23], s64 offen offset:1024 nt
  buffer_store_dwordx4 a[72:75], v20, s[20:23], s64 offen offset:2048 nt
  buffer_store_dwordx4 a[76:79], v20, s[20:23], s64 offen offset:3072 nt
  s_cmp_lg_u32 s68, 0
  s_cbranch_scc1 L_epi3
L_epx2:
  v_mfma_f32_16x16x32_bf16 v[40:43], a[128:131], v[160:163], 0
  ds_read_b128 a[128:131], v1 offset:8192
  v_exp_f32 v32, v32
  v_exp_f32 v33, v33
  v_mfma_f32_16x16x32_bf16 v[40:43], a[132:135], v[164:167], v[40:43]
  ds_read_b128 a[132:135], v2 offset:8192
  v_exp_f32 v34, v34
  v_mfma_f32_16x16x32_bf16 v[40:43], a[136:139], v[168:171], v[40:43]
  ds_read_b128 a[136:139], v3 offset:8192
  v_cvt_pk_bf16_f32 v52, v32, v33
  v_exp_f32 v35, v35
  v_mfma_f32_16x16x32_bf16 v[40:43], a[140:143], v[172:175], v[40:43]
  ds_read_b128 a[140:143], v4 offset:8192
  v_exp_f32 v36, v36
  v_mfma_f32_16x16x32_bf16 v[44:47], a[144:147], v[160:163], 0
  ds_read_b128 a[144:147], v1 offset:12288
  v_cvt_pk_bf16_f32 v53, v34, v35
  v_exp_f32 v37, v37
  v_mfma_f32_16x16x32_bf16 v[44:47], a[148:151], v[164:167], v[44:47]
  ds_read_b128 a[148:151], v2 offset:12288
  v_exp_f32 v38, v38
  v_mfma_f32_16x16x32_bf16 v[44:47], a[152:155], v[168:171], v[44:47]
  ds_read_b128 a[152:155], v3 offset:12288
  v_cvt_pk_bf16_f32 v54, v36, v37
  v_exp_f32 v39, v39
  v_mfma_f32_16x16x32_bf16 v[44:47], a[156:159], v[172:175], v[44:47]
  ds_read_b128 a[156:159], v4 offset:12288
  v_cvt_pk_bf16_f32 v55, v38, v39
  v_mfma_f32_16x16x32_bf16 a[64:67], a[160:163], v[48:51], 0
  v_max3_f32 v75, v248, v249, v75
  v_max3_f32 v75, v250, v251, v75
  v_max3_f32 v75, v252, v253, v75
  v_mfma_f32_16x16x32_bf16 a[68:71], a[164:167], v[48:51], 0
  v_max3_f32 v75, v254, v255, v75
  v_mov_b32 v22, v75
  v_mfma_f32_16x16x32_bf16 a[72:75], a[168:171], v[48:51], 0
  s_nop 0
  v_permlane32_swap_b32 v22, v75
  v_max_f32 v75, v22, v75
  v_mov_b32 v22, v75
  v_mfma_f32_16x16x32_bf16 a[76:79], a[172:175], v[48:51], 0
  s_nop 0
  v_permlane16_swap_b32 v22, v75
  v_max_f32 v22, v22, v75
  v_mfma_f32_16x16x32_bf16 a[80:83], a[176:179], v[48:51], 0
  v_sub_f32 v248, v248, v22
  v_sub_f32 v249, v249, v22
  v_sub_f32 v250, v250, v22
  v_mfma_f32_16x16x32_bf16 a[84:87], a[180:183], v[48:51], 0
  v_sub_f32 v251, v251, v22
  v_sub_f32 v252, v252, v22
  v_mfma_f32_16x16x32_bf16 a[88:91], a[184:187], v[48:51], 0
  v_sub_f32 v253, v253, v22
  v_sub_f32 v254, v254, v22
  v_sub_f32 v255, v255, v22
  v_mfma_f32_16x16x32_bf16 a[92:95], a[188:191], v[48:51], 0
  v_sub_f32 v72, 0, v22
  v_sub_f32 v73, 0, v22
  v_mfma_f32_16x16x32_bf16 a[200:203], a[216:219], v[48:51], 0
  v_sub_f32 v74, 0, v22
  v_sub_f32 v75, 0, v22
L_epi3:
  v_accvgpr_read_b32 v23, a208
  v_rcp_f32 v22, v23
  v_add_f32 v21, v21, v23
  v_accvgpr_read_b32 v23, a254
  v_pk_mul_f32 v[176:177], v[176:177], v[22:23] op_sel_hi:[1,0]
  v_pk_mul_f32 v[178:179], v[178:179], v[22:23] op_sel_hi:[1,0]
  v_pk_mul_f32 v[180:181], v[180:181], v[22:23] op_sel_hi:[1,0]
  v_pk_mul_f32 v[182:183], v[182:183], v[22:23] op_sel_hi:[1,0]
  v_cvt_pk_bf16_f32 v24, v176, v177
  v_cvt_pk_bf16_f32 v25, v178, v179
  v_cvt_pk_bf16_f32 v26, v180, v181
  v_cvt_pk_bf16_f32 v27, v182, v183
  ds_write_b64 v23, v[24:25] offset:0
  v_xor_b32 v23, 32, v23
  ds_write_b64 v23, v[26:27] offset:0
  v_xor_b32 v23, 96, v23
  v_pk_mul_f32 v[184:185], v[184:185], v[22:23] op_sel_hi:[1,0]
  v_pk_mul_f32 v[186:187], v[186:187], v[22:23] op_sel_hi:[1,0]
  v_pk_mul_f32 v[188:189], v[188:189], v[22:23] op_sel_hi:[1,0]
  v_pk_mul_f32 v[190:191], v[190:191], v[22:23] op_sel_hi:[1,0]
  v_cvt_pk_bf16_f32 v28, v184, v185
  v_cvt_pk_bf16_f32 v29, v186, v187
  v_cvt_pk_bf16_f32 v30, v188, v189
  v_cvt_pk_bf16_f32 v31, v190, v191
  ds_write_b64 v23, v[28:29] offset:0
  v_xor_b32 v23, 32, v23
  ds_write_b64 v23, v[30:31] offset:0
  v_xor_b32 v23, 224, v23
  v_pk_mul_f32 v[192:193], v[192:193], v[22:23] op_sel_hi:[1,0]
  v_pk_mul_f32 v[194:195], v[194:195], v[22:23] op_sel_hi:[1,0]
  v_pk_mul_f32 v[196:197], v[196:197], v[22:23] op_sel_hi:[1,0]
  v_pk_mul_f32 v[198:199], v[198:199], v[22:23] op_sel_hi:[1,0]
  v_cvt_pk_bf16_f32 v24, v192, v193
  v_cvt_pk_bf16_f32 v25, v194, v195
  v_cvt_pk_bf16_f32 v26, v196, v197
  v_cvt_pk_bf16_f32 v27, v198, v199
  ds_write_b64 v23, v[24:25] offset:0
  v_xor_b32 v23, 32, v23
  ds_write_b64 v23, v[26:27] offset:0
  v_xor_b32 v23, 96, v23
  v_pk_mul_f32 v[200:201], v[200:201], v[22:23] op_sel_hi:[1,0]
  v_pk_mul_f32 v[202:203], v[202:203], v[22:23] op_sel_hi:[1,0]
  v_pk_mul_f32 v[204:205], v[204:205], v[22:23] op_sel_hi:[1,0]
  v_pk_mul_f32 v[206:207], v[206:207], v[22:23] op_sel_hi:[1,0]
  v_cvt_pk_bf16_f32 v28, v200, v201
  v_cvt_pk_bf16_f32 v29, v202, v203
  v_cvt_pk_bf16_f32 v30, v204, v205
  v_cvt_pk_bf16_f32 v31, v206, v207
  ds_write_b64 v23, v[28:29] offset:0
  v_xor_b32 v23, 32, v23
  ds_write_b64 v23, v[30:31] offset:0
  v_accvgpr_read_b32 v23, a255
  ds_read_b128 v[176:179], v23 offset:0
  v_xor_b32 v23, 64, v23
  ds_read_b128 v[180:183], v23 offset:1024
  v_xor_b32 v23, 192, v23
  ds_read_b128 v[184:187], v23 offset:2048
  v_xor_b32 v23, 64, v23
  ds_read_b128 v[188:191], v23 offset:3072
  s_add_u32 s64, s51, 12288
  s_waitcnt lgkmcnt(12)
  buffer_store_dwordx4 a[96:99], v20, s[20:23], s64 offen offset:0 nt
  buffer_store_dwordx4 a[100:103], v20, s[20:23], s64 offen offset:1024 nt
  buffer_store_dwordx4 a[104:107], v20, s[20:23], s64 offen offset:2048 nt
  buffer_store_dwordx4 a[108:111], v20, s[20:23], s64 offen offset:3072 nt
  v_accvgpr_read_b32 v23, a212
  v_rcp_f32 v22, v23
  v_add_f32 v21, v21, v23
  v_accvgpr_read_b32 v23, a254
  v_pk_mul_f32 v[208:209], v[208:209], v[22:23] op_sel_hi:[1,0]
  v_pk_mul_f32 v[210:211], v[210:211], v[22:23] op_sel_hi:[1,0]
  v_pk_mul_f32 v[212:213], v[212:213], v[22:23] op_sel_hi:[1,0]
  v_pk_mul_f32 v[214:215], v[214:215], v[22:23] op_sel_hi:[1,0]
  v_cvt_pk_bf16_f32 v24, v208, v209
  v_cvt_pk_bf16_f32 v25, v210, v211
  v_cvt_pk_bf16_f32 v26, v212, v213
  v_cvt_pk_bf16_f32 v27, v214, v215
  ds_write_b64 v23, v[24:25] offset:4096
  v_xor_b32 v23, 32, v23
  ds_write_b64 v23, v[26:27] offset:4096
  v_xor_b32 v23, 96, v23
  v_pk_mul_f32 v[216:217], v[216:217], v[22:23] op_sel_hi:[1,0]
  v_pk_mul_f32 v[218:219], v[218:219], v[22:23] op_sel_hi:[1,0]
  v_pk_mul_f32 v[220:221], v[220:221], v[22:23] op_sel_hi:[1,0]
  v_pk_mul_f32 v[222:223], v[222:223], v[22:23] op_sel_hi:[1,0]
  v_cvt_pk_bf16_f32 v28, v216, v217
  v_cvt_pk_bf16_f32 v29, v218, v219
  v_cvt_pk_bf16_f32 v30, v220, v221
  v_cvt_pk_bf16_f32 v31, v222, v223
  ds_write_b64 v23, v[28:29] offset:4096
  v_xor_b32 v23, 32, v23
  ds_write_b64 v23, v[30:31] offset:4096
  v_xor_b32 v23, 224, v23
  v_pk_mul_f32 v[224:225], v[224:225], v[22:23] op_sel_hi:[1,0]
  v_pk_mul_f32 v[226:227], v[226:227], v[22:23] op_sel_hi:[1,0]
  v_pk_mul_f32 v[228:229], v[228:229], v[22:23] op_sel_hi:[1,0]
  v_pk_mul_f32 v[230:231], v[230:231], v[22:23] op_sel_hi:[1,0]
  v_cvt_pk_bf16_f32 v24, v224, v225
  v_cvt_pk_bf16_f32 v25, v226, v227
  v_cvt_pk_bf16_f32 v26, v228, v229
  v_cvt_pk_bf16_f32 v27, v230, v231
  ds_write_b64 v23, v[24:25] offset:4096
  v_xor_b32 v23, 32, v23
  ds_write_b64 v23, v[26:27] offset:4096
  v_xor_b32 v23, 96, v23
  v_pk_mul_f32 v[232:233], v[232:233], v[22:23] op_sel_hi:[1,0]
  v_pk_mul_f32 v[234:235], v[234:235], v[22:23] op_sel_hi:[1,0]
  v_pk_mul_f32 v[236:237], v[236:237], v[22:23] op_sel_hi:[1,0]
  v_pk_mul_f32 v[238:239], v[238:239], v[22:23] op_sel_hi:[1,0]
  v_cvt_pk_bf16_f32 v28, v232, v233
  v_cvt_pk_bf16_f32 v29, v234, v235
  v_cvt_pk_bf16_f32 v30, v236, v237
  v_cvt_pk_bf16_f32 v31, v238, v239
  ds_write_b64 v23, v[28:29] offset:4096
  v_xor_b32 v23, 32, v23
  ds_write_b64 v23, v[30:31] offset:4096
  v_accvgpr_read_b32 v23, a255
  ds_read_b128 v[208:211], v23 offset:4096
  v_xor_b32 v23, 64, v23
  ds_read_b128 v[212:215], v23 offset:5120
  v_xor_b32 v23, 192, v23
  ds_read_b128 v[216:219], v23 offset:6144
  v_xor_b32 v23, 64, v23
  ds_read_b128 v[220:223], v23 offset:7168
  v_cmp_nge_f32 vcc, s35, v21
  s_nop 1
  s_cmp_lg_u64 vcc, 0
  s_cselect_b32 s48, s34, 0
  s_or_b32 s32, s32, s48
  s_add_u32 s64, s51, 16384
  s_waitcnt lgkmcnt(12)
  buffer_store_dwordx4 v[176:179], v20, s[20:23], s64 offen offset:0 nt
  buffer_store_dwordx4 v[180:183], v20, s[20:23], s64 offen offset:1024 nt
  buffer_store_dwordx4 v[184:187], v20, s[20:23], s64 offen offset:2048 nt
  buffer_store_dwordx4 v[188:191], v20, s[20:23], s64 offen offset:3072 nt
  s_cmp_lg_u32 s68, 0
  s_cbranch_scc1 L_epi4
L_epx3:
  v_mfma_f32_16x16x32_bf16 a[96:99], a[160:163], v[52:55], 0
  v_exp_f32 v248, v248
  v_exp_f32 v249, v249
  v_exp_f32 v250, v250
  v_mfma_f32_16x16x32_bf16 a[100:103], a[164:167], v[52:55], 0
  v_cvt_pk_bf16_f32 v48, v248, v249
  v_exp_f32 v251, v251
  v_exp_f32 v252, v252
  v_mfma_f32_16x16x32_bf16 a[104:107], a[168:171], v[52:55], 0
  v_cvt_pk_bf16_f32 v49, v250, v251
  v_exp_f32 v253, v253
  v_mfma_f32_16x16x32_bf16 a[108:111], a[172:175], v[52:55], 0
  v_exp_f32 v254, v254
  v_cvt_pk_bf16_f32 v50, v252, v253
  v_exp_f32 v255, v255
  v_mfma_f32_16x16x32_bf16 a[112:115], a[176:179], v[52:55], 0
  v_cvt_pk_bf16_f32 v51, v254, v255
  v_max3_f32 v79, v40, v41, v79
  v_max3_f32 v79, v42, v43, v79
  v_max3_f32 v79, v44, v45, v79
  v_max3_f32 v79, v46, v47, v79
  v_mfma_f32_16x16x32_bf16 a[116:119], a[180:183], v[52:55], 0
  v_mov_b32 v23, v79
  s_nop 1
  v_permlane32_swap_b32 v23, v79
  v_max_f32 v79, v23, v79
  v_mov_b32 v23, v79
  s_nop 1
  v_permlane16_swap_b32 v23, v79
  v_mfma_f32_16x16x32_bf16 a[120:123], a[184:187], v[52:55], 0
  v_max_f32 v23, v23, v79
  v_sub_f32 v40, v40, v23
  v_sub_f32 v41, v41, v23
  v_sub_f32 v42, v42, v23
  v_mfma_f32_16x16x32_bf16 a[124:127], a[188:191], v[52:55], 0
  v_sub_f32 v43, v43, v23
  v_sub_f32 v44, v44, v23
  v_sub_f32 v45, v45, v23
  v_sub_f32 v46, v46, v23
  v_sub_f32 v47, v47, v23
  v_mfma_f32_16x16x32_bf16 a[204:207], a[216:219], v[52:55], 0
  v_sub_f32 v76, 0, v23
  v_sub_f32 v77, 0, v23
  v_sub_f32 v78, 0, v23
  v_sub_f32 v79, 0, v23
L_epi4:
  s_add_u32 s64, s51, 20480
  s_waitcnt lgkmcnt(0)
  buffer_store_dwordx4 v[208:211], v20, s[20:23], s64 offen offset:0 nt
  buffer_store_dwordx4 v[212:215], v20, s[20:23], s64 offen offset:1024 nt
  buffer_store_dwordx4 v[216:219], v20, s[20:23], s64 offen offset:2048 nt
  buffer_store_dwordx4 v[220:223], v20, s[20:23], s64 offen offset:3072 nt
  s_cmp_lg_u32 s68, 0
  s_cbranch_scc1 L_end
L_epx4:
  s_waitcnt lgkmcnt(15)
  v_mfma_f32_16x16x32_bf16 v[32:35], a[128:131], v[80:83], v[56:59]
  s_add_u32 m0, s25, 49152
  s_nop 0
  buffer_load_dwordx4 v13, s[12:15], s28 offen offset:0 nt lds
  v_exp_f32 v40, v40
  v_mfma_f32_16x16x32_bf16 v[32:35], a[132:135], v[84:87], v[32:35]
  v_exp_f32 v41, v41
  v_exp_f32 v42, v42
  v_mfma_f32_16x16x32_bf16 v[32:35], a[136:139], v[88:91], v[32:35]
  v_cvt_pk_bf16_f32 v52, v40, v41
  v_exp_f32 v43, v43
  v_mfma_f32_16x16x32_bf16 v[32:35], a[140:143], v[92:95], v[32:35]
  v_exp_f32 v44, v44
  v_cvt_pk_bf16_f32 v53, v42, v43
  v_exp_f32 v45, v45
  v_mfma_f32_16x16x32_bf16 v[36:39], a[144:147], v[80:83], v[56:59]
  v_exp_f32 v46, v46
  v_cvt_pk_bf16_f32 v54, v44, v45
  v_mfma_f32_16x16x32_bf16 v[36:39], a[148:151], v[84:87], v[36:39]
  v_exp_f32 v47, v47
  s_nop 0
  v_cvt_pk_bf16_f32 v55, v46, v47
  buffer_load_dwordx4 v14, s[12:15], s28 offen offset:1024 nt lds
  v_mfma_f32_16x16x32_bf16 v[36:39], a[152:155], v[88:91], v[36:39]
  v_mov_b32 v208, 0
  v_mov_b32 v209, 0
  v_mov_b32 v210, 0
  v_mfma_f32_16x16x32_bf16 v[36:39], a[156:159], v[92:95], v[36:39]
  v_mov_b32 v211, 0
  v_mov_b32 v212, 0
  v_mov_b32 v213, 0
  v_mov_b32 v214, 0
  v_mfma_f32_16x16x32_bf16 v[176:179], a[160:163], v[48:51], 0
  v_mov_b32 v215, 0
  v_mov_b32 v216, 0
  v_mov_b32 v217, 0
  v_mov_b32 v218, 0
  v_mfma_f32_16x16x32_bf16 v[180:183], a[164:167], v[48:51], 0
  v_mov_b32 v219, 0
  buffer_load_dwordx4 v15, s[12:15], s28 offen offset:2048 nt lds
  v_mov_b32 v220, 0
  v_mfma_f32_16x16x32_bf16 v[184:187], a[168:171], v[48:51], 0
  v_mov_b32 v221, 0
  v_mov_b32 v222, 0
  v_mov_b32 v223, 0
  v_mov_b32 v224, 0
  v_mfma_f32_16x16x32_bf16 v[188:191], a[172:175], v[48:51], 0
  v_mov_b32 v225, 0
  v_mov_b32 v226, 0
  v_mov_b32 v227, 0
  v_mov_b32 v228, 0
  v_mfma_f32_16x16x32_bf16 v[192:195], a[176:179], v[48:51], 0
  v_mov_b32 v229, 0
  v_mov_b32 v230, 0
  v_mov_b32 v231, 0
  buffer_load_dwordx4 v16, s[12:15], s28 offen offset:3072 nt lds
  v_mfma_f32_16x16x32_bf16 v[196:199], a[180:183], v[48:51], 0
  v_mov_b32 v232, 0
  v_mov_b32 v233, 0
  v_mov_b32 v234, 0
  v_mfma_f32_16x16x32_bf16 v[200:203], a[184:187], v[48:51], 0
  v_mov_b32 v235, 0
  v_mov_b32 v236, 0
  v_mov_b32 v237, 0
  v_mov_b32 v238, 0
  v_mfma_f32_16x16x32_bf16 v[204:207], a[188:191], v[48:51], 0
  v_mov_b32 v239, 0
  v_accvgpr_write_b32 a212, 0
  v_accvgpr_write_b32 a213, 0
  v_accvgpr_write_b32 a214, 0
  v_mfma_f32_16x16x32_bf16 a[208:211], a[216:219], v[48:51], 0
  v_accvgpr_write_b32 a215, 0
  s_add_u32 m0, s25, 114688
  s_nop 0
  buffer_load_dwordx4 v17, s[16:19], s28 offen offset:0 nt lds
  v_exp_f32 v32, v32
  v_exp_f32 v33, v33
  s_mov_b32 s47, 0
  s_mov_b32 s34, s66
  s_mul_i32 s62, s27, 98304
  s_mul_i32 s49, s24, 20480
  s_add_u32 s62, s62, s49
  s_branch L_body1
.p2align 6
L_body0:
  v_mfma_f32_16x16x32_bf16 v[40:43], a[128:131], v[96:99], v[60:63]
  v_exp_f32 v34, v34
  v_mfma_f32_16x16x32_bf16 v[40:43], a[132:135], v[100:103], v[40:43]
  v_exp_f32 v35, v35
  v_mfma_f32_16x16x32_bf16 v[40:43], a[136:139], v[104:107], v[40:43]
  v_cvt_pk_bf16_f32 v48, v32, v33
  v_cvt_pk_bf16_f32 v49, v34, v35
  v_mfma_f32_16x16x32_bf16 v[40:43], a[140:143], v[108:111], v[40:43]
  v_exp_f32 v36, v36
  v_mfma_f32_16x16x32_bf16 v[44:47], a[144:147], v[96:99], v[60:63]
  v_exp_f32 v37, v37
  v_mfma_f32_16x16x32_bf16 v[44:47], a[148:151], v[100:103], v[44:47]
  v_exp_f32 v38, v38
  v_mfma_f32_16x16x32_bf16 v[44:47], a[152:155], v[104:107], v[44:47]
  v_exp_f32 v39, v39
  v_mfma_f32_16x16x32_bf16 v[44:47], a[156:159], v[108:111], v[44:47]
  v_cvt_pk_bf16_f32 v50, v36, v37
  v_cvt_pk_bf16_f32 v51, v38, v39
  v_mfma_f32_16x16x32_bf16 v[208:211], a[160:163], v[52:55], v[208:211]
  ds_read_b64_tr_b16 a[160:161], v5 offset:0
  ds_read_b64_tr_b16 a[162:163], v5 offset:4096
  v_mfma_f32_16x16x32_bf16 v[212:215], a[164:167], v[52:55], v[212:215]
  ds_read_b64_tr_b16 a[164:165], v6 offset:0
  ds_read_b64_tr_b16 a[166:167], v6 offset:4096
  v_mfma_f32_16x16x32_bf16 v[216:219], a[168:171], v[52:55], v[216:219]
  ds_read_b64_tr_b16 a[168:169], v7 offset:0
  ds_read_b64_tr_b16 a[170:171], v7 offset:4096
  v_mfma_f32_16x16x32_bf16 v[220:223], a[172:175], v[52:55], v[220:223]
  ds_read_b64_tr_b16 a[172:173], v8 offset:0
  ds_read_b64_tr_b16 a[174:175], v8 offset:4096
  v_mfma_f32_16x16x32_bf16 v[224:227], a[176:179], v[52:55], v[224:227]
  ds_read_b64_tr_b16 a[176:177], v9 offset:0
  ds_read_b64_tr_b16 a[178:179], v9 offset:4096
  v_mfma_f32_16x16x32_bf16 v[228:231], a[180:183], v[52:55], v[228:231]
  ds_read_b64_tr_b16 a[180:181], v10 offset:0
  ds_read_b64_tr_b16 a[182:183], v10 offset:4096
  v_mfma_f32_16x16x32_bf16 v[232:235], a[184:187], v[52:55], v[232:235]
  ds_read_b64_tr_b16 a[184:185], v11 offset:0
  ds_read_b64_tr_b16 a[186:187], v11 offset:4096
  v_mfma_f32_16x16x32_bf16 v[236:239], a[188:191], v[52:55], v[236:239]
  ds_read_b64_tr_b16 a[188:189], v12 offset:0
  ds_read_b64_tr_b16 a[190:191], v12 offset:4096
  v_mfma_f32_16x16x32_bf16 a[212:215], a[216:219], v[52:55], a[212:215]
  v_mfma_f32_16x16x32_bf16 v[32:35], a[128:131], v[112:115], v[64:67]
  v_exp_f32 v40, v40
  v_mfma_f32_16x16x32_bf16 v[32:35], a[132:135], v[116:119], v[32:35]
  v_exp_f32 v41, v41
  v_mfma_f32_16x16x32_bf16 v[32:35], a[136:139], v[120:123], v[32:35]
  buffer_load_dwordx4 v14, s[12:15], s28 offen offset:1024 nt lds
  v_mfma_f32_16x16x32_bf16 v[32:35], a[140:143], v[124:127], v[32:35]
  v_exp_f32 v42, v42
  v_mfma_f32_16x16x32_bf16 v[36:39], a[144:147], v[112:115], v[64:67]
  v_exp_f32 v43, v43
  v_mfma_f32_16x16x32_bf16 v[36:39], a[148:151], v[116:119], v[36:39]
  v_cvt_pk_bf16_f32 v52, v40, v41
  v_cvt_pk_bf16_f32 v53, v42, v43
  v_mfma_f32_16x16x32_bf16 v[36:39], a[152:155], v[120:123], v[36:39]
  v_exp_f32 v44, v44
  v_mfma_f32_16x16x32_bf16 v[36:39], a[156:159], v[124:127], v[36:39]
  s_waitcnt lgkmcnt(0)
  v_mfma_f32_16x16x32_bf16 a[0:3], a[160:163], v[48:51], a[0:3]
  v_exp_f32 v45, v45
  v_mfma_f32_16x16x32_bf16 a[4:7], a[164:167], v[48:51], a[4:7]
  v_exp_f32 v46, v46
  v_mfma_f32_16x16x32_bf16 a[8:11], a[168:171], v[48:51], a[8:11]
  v_exp_f32 v47, v47
  v_mfma_f32_16x16x32_bf16 a[12:15], a[172:175], v[48:51], a[12:15]
  v_cvt_pk_bf16_f32 v54, v44, v45
  v_cvt_pk_bf16_f32 v55, v46, v47
  v_mfma_f32_16x16x32_bf16 a[16:19], a[176:179], v[48:51], a[16:19]
  v_mfma_f32_16x16x32_bf16 a[20:23], a[180:183], v[48:51], a[20:23]
  v_mfma_f32_16x16x32_bf16 a[24:27], a[184:187], v[48:51], a[24:27]
  v_mfma_f32_16x16x32_bf16 a[28:31], a[188:191], v[48:51], a[28:31]
  v_mfma_f32_16x16x32_bf16 a[192:195], a[216:219], v[48:51], a[192:195]
  v_mfma_f32_16x16x32_bf16 v[40:43], a[128:131], v[128:131], v[68:71]
  v_exp_f32 v32, v32
  v_mfma_f32_16x16x32_bf16 v[40:43], a[132:135], v[132:135], v[40:43]
  v_exp_f32 v33, v33
  v_mfma_f32_16x16x32_bf16 v[40:43], a[136:139], v[136:139], v[40:43]
  buffer_load_dwordx4 v15, s[12:15], s28 offen offset:2048 nt lds
  v_mfma_f32_16x16x32_bf16 v[40:43], a[140:143], v[140:143], v[40:43]
  v_exp_f32 v34, v34
  v_mfma_f32_16x16x32_bf16 v[44:47], a[144:147], v[128:131], v[68:71]
  v_exp_f32 v35, v35
  v_mfma_f32_16x16x32_bf16 v[44:47], a[148:151], v[132:135], v[44:47]
  v_cvt_pk_bf16_f32 v48, v32, v33
  v_cvt_pk_bf16_f32 v49, v34, v35
  v_mfma_f32_16x16x32_bf16 v[44:47], a[152:155], v[136:139], v[44:47]
  v_exp_f32 v36, v36
  v_mfma_f32_16x16x32_bf16 v[44:47], a[156:159], v[140:143], v[44:47]
  v_exp_f32 v37, v37
  v_mfma_f32_16x16x32_bf16 a[32:35], a[160:163], v[52:55], a[32:35]
  v_exp_f32 v38, v38
  v_mfma_f32_16x16x32_bf16 a[36:39], a[164:167], v[52:55], a[36:39]
  v_exp_f32 v39, v39
  v_mfma_f32_16x16x32_bf16 a[40:43], a[168:171], v[52:55], a[40:43]
  v_cvt_pk_bf16_f32 v50, v36, v37
  v_cvt_pk_bf16_f32 v51, v38, v39
  v_mfma_f32_16x16x32_bf16 a[44:47], a[172:175], v[52:55], a[44:47]
  v_mfma_f32_16x16x32_bf16 a[48:51], a[176:179], v[52:55], a[48:51]
  v_mfma_f32_16x16x32_bf16 a[52:55], a[180:183], v[52:55], a[52:55]
  v_mfma_f32_16x16x32_bf16 a[56:59], a[184:187], v[52:55], a[56:59]
  v_mfma_f32_16x16x32_bf16 a[60:63], a[188:191], v[52:55], a[60:63]
  v_mfma_f32_16x16x32_bf16 a[196:199], a[216:219], v[52:55], a[196:199]
  v_mfma_f32_16x16x32_bf16 v[32:35], a[128:131], v[144:147], v[72:75]
  v_exp_f32 v40, v40
  v_mfma_f32_16x16x32_bf16 v[32:35], a[132:135], v[148:151], v[32:35]
  v_exp_f32 v41, v41
  v_mfma_f32_16x16x32_bf16 v[32:35], a[136:139], v[152:155], v[32:35]
  buffer_load_dwordx4 v16, s[12:15], s28 offen offset:3072 nt lds
  v_mfma_f32_16x16x32_bf16 v[32:35], a[140:143], v[156:159], v[32:35]
  v_exp_f32 v42, v42
  v_mfma_f32_16x16x32_bf16 v[36:39], a[144:147], v[144:147], v[72:75]
  v_exp_f32 v43, v43
  v_mfma_f32_16x16x32_bf16 v[36:39], a[148:151], v[148:151], v[36:39]
  v_cvt_pk_bf16_f32 v52, v40, v41
  v_cvt_pk_bf16_f32 v53, v42, v43
  v_mfma_f32_16x16x32_bf16 v[36:39], a[152:155], v[152:155], v[36:39]
  v_exp_f32 v44, v44
  v_mfma_f32_16x16x32_bf16 v[36:39], a[156:159], v[156:159], v[36:39]
  v_exp_f32 v45, v45
  v_mfma_f32_16x16x32_bf16 a[64:67], a[160:163], v[48:51], a[64:67]
  v_exp_f32 v46, v46
  v_mfma_f32_16x16x32_bf16 a[68:71], a[164:167], v[48:51], a[68:71]
  v_exp_f32 v47, v47
  v_mfma_f32_16x16x32_bf16 a[72:75], a[168:171], v[48:51], a[72:75]
  v_cvt_pk_bf16_f32 v54, v44, v45
  v_cvt_pk_bf16_f32 v55, v46, v47
  v_mfma_f32_16x16x32_bf16 a[76:79], a[172:175], v[48:51], a[76:79]
  v_mfma_f32_16x16x32_bf16 a[80:83], a[176:179], v[48:51], a[80:83]
  v_mfma_f32_16x16x32_bf16 a[84:87], a[180:183], v[48:51], a[84:87]
  v_mfma_f32_16x16x32_bf16 a[88:91], a[184:187], v[48:51], a[88:91]
  v_mfma_f32_16x16x32_bf16 a[92:95], a[188:191], v[48:51], a[92:95]
  v_mfma_f32_16x16x32_bf16 a[200:203], a[216:219], v[48:51], a[200:203]
  v_mfma_f32_16x16x32_bf16 v[40:43], a[128:131], v[160:163], v[76:79]
  v_exp_f32 v32, v32
  v_mfma_f32_16x16x32_bf16 v[40:43], a[132:135], v[164:167], v[40:43]
  ds_read_b128 a[128:131], v1 offset:8192
  ds_read_b128 a[132:135], v2 offset:8192
  v_mfma_f32_16x16x32_bf16 v[40:43], a[136:139], v[168:171], v[40:43]
  v_exp_f32 v33, v33
  v_mfma_f32_16x16x32_bf16 v[40:43], a[140:143], v[172:175], v[40:43]
  ds_read_b128 a[136:139], v3 offset:8192
  ds_read_b128 a[140:143], v4 offset:8192
  v_mfma_f32_16x16x32_bf16 v[44:47], a[144:147], v[160:163], v[76:79]
  v_exp_f32 v34, v34
  v_mfma_f32_16x16x32_bf16 v[44:47], a[148:151], v[164:167], v[44:47]
  ds_read_b128 a[144:147], v1 offset:12288
  ds_read_b128 a[148:151], v2 offset:12288
  v_mfma_f32_16x16x32_bf16 v[44:47], a[152:155], v[168:171], v[44:47]
  v_exp_f32 v35, v35
  v_mfma_f32_16x16x32_bf16 v[44:47], a[156:159], v[172:175], v[44:47]
  ds_read_b128 a[152:155], v3 offset:12288
  ds_read_b128 a[156:159], v4 offset:12288
  v_mfma_f32_16x16x32_bf16 a[96:99], a[160:163], v[52:55], a[96:99]
  v_cvt_pk_bf16_f32 v48, v32, v33
  v_cvt_pk_bf16_f32 v49, v34, v35
  v_mfma_f32_16x16x32_bf16 a[100:103], a[164:167], v[52:55], a[100:103]
  v_exp_f32 v36, v36
  v_mfma_f32_16x16x32_bf16 a[104:107], a[168:171], v[52:55], a[104:107]
  v_exp_f32 v37, v37
  v_mfma_f32_16x16x32_bf16 a[108:111], a[172:175], v[52:55], a[108:111]
  v_exp_f32 v38, v38
  v_mfma_f32_16x16x32_bf16 a[112:115], a[176:179], v[52:55], a[112:115]
  v_exp_f32 v39, v39
  v_mfma_f32_16x16x32_bf16 a[116:119], a[180:183], v[52:55], a[116:119]
  v_cvt_pk_bf16_f32 v50, v36, v37
  v_cvt_pk_bf16_f32 v51, v38, v39
  v_mfma_f32_16x16x32_bf16 a[120:123], a[184:187], v[52:55], a[120:123]
  v_mfma_f32_16x16x32_bf16 a[124:127], a[188:191], v[52:55], a[124:127]
  v_mfma_f32_16x16x32_bf16 a[204:207], a[216:219], v[52:55], a[204:207]
  s_waitcnt lgkmcnt(0)
  v_mfma_f32_16x16x32_bf16 v[32:35], a[128:131], v[80:83], v[56:59]
  v_exp_f32 v40, v40
  v_mfma_f32_16x16x32_bf16 v[32:35], a[132:135], v[84:87], v[32:35]
  s_add_u32 m0, s25, 114688
  v_mfma_f32_16x16x32_bf16 v[32:35], a[136:139], v[88:91], v[32:35]
  buffer_load_dwordx4 v17, s[16:19], s28 offen offset:0 nt lds
  v_mfma_f32_16x16x32_bf16 v[32:35], a[140:143], v[92:95], v[32:35]
  v_exp_f32 v41, v41
  v_mfma_f32_16x16x32_bf16 v[36:39], a[144:147], v[80:83], v[56:59]
  v_exp_f32 v42, v42
  v_mfma_f32_16x16x32_bf16 v[36:39], a[148:151], v[84:87], v[36:39]
  v_exp_f32 v43, v43
  v_mfma_f32_16x16x32_bf16 v[36:39], a[152:155], v[88:91], v[36:39]
  v_cvt_pk_bf16_f32 v52, v40, v41
  v_cvt_pk_bf16_f32 v53, v42, v43
  v_mfma_f32_16x16x32_bf16 v[36:39], a[156:159], v[92:95], v[36:39]
  v_exp_f32 v44, v44
  v_mfma_f32_16x16x32_bf16 v[176:179], a[160:163], v[48:51], v[176:179]
  v_exp_f32 v45, v45
  v_mfma_f32_16x16x32_bf16 v[180:183], a[164:167], v[48:51], v[180:183]
  v_exp_f32 v46, v46
  v_mfma_f32_16x16x32_bf16 v[184:187], a[168:171], v[48:51], v[184:187]
  v_exp_f32 v47, v47
  v_mfma_f32_16x16x32_bf16 v[188:191], a[172:175], v[48:51], v[188:191]
  v_cvt_pk_bf16_f32 v54, v44, v45
  v_cvt_pk_bf16_f32 v55, v46, v47
  v_mfma_f32_16x16x32_bf16 v[192:195], a[176:179], v[48:51], v[192:195]
  v_exp_f32 v32, v32
  v_mfma_f32_16x16x32_bf16 v[196:199], a[180:183], v[48:51], v[196:199]
  v_exp_f32 v33, v33
  v_mfma_f32_16x16x32_bf16 v[200:203], a[184:187], v[48:51], v[200:203]
  v_mfma_f32_16x16x32_bf16 v[204:207], a[188:191], v[48:51], v[204:207]
  v_mfma_f32_16x16x32_bf16 a[208:211], a[216:219], v[48:51], a[208:211]
L_body1:
  v_mfma_f32_16x16x32_bf16 v[40:43], a[128:131], v[96:99], v[60:63]
  v_exp_f32 v34, v34
  v_mfma_f32_16x16x32_bf16 v[40:43], a[132:135], v[100:103], v[40:43]
  v_exp_f32 v35, v35
  v_mfma_f32_16x16x32_bf16 v[40:43], a[136:139], v[104:107], v[40:43]
  v_cvt_pk_bf16_f32 v48, v32, v33
  v_cvt_pk_bf16_f32 v49, v34, v35
  v_mfma_f32_16x16x32_bf16 v[40:43], a[140:143], v[108:111], v[40:43]
  v_exp_f32 v36, v36
  v_mfma_f32_16x16x32_bf16 v[44:47], a[144:147], v[96:99], v[60:63]
  v_exp_f32 v37, v37
  v_mfma_f32_16x16x32_bf16 v[44:47], a[148:151], v[100:103], v[44:47]
  v_exp_f32 v38, v38
  v_mfma_f32_16x16x32_bf16 v[44:47], a[152:155], v[104:107], v[44:47]
  v_exp_f32 v39, v39
  v_mfma_f32_16x16x32_bf16 v[44:47], a[156:159], v[108:111], v[44:47]
  v_cvt_pk_bf16_f32 v50, v36, v37
  v_cvt_pk_bf16_f32 v51, v38, v39
  v_mfma_f32_16x16x32_bf16 v[208:211], a[160:163], v[52:55], v[208:211]
  ds_read_b64_tr_b16 a[160:161], v5 offset:8192
  ds_read_b64_tr_b16 a[162:163], v5 offset:12288
  v_mfma_f32_16x16x32_bf16 v[212:215], a[164:167], v[52:55], v[212:215]
  ds_read_b64_tr_b16 a[164:165], v6 offset:8192
  ds_read_b64_tr_b16 a[166:167], v6 offset:12288
  v_mfma_f32_16x16x32_bf16 v[216:219], a[168:171], v[52:55], v[216:219]
  ds_read_b64_tr_b16 a[168:169], v7 offset:8192
  ds_read_b64_tr_b16 a[170:171], v7 offset:12288
  v_mfma_f32_16x16x32_bf16 v[220:223], a[172:175], v[52:55], v[220:223]
  ds_read_b64_tr_b16 a[172:173], v8 offset:8192
  ds_read_b64_tr_b16 a[174:175], v8 offset:12288
  v_mfma_f32_16x16x32_bf16 v[224:227], a[176:179], v[52:55], v[224:227]
  ds_read_b64_tr_b16 a[176:177], v9 offset:8192
  ds_read_b64_tr_b16 a[178:179], v9 offset:12288
  v_mfma_f32_16x16x32_bf16 v[228:231], a[180:183], v[52:55], v[228:231]
  ds_read_b64_tr_b16 a[180:181], v10 offset:8192
  ds_read_b64_tr_b16 a[182:183], v10 offset:12288
  v_mfma_f32_16x16x32_bf16 v[232:235], a[184:187], v[52:55], v[232:235]
  ds_read_b64_tr_b16 a[184:185], v11 offset:8192
  ds_read_b64_tr_b16 a[186:187], v11 offset:12288
  v_mfma_f32_16x16x32_bf16 v[236:239], a[188:191], v[52:55], v[236:239]
  ds_read_b64_tr_b16 a[188:189], v12 offset:8192
  ds_read_b64_tr_b16 a[190:191], v12 offset:12288
  v_mfma_f32_16x16x32_bf16 a[212:215], a[216:219], v[52:55], a[212:215]
  v_mfma_f32_16x16x32_bf16 v[32:35], a[128:131], v[112:115], v[64:67]
  v_exp_f32 v40, v40
  v_mfma_f32_16x16x32_bf16 v[32:35], a[132:135], v[116:119], v[32:35]
  v_exp_f32 v41, v41
  v_mfma_f32_16x16x32_bf16 v[32:35], a[136:139], v[120:123], v[32:35]
  buffer_load_dwordx4 v18, s[16:19], s28 offen offset:1024 nt lds
  v_mfma_f32_16x16x32_bf16 v[32:35], a[140:143], v[124:127], v[32:35]
  v_exp_f32 v42, v42
  v_mfma_f32_16x16x32_bf16 v[36:39], a[144:147], v[112:115], v[64:67]
  v_exp_f32 v43, v43
  v_mfma_f32_16x16x32_bf16 v[36:39], a[148:151], v[116:119], v[36:39]
  v_cvt_pk_bf16_f32 v52, v40, v41
  v_cvt_pk_bf16_f32 v53, v42, v43
  v_mfma_f32_16x16x32_bf16 v[36:39], a[152:155], v[120:123], v[36:39]
  v_exp_f32 v44, v44
  v_mfma_f32_16x16x32_bf16 v[36:39], a[156:159], v[124:127], v[36:39]
  s_waitcnt lgkmcnt(0)
  v_mfma_f32_16x16x32_bf16 a[0:3], a[160:163], v[48:51], a[0:3]
  v_exp_f32 v45, v45
  v_mfma_f32_16x16x32_bf16 a[4:7], a[164:167], v[48:51], a[4:7]
  v_exp_f32 v46, v46
  v_mfma_f32_16x16x32_bf16 a[8:11], a[168:171], v[48:51], a[8:11]
  v_exp_f32 v47, v47
  v_mfma_f32_16x16x32_bf16 a[12:15], a[172:175], v[48:51], a[12:15]
  v_cvt_pk_bf16_f32 v54, v44, v45
  v_cvt_pk_bf16_f32 v55, v46, v47
  v_mfma_f32_16x16x32_bf16 a[16:19], a[176:179], v[48:51], a[16:19]
  v_mfma_f32_16x16x32_bf16 a[20:23], a[180:183], v[48:51], a[20:23]
  v_mfma_f32_16x16x32_bf16 a[24:27], a[184:187], v[48:51], a[24:27]
  v_mfma_f32_16x16x32_bf16 a[28:31], a[188:191], v[48:51], a[28:31]
  v_mfma_f32_16x16x32_bf16 a[192:195], a[216:219], v[48:51], a[192:195]
  v_mfma_f32_16x16x32_bf16 v[40:43], a[128:131], v[128:131], v[68:71]
  v_exp_f32 v32, v32
  v_mfma_f32_16x16x32_bf16 v[40:43], a[132:135], v[132:135], v[40:43]
  v_exp_f32 v33, v33
  v_mfma_f32_16x16x32_bf16 v[40:43], a[136:139], v[136:139], v[40:43]
  buffer_load_dwordx4 v17, s[16:19], s28 offen offset:2048 nt lds
  v_mfma_f32_16x16x32_bf16 v[40:43], a[140:143], v[140:143], v[40:43]
  v_exp_f32 v34, v34
  v_mfma_f32_16x16x32_bf16 v[44:47], a[144:147], v[128:131], v[68:71]
  v_exp_f32 v35, v35
  v_mfma_f32_16x16x32_bf16 v[44:47], a[148:151], v[132:135], v[44:47]
  v_cvt_pk_bf16_f32 v48, v32, v33
  v_cvt_pk_bf16_f32 v49, v34, v35
  v_mfma_f32_16x16x32_bf16 v[44:47], a[152:155], v[136:139], v[44:47]
  v_exp_f32 v36, v36
  v_mfma_f32_16x16x32_bf16 v[44:47], a[156:159], v[140:143], v[44:47]
  v_exp_f32 v37, v37
  v_mfma_f32_16x16x32_bf16 a[32:35], a[160:163], v[52:55], a[32:35]
  v_exp_f32 v38, v38
  v_mfma_f32_16x16x32_bf16 a[36:39], a[164:167], v[52:55], a[36:39]
  v_exp_f32 v39, v39
  v_mfma_f32_16x16x32_bf16 a[40:43], a[168:171], v[52:55], a[40:43]
  v_cvt_pk_bf16_f32 v50, v36, v37
  v_cvt_pk_bf16_f32 v51, v38, v39
  v_mfma_f32_16x16x32_bf16 a[44:47], a[172:175], v[52:55], a[44:47]
  v_mfma_f32_16x16x32_bf16 a[48:51], a[176:179], v[52:55], a[48:51]
  s_cmp_eq_u32 s30, s63
  s_cbranch_scc0 L_q0
  s_add_u32 s33, s62, 0
  s_add_u32 m0, s65, 0
  s_nop 0
  buffer_load_dwordx4 v13, s[8:11], s33 offen offset:0 nt lds
  buffer_load_dwordx4 v14, s[8:11], s33 offen offset:1024 nt lds
  buffer_load_dwordx4 v15, s[8:11], s33 offen offset:2048 nt lds
  buffer_load_dwordx4 v16, s[8:11], s33 offen offset:3072 nt lds
  s_add_u32 m0, s25, 114688
L_q0:
  v_mfma_f32_16x16x32_bf16 a[52:55], a[180:183], v[52:55], a[52:55]
  v_mfma_f32_16x16x32_bf16 a[56:59], a[184:187], v[52:55], a[56:59]
  v_mfma_f32_16x16x32_bf16 a[60:63], a[188:191], v[52:55], a[60:63]
  v_mfma_f32_16x16x32_bf16 a[196:199], a[216:219], v[52:55], a[196:199]
  v_mfma_f32_16x16x32_bf16 v[32:35], a[128:131], v[144:147], v[72:75]
  v_exp_f32 v40, v40
  v_mfma_f32_16x16x32_bf16 v[32:35], a[132:135], v[148:151], v[32:35]
  v_exp_f32 v41, v41
  v_mfma_f32_16x16x32_bf16 v[32:35], a[136:139], v[152:155], v[32:35]
  buffer_load_dwordx4 v18, s[16:19], s28 offen offset:3072 nt lds
  v_mfma_f32_16x16x32_bf16 v[32:35], a[140:143], v[156:159], v[32:35]
  v_exp_f32 v42, v42
  v_mfma_f32_16x16x32_bf16 v[36:39], a[144:147], v[144:147], v[72:75]
  v_exp_f32 v43, v43
  v_mfma_f32_16x16x32_bf16 v[36:39], a[148:151], v[148:151], v[36:39]
  v_cvt_pk_bf16_f32 v52, v40, v41
  v_cvt_pk_bf16_f32 v53, v42, v43
  v_mfma_f32_16x16x32_bf16 v[36:39], a[152:155], v[152:155], v[36:39]
  v_exp_f32 v44, v44
  v_mfma_f32_16x16x32_bf16 v[36:39], a[156:159], v[156:159], v[36:39]
  v_exp_f32 v45, v45
  v_mfma_f32_16x16x32_bf16 a[64:67], a[160:163], v[48:51], a[64:67]
  v_exp_f32 v46, v46
  v_mfma_f32_16x16x32_bf16 a[68:71], a[164:167], v[48:51], a[68:71]
  v_exp_f32 v47, v47
  v_mfma_f32_16x16x32_bf16 a[72:75], a[168:171], v[48:51], a[72:75]
  v_cvt_pk_bf16_f32 v54, v44, v45
  v_cvt_pk_bf16_f32 v55, v46, v47
  v_mfma_f32_16x16x32_bf16 a[76:79], a[172:175], v[48:51], a[76:79]
  v_mfma_f32_16x16x32_bf16 a[80:83], a[176:179], v[48:51], a[80:83]
  v_mfma_f32_16x16x32_bf16 a[84:87], a[180:183], v[48:51], a[84:87]
  v_mfma_f32_16x16x32_bf16 a[88:91], a[184:187], v[48:51], a[88:91]
  v_mfma_f32_16x16x32_bf16 a[92:95], a[188:191], v[48:51], a[92:95]
  v_mfma_f32_16x16x32_bf16 a[200:203], a[216:219], v[48:51], a[200:203]
  s_waitcnt vmcnt(16)
  s_barrier
  v_mfma_f32_16x16x32_bf16 v[40:43], a[128:131], v[160:163], v[76:79]
  v_exp_f32 v32, v32
  v_mfma_f32_16x16x32_bf16 v[40:43], a[132:135], v[164:167], v[40:43]
  ds_read_b128 a[128:131], v1 offset:16384
  ds_read_b128 a[132:135], v2 offset:16384
  v_mfma_f32_16x16x32_bf16 v[40:43], a[136:139], v[168:171], v[40:43]
  v_exp_f32 v33, v33
  v_mfma_f32_16x16x32_bf16 v[40:43], a[140:143], v[172:175], v[40:43]
  ds_read_b128 a[136:139], v3 offset:16384
  ds_read_b128 a[140:143], v4 offset:16384
  v_mfma_f32_16x16x32_bf16 v[44:47], a[144:147], v[160:163], v[76:79]
  v_exp_f32 v34, v34
  v_mfma_f32_16x16x32_bf16 v[44:47], a[148:151], v[164:167], v[44:47]
  ds_read_b128 a[144:147], v1 offset:20480
  ds_read_b128 a[148:151], v2 offset:20480
  v_mfma_f32_16x16x32_bf16 v[44:47], a[152:155], v[168:171], v[44:47]
  v_exp_f32 v35, v35
  v_mfma_f32_16x16x32_bf16 v[44:47], a[156:159], v[172:175], v[44:47]
  ds_read_b128 a[152:155], v3 offset:20480
  ds_read_b128 a[156:159], v4 offset:20480
  v_mfma_f32_16x16x32_bf16 a[96:99], a[160:163], v[52:55], a[96:99]
  v_cvt_pk_bf16_f32 v48, v32, v33
  v_cvt_pk_bf16_f32 v49, v34, v35
  v_mfma_f32_16x16x32_bf16 a[100:103], a[164:167], v[52:55], a[100:103]
  v_exp_f32 v36, v36
  v_mfma_f32_16x16x32_bf16 a[104:107], a[168:171], v[52:55], a[104:107]
  v_exp_f32 v37, v37
  v_mfma_f32_16x16x32_bf16 a[108:111], a[172:175], v[52:55], a[108:111]
  v_exp_f32 v38, v38
  v_mfma_f32_16x16x32_bf16 a[112:115], a[176:179], v[52:55], a[112:115]
  v_exp_f32 v39, v39
  v_mfma_f32_16x16x32_bf16 a[116:119], a[180:183], v[52:55], a[116:119]
  v_cvt_pk_bf16_f32 v50, v36, v37
  v_cvt_pk_bf16_f32 v51, v38, v39
  v_mfma_f32_16x16x32_bf16 a[120:123], a[184:187], v[52:55], a[120:123]
  v_mfma_f32_16x16x32_bf16 a[124:127], a[188:191], v[52:55], a[124:127]
  v_mfma_f32_16x16x32_bf16 a[204:207], a[216:219], v[52:55], a[204:207]
  s_waitcnt lgkmcnt(0)
  v_mfma_f32_16x16x32_bf16 v[32:35], a[128:131], v[80:83], v[56:59]
  s_add_u32 s28, s28, 16384
  s_cmp_eq_u32 s30, 3
  v_mfma_f32_16x16x32_bf16 v[32:35], a[132:135], v[84:87], v[32:35]
  s_cselect_b32 s28, s29, s28
  s_add_u32 m0, s25, 0
  v_mfma_f32_16x16x32_bf16 v[32:35], a[136:139], v[88:91], v[32:35]
  buffer_load_dwordx4 v13, s[12:15], s28 offen offset:0 nt lds
  v_mfma_f32_16x16x32_bf16 v[32:35], a[140:143], v[92:95], v[32:35]
  v_exp_f32 v40, v40
  v_mfma_f32_16x16x32_bf16 v[36:39], a[144:147], v[80:83], v[56:59]
  v_exp_f32 v41, v41
  v_mfma_f32_16x16x32_bf16 v[36:39], a[148:151], v[84:87], v[36:39]
  v_exp_f32 v42, v42
  v_mfma_f32_16x16x32_bf16 v[36:39], a[152:155], v[88:91], v[36:39]
  v_exp_f32 v43, v43
  v_mfma_f32_16x16x32_bf16 v[36:39], a[156:159], v[92:95], v[36:39]
  v_cvt_pk_bf16_f32 v52, v40, v41
  v_cvt_pk_bf16_f32 v53, v42, v43
  v_mfma_f32_16x16x32_bf16 v[176:179], a[160:163], v[48:51], v[176:179]
  v_exp_f32 v44, v44
  v_mfma_f32_16x16x32_bf16 v[180:183], a[164:167], v[48:51], v[180:183]
  v_exp_f32 v45, v45
  v_mfma_f32_16x16x32_bf16 v[184:187], a[168:171], v[48:51], v[184:187]
  v_exp_f32 v46, v46
  v_mfma_f32_16x16x32_bf16 v[188:191], a[172:175], v[48:51], v[188:191]
  v_exp_f32 v47, v47
  v_mfma_f32_16x16x32_bf16 v[192:195], a[176:179], v[48:51], v[192:195]
  v_cvt_pk_bf16_f32 v54, v44, v45
  v_cvt_pk_bf16_f32 v55, v46, v47
  v_mfma_f32_16x16x32_bf16 v[196:199], a[180:183], v[48:51], v[196:199]
  v_exp_f32 v32, v32
  v_mfma_f32_16x16x32_bf16 v[200:203], a[184:187], v[48:51], v[200:203]
  v_exp_f32 v33, v33
  v_mfma_f32_16x16x32_bf16 v[204:207], a[188:191], v[48:51], v[204:207]
  v_mfma_f32_16x16x32_bf16 a[208:211], a[216:219], v[48:51], a[208:211]
  v_mfma_f32_16x16x32_bf16 v[40:43], a[128:131], v[96:99], v[60:63]
  v_exp_f32 v34, v34
  v_mfma_f32_16x16x32_bf16 v[40:43], a[132:135], v[100:103], v[40:43]
  v_exp_f32 v35, v35
  v_mfma_f32_16x16x32_bf16 v[40:43], a[136:139], v[104:107], v[40:43]
  v_cvt_pk_bf16_f32 v48, v32, v33
  v_cvt_pk_bf16_f32 v49, v34, v35
  v_mfma_f32_16x16x32_bf16 v[40:43], a[140:143], v[108:111], v[40:43]
  v_exp_f32 v36, v36
  v_mfma_f32_16x16x32_bf16 v[44:47], a[144:147], v[96:99], v[60:63]
  v_exp_f32 v37, v37
  v_mfma_f32_16x16x32_bf16 v[44:47], a[148:151], v[100:103], v[44:47]
  v_exp_f32 v38, v38
  v_mfma_f32_16x16x32_bf16 v[44:47], a[152:155], v[104:107], v[44:47]
  v_exp_f32 v39, v39
  v_mfma_f32_16x16x32_bf16 v[44:47], a[156:159], v[108:111], v[44:47]
  v_cvt_pk_bf16_f32 v50, v36, v37
  v_cvt_pk_bf16_f32 v51, v38, v39
  v_mfma_f32_16x16x32_bf16 v[208:211], a[160:163], v[52:55], v[208:211]
  ds_read_b64_tr_b16 a[160:161], v5 offset:16384
  ds_read_b64_tr_b16 a[162:163], v5 offset:20480
  v_mfma_f32_16x16x32_bf16 v[212:215], a[164:167], v[52:55], v[212:215]
  ds_read_b64_tr_b16 a[164:165], v6 offset:16384
  ds_read_b64_tr_b16 a[166:167], v6 offset:20480
  v_mfma_f32_16x16x32_bf16 v[216:219], a[168:171], v[52:55], v[216:219]
  ds_read_b64_tr_b16 a[168:169], v7 offset:16384
  ds_read_b64_tr_b16 a[170:171], v7 offset:20480
  v_mfma_f32_16x16x32_bf16 v[220:223], a[172:175], v[52:55], v[220:223]
  ds_read_b64_tr_b16 a[172:173], v8 offset:16384
  ds_read_b64_tr_b16 a[174:175], v8 offset:20480
  v_mfma_f32_16x16x32_bf16 v[224:227], a[176:179], v[52:55], v[224:227]
  ds_read_b64_tr_b16 a[176:177], v9 offset:16384
  ds_read_b64_tr_b16 a[178:179], v9 offset:20480
  v_mfma_f32_16x16x32_bf16 v[228:231], a[180:183], v[52:55], v[228:231]
  ds_read_b64_tr_b16 a[180:181], v10 offset:16384
  ds_read_b64_tr_b16 a[182:183], v10 offset:20480
  v_mfma_f32_16x16x32_bf16 v[232:235], a[184:187], v[52:55], v[232:235]
  ds_read_b64_tr_b16 a[184:185], v11 offset:16384
  ds_read_b64_tr_b16 a[186:187], v11 offset:20480
  v_mfma_f32_16x16x32_bf16 v[236:239], a[188:191], v[52:55], v[236:239]
  ds_read_b64_tr_b16 a[188:189], v12 offset:16384
  ds_read_b64_tr_b16 a[190:191], v12 offset:20480
  v_mfma_f32_16x16x32_bf16 a[212:215], a[216:219], v[52:55], a[212:215]
  v_mfma_f32_16x16x32_bf16 v[32:35], a[128:131], v[112:115], v[64:67]
  v_exp_f32 v40, v40
  v_mfma_f32_16x16x32_bf16 v[32:35], a[132:135], v[116:119], v[32:35]
  v_exp_f32 v41, v41
  v_mfma_f32_16x16x32_bf16 v[32:35], a[136:139], v[120:123], v[32:35]
  buffer_load_dwordx4 v14, s[12:15], s28 offen offset:1024 nt lds
  v_mfma_f32_16x16x32_bf16 v[32:35], a[140:143], v[124:127], v[32:35]
  v_exp_f32 v42, v42
  v_mfma_f32_16x16x32_bf16 v[36:39], a[144:147], v[112:115], v[64:67]
  v_exp_f32 v43, v43
  v_mfma_f32_16x16x32_bf16 v[36:39], a[148:151], v[116:119], v[36:39]
  v_cvt_pk_bf16_f32 v52, v40, v41
  v_cvt_pk_bf16_f32 v53, v42, v43
  v_mfma_f32_16x16x32_bf16 v[36:39], a[152:155], v[120:123], v[36:39]
  v_exp_f32 v44, v44
  v_mfma_f32_16x16x32_bf16 v[36:39], a[156:159], v[124:127], v[36:39]
  s_waitcnt lgkmcnt(0)
  v_mfma_f32_16x16x32_bf16 a[0:3], a[160:163], v[48:51], a[0:3]
  v_exp_f32 v45, v45
  v_mfma_f32_16x16x32_bf16 a[4:7], a[164:167], v[48:51], a[4:7]
  v_exp_f32 v46, v46
  v_mfma_f32_16x16x32_bf16 a[8:11], a[168:171], v[48:51], a[8:11]
  v_exp_f32 v47, v47
  v_mfma_f32_16x16x32_bf16 a[12:15], a[172:175], v[48:51], a[12:15]
  v_cvt_pk_bf16_f32 v54, v44, v45
  v_cvt_pk_bf16_f32 v55, v46, v47
  v_mfma_f32_16x16x32_bf16 a[16:19], a[176:179], v[48:51], a[16:19]
  v_mfma_f32_16x16x32_bf16 a[20:23], a[180:183], v[48:51], a[20:23]
  v_mfma_f32_16x16x32_bf16 a[24:27], a[184:187], v[48:51], a[24:27]
  v_mfma_f32_16x16x32_bf16 a[28:31], a[188:191], v[48:51], a[28:31]
  v_mfma_f32_16x16x32_bf16 a[192:195], a[216:219], v[48:51], a[192:195]
  v_mfma_f32_16x16x32_bf16 v[40:43], a[128:131], v[128:131], v[68:71]
  v_exp_f32 v32, v32
  v_mfma_f32_16x16x32_bf16 v[40:43], a[132:135], v[132:135], v[40:43]
  v_exp_f32 v33, v33
  v_mfma_f32_16x16x32_bf16 v[40:43], a[136:139], v[136:139], v[40:43]
  buffer_load_dwordx4 v15, s[12:15], s28 offen offset:2048 nt lds
  v_mfma_f32_16x16x32_bf16 v[40:43], a[140:143], v[140:143], v[40:43]
  v_exp_f32 v34, v34
  v_mfma_f32_16x16x32_bf16 v[44:47], a[144:147], v[128:131], v[68:71]
  v_exp_f32 v35, v35
  v_mfma_f32_16x16x32_bf16 v[44:47], a[148:151], v[132:135], v[44:47]
  v_cvt_pk_bf16_f32 v48, v32, v33
  v_cvt_pk_bf16_f32 v49, v34, v35
  v_mfma_f32_16x16x32_bf16 v[44:47], a[152:155], v[136:139], v[44:47]
  v_exp_f32 v36, v36
  v_mfma_f32_16x16x32_bf16 v[44:47], a[156:159], v[140:143], v[44:47]
  v_exp_f32 v37, v37
  v_mfma_f32_16x16x32_bf16 a[32:35], a[160:163], v[52:55], a[32:35]
  v_exp_f32 v38, v38
  v_mfma_f32_16x16x32_bf16 a[36:39], a[164:167], v[52:55], a[36:39]
  v_exp_f32 v39, v39
  v_mfma_f32_16x16x32_bf16 a[40:43], a[168:171], v[52:55], a[40:43]
  v_cvt_pk_bf16_f32 v50, v36, v37
  v_cvt_pk_bf16_f32 v51, v38, v39
  v_mfma_f32_16x16x32_bf16 a[44:47], a[172:175], v[52:55], a[44:47]
  v_mfma_f32_16x16x32_bf16 a[48:51], a[176:179], v[52:55], a[48:51]
  s_cmp_eq_u32 s30, s63
  s_cbranch_scc0 L_q1
  s_add_u32 s33, s62, 4096
  s_add_u32 m0, s65, 4096
  s_nop 0
  buffer_load_dwordx4 v13, s[8:11], s33 offen offset:0 nt lds
  buffer_load_dwordx4 v14, s[8:11], s33 offen offset:1024 nt lds
  buffer_load_dwordx4 v15, s[8:11], s33 offen offset:2048 nt lds
  buffer_load_dwordx4 v16, s[8:11], s33 offen offset:3072 nt lds
  s_add_u32 m0, s25, 0
L_q1:
  v_mfma_f32_16x16x32_bf16 a[52:55], a[180:183], v[52:55], a[52:55]
  v_mfma_f32_16x16x32_bf16 a[56:59], a[184:187], v[52:55], a[56:59]
  v_mfma_f32_16x16x32_bf16 a[60:63], a[188:191], v[52:55], a[60:63]
  v_mfma_f32_16x16x32_bf16 a[196:199], a[216:219], v[52:55], a[196:199]
  v_mfma_f32_16x16x32_bf16 v[32:35], a[128:131], v[144:147], v[72:75]
  v_exp_f32 v40, v40
  v_mfma_f32_16x16x32_bf16 v[32:35], a[132:135], v[148:151], v[32:35]
  v_exp_f32 v41, v41
  v_mfma_f32_16x16x32_bf16 v[32:35], a[136:139], v[152:155], v[32:35]
  buffer_load_dwordx4 v16, s[12:15], s28 offen offset:3072 nt lds
  v_mfma_f32_16x16x32_bf16 v[32:35], a[140:143], v[156:159], v[32:35]
  v_exp_f32 v42, v42
  v_mfma_f32_16x16x32_bf16 v[36:39], a[144:147], v[144:147], v[72:75]
  v_exp_f32 v43, v43
  v_mfma_f32_16x16x32_bf16 v[36:39], a[148:151], v[148:151], v[36:39]
  v_cvt_pk_bf16_f32 v52, v40, v41
  v_cvt_pk_bf16_f32 v53, v42, v43
  v_mfma_f32_16x16x32_bf16 v[36:39], a[152:155], v[152:155], v[36:39]
  v_exp_f32 v44, v44
  v_mfma_f32_16x16x32_bf16 v[36:39], a[156:159], v[156:159], v[36:39]
  v_exp_f32 v45, v45
  v_mfma_f32_16x16x32_bf16 a[64:67], a[160:163], v[48:51], a[64:67]
  v_exp_f32 v46, v46
  v_mfma_f32_16x16x32_bf16 a[68:71], a[164:167], v[48:51], a[68:71]
  v_exp_f32 v47, v47
  v_mfma_f32_16x16x32_bf16 a[72:75], a[168:171], v[48:51], a[72:75]
  v_cvt_pk_bf16_f32 v54, v44, v45
  v_cvt_pk_bf16_f32 v55, v46, v47
  v_mfma_f32_16x16x32_bf16 a[76:79], a[172:175], v[48:51], a[76:79]
  v_mfma_f32_16x16x32_bf16 a[80:83], a[176:179], v[48:51], a[80:83]
  v_mfma_f32_16x16x32_bf16 a[84:87], a[180:183], v[48:51], a[84:87]
  v_mfma_f32_16x16x32_bf16 a[88:91], a[184:187], v[48:51], a[88:91]
  v_mfma_f32_16x16x32_bf16 a[92:95], a[188:191], v[48:51], a[92:95]
  v_mfma_f32_16x16x32_bf16 a[200:203], a[216:219], v[48:51], a[200:203]
  v_mfma_f32_16x16x32_bf16 v[40:43], a[128:131], v[160:163], v[76:79]
  v_exp_f32 v32, v32
  v_mfma_f32_16x16x32_bf16 v[40:43], a[132:135], v[164:167], v[40:43]
  ds_read_b128 a[128:131], v1 offset:24576
  ds_read_b128 a[132:135], v2 offset:24576
  v_mfma_f32_16x16x32_bf16 v[40:43], a[136:139], v[168:171], v[40:43]
  v_exp_f32 v33, v33
  v_mfma_f32_16x16x32_bf16 v[40:43], a[140:143], v[172:175], v[40:43]
  ds_read_b128 a[136:139], v3 offset:24576
  ds_read_b128 a[140:143], v4 offset:24576
  v_mfma_f32_16x16x32_bf16 v[44:47], a[144:147], v[160:163], v[76:79]
  v_exp_f32 v34, v34
  v_mfma_f32_16x16x32_bf16 v[44:47], a[148:151], v[164:167], v[44:47]
  ds_read_b128 a[144:147], v1 offset:28672
  ds_read_b128 a[148:151], v2 offset:28672
  v_mfma_f32_16x16x32_bf16 v[44:47], a[152:155], v[168:171], v[44:47]
  v_exp_f32 v35, v35
  v_mfma_f32_16x16x32_bf16 v[44:47], a[156:159], v[172:175], v[44:47]
  ds_read_b128 a[152:155], v3 offset:28672
  ds_read_b128 a[156:159], v4 offset:28672
  v_mfma_f32_16x16x32_bf16 a[96:99], a[160:163], v[52:55], a[96:99]
  v_cvt_pk_bf16_f32 v48, v32, v33
  v_cvt_pk_bf16_f32 v49, v34, v35
  v_mfma_f32_16x16x32_bf16 a[100:103], a[164:167], v[52:55], a[100:103]
  v_exp_f32 v36, v36
  v_mfma_f32_16x16x32_bf16 a[104:107], a[168:171], v[52:55], a[104:107]
  v_exp_f32 v37, v37
  v_mfma_f32_16x16x32_bf16 a[108:111], a[172:175], v[52:55], a[108:111]
  v_exp_f32 v38, v38
  v_mfma_f32_16x16x32_bf16 a[112:115], a[176:179], v[52:55], a[112:115]
  v_exp_f32 v39, v39
  v_mfma_f32_16x16x32_bf16 a[116:119], a[180:183], v[52:55], a[116:119]
  v_cvt_pk_bf16_f32 v50, v36, v37
  v_cvt_pk_bf16_f32 v51, v38, v39
  v_mfma_f32_16x16x32_bf16 a[120:123], a[184:187], v[52:55], a[120:123]
  v_mfma_f32_16x16x32_bf16 a[124:127], a[188:191], v[52:55], a[124:127]
  v_mfma_f32_16x16x32_bf16 a[204:207], a[216:219], v[52:55], a[204:207]
  s_waitcnt lgkmcnt(0)
  v_mfma_f32_16x16x32_bf16 v[32:35], a[128:131], v[80:83], v[56:59]
  v_exp_f32 v40, v40
  v_mfma_f32_16x16x32_bf16 v[32:35], a[132:135], v[84:87], v[32:35]
  s_add_u32 m0, s25, 65536
  v_mfma_f32_16x16x32_bf16 v[32:35], a[136:139], v[88:91], v[32:35]
  buffer_load_dwordx4 v17, s[16:19], s28 offen offset:0 nt lds
  v_mfma_f32_16x16x32_bf16 v[32:35], a[140:143], v[92:95], v[32:35]
  v_exp_f32 v41, v41
  v_mfma_f32_16x16x32_bf16 v[36:39], a[144:147], v[80:83], v[56:59]
  v_exp_f32 v42, v42
  v_mfma_f32_16x16x32_bf16 v[36:39], a[148:151], v[84:87], v[36:39]
  v_exp_f32 v43, v43
  v_mfma_f32_16x16x32_bf16 v[36:39], a[152:155], v[88:91], v[36:39]
  v_cvt_pk_bf16_f32 v52, v40, v41
  v_cvt_pk_bf16_f32 v53, v42, v43
  v_mfma_f32_16x16x32_bf16 v[36:39], a[156:159], v[92:95], v[36:39]
  v_exp_f32 v44, v44
  v_mfma_f32_16x16x32_bf16 v[176:179], a[160:163], v[48:51], v[176:179]
  v_exp_f32 v45, v45
  v_mfma_f32_16x16x32_bf16 v[180:183], a[164:167], v[48:51], v[180:183]
  v_exp_f32 v46, v46
  v_mfma_f32_16x16x32_bf16 v[184:187], a[168:171], v[48:51], v[184:187]
  v_exp_f32 v47, v47
  v_mfma_f32_16x16x32_bf16 v[188:191], a[172:175], v[48:51], v[188:191]
  v_cvt_pk_bf16_f32 v54, v44, v45
  v_cvt_pk_bf16_f32 v55, v46, v47
  v_mfma_f32_16x16x32_bf16 v[192:195], a[176:179], v[48:51], v[192:195]
  v_exp_f32 v32, v32
  v_mfma_f32_16x16x32_bf16 v[196:199], a[180:183], v[48:51], v[196:199]
  v_exp_f32 v33, v33
  v_mfma_f32_16x16x32_bf16 v[200:203], a[184:187], v[48:51], v[200:203]
  v_mfma_f32_16x16x32_bf16 v[204:207], a[188:191], v[48:51], v[204:207]
  v_mfma_f32_16x16x32_bf16 a[208:211], a[216:219], v[48:51], a[208:211]
  v_mfma_f32_16x16x32_bf16 v[40:43], a[128:131], v[96:99], v[60:63]
  v_exp_f32 v34, v34
  v_mfma_f32_16x16x32_bf16 v[40:43], a[132:135], v[100:103], v[40:43]
  v_exp_f32 v35, v35
  v_mfma_f32_16x16x32_bf16 v[40:43], a[136:139], v[104:107], v[40:43]
  v_cvt_pk_bf16_f32 v48, v32, v33
  v_cvt_pk_bf16_f32 v49, v34, v35
  v_mfma_f32_16x16x32_bf16 v[40:43], a[140:143], v[108:111], v[40:43]
  v_exp_f32 v36, v36
  v_mfma_f32_16x16x32_bf16 v[44:47], a[144:147], v[96:99], v[60:63]
  v_exp_f32 v37, v37
  v_mfma_f32_16x16x32_bf16 v[44:47], a[148:151], v[100:103], v[44:47]
  v_exp_f32 v38, v38
  v_mfma_f32_16x16x32_bf16 v[44:47], a[152:155], v[104:107], v[44:47]
  v_exp_f32 v39, v39
  v_mfma_f32_16x16x32_bf16 v[44:47], a[156:159], v[108:111], v[44:47]
  v_cvt_pk_bf16_f32 v50, v36, v37
  v_cvt_pk_bf16_f32 v51, v38, v39
  v_mfma_f32_16x16x32_bf16 v[208:211], a[160:163], v[52:55], v[208:211]
  ds_read_b64_tr_b16 a[160:161], v5 offset:24576
  ds_read_b64_tr_b16 a[162:163], v5 offset:28672
  v_mfma_f32_16x16x32_bf16 v[212:215], a[164:167], v[52:55], v[212:215]
  ds_read_b64_tr_b16 a[164:165], v6 offset:24576
  ds_read_b64_tr_b16 a[166:167], v6 offset:28672
  v_mfma_f32_16x16x32_bf16 v[216:219], a[168:171], v[52:55], v[216:219]
  ds_read_b64_tr_b16 a[168:169], v7 offset:24576
  ds_read_b64_tr_b16 a[170:171], v7 offset:28672
  v_mfma_f32_16x16x32_bf16 v[220:223], a[172:175], v[52:55], v[220:223]
  ds_read_b64_tr_b16 a[172:173], v8 offset:24576
  ds_read_b64_tr_b16 a[174:175], v8 offset:28672
  v_mfma_f32_16x16x32_bf16 v[224:227], a[176:179], v[52:55], v[224:227]
  ds_read_b64_tr_b16 a[176:177], v9 offset:24576
  ds_read_b64_tr_b16 a[178:179], v9 offset:28672
  v_mfma_f32_16x16x32_bf16 v[228:231], a[180:183], v[52:55], v[228:231]
  ds_read_b64_tr_b16 a[180:181], v10 offset:24576
  ds_read_b64_tr_b16 a[182:183], v10 offset:28672
  v_mfma_f32_16x16x32_bf16 v[232:235], a[184:187], v[52:55], v[232:235]
  ds_read_b64_tr_b16 a[184:185], v11 offset:24576
  ds_read_b64_tr_b16 a[186:187], v11 offset:28672
  v_mfma_f32_16x16x32_bf16 v[236:239], a[188:191], v[52:55], v[236:239]
  ds_read_b64_tr_b16 a[188:189], v12 offset:24576
  ds_read_b64_tr_b16 a[190:191], v12 offset:28672
  v_mfma_f32_16x16x32_bf16 a[212:215], a[216:219], v[52:55], a[212:215]
  v_mfma_f32_16x16x32_bf16 v[32:35], a[128:131], v[112:115], v[64:67]
  v_exp_f32 v40, v40
  v_mfma_f32_16x16x32_bf16 v[32:35], a[132:135], v[116:119], v[32:35]
  v_exp_f32 v41, v41
  v_mfma_f32_16x16x32_bf16 v[32:35], a[136:139], v[120:123], v[32:35]
  buffer_load_dwordx4 v18, s[16:19], s28 offen offset:1024 nt lds
  v_mfma_f32_16x16x32_bf16 v[32:35], a[140:143], v[124:127], v[32:35]
  v_exp_f32 v42, v42
  v_mfma_f32_16x16x32_bf16 v[36:39], a[144:147], v[112:115], v[64:67]
  v_exp_f32 v43, v43
  v_mfma_f32_16x16x32_bf16 v[36:39], a[148:151], v[116:119], v[36:39]
  v_cvt_pk_bf16_f32 v52, v40, v41
  v_cvt_pk_bf16_f32 v53, v42, v43
  v_mfma_f32_16x16x32_bf16 v[36:39], a[152:155], v[120:123], v[36:39]
  v_exp_f32 v44, v44
  v_mfma_f32_16x16x32_bf16 v[36:39], a[156:159], v[124:127], v[36:39]
  s_waitcnt lgkmcnt(0)
  v_mfma_f32_16x16x32_bf16 a[0:3], a[160:163], v[48:51], a[0:3]
  v_exp_f32 v45, v45
  v_mfma_f32_16x16x32_bf16 a[4:7], a[164:167], v[48:51], a[4:7]
  v_exp_f32 v46, v46
  v_mfma_f32_16x16x32_bf16 a[8:11], a[168:171], v[48:51], a[8:11]
  v_exp_f32 v47, v47
  v_mfma_f32_16x16x32_bf16 a[12:15], a[172:175], v[48:51], a[12:15]
  v_cvt_pk_bf16_f32 v54, v44, v45
  v_cvt_pk_bf16_f32 v55, v46, v47
  v_mfma_f32_16x16x32_bf16 a[16:19], a[176:179], v[48:51], a[16:19]
  v_mfma_f32_16x16x32_bf16 a[20:23], a[180:183], v[48:51], a[20:23]
  v_mfma_f32_16x16x32_bf16 a[24:27], a[184:187], v[48:51], a[24:27]
  v_mfma_f32_16x16x32_bf16 a[28:31], a[188:191], v[48:51], a[28:31]
  v_mfma_f32_16x16x32_bf16 a[192:195], a[216:219], v[48:51], a[192:195]
  v_mfma_f32_16x16x32_bf16 v[40:43], a[128:131], v[128:131], v[68:71]
  v_exp_f32 v32, v32
  v_mfma_f32_16x16x32_bf16 v[40:43], a[132:135], v[132:135], v[40:43]
  v_exp_f32 v33, v33
  v_mfma_f32_16x16x32_bf16 v[40:43], a[136:139], v[136:139], v[40:43]
  buffer_load_dwordx4 v17, s[16:19], s28 offen offset:2048 nt lds
  v_mfma_f32_16x16x32_bf16 v[40:43], a[140:143], v[140:143], v[40:43]
  v_exp_f32 v34, v34
  v_mfma_f32_16x16x32_bf16 v[44:47], a[144:147], v[128:131], v[68:71]
  v_exp_f32 v35, v35
  v_mfma_f32_16x16x32_bf16 v[44:47], a[148:151], v[132:135], v[44:47]
  v_cvt_pk_bf16_f32 v48, v32, v33
  v_cvt_pk_bf16_f32 v49, v34, v35
  v_mfma_f32_16x16x32_bf16 v[44:47], a[152:155], v[136:139], v[44:47]
  v_exp_f32 v36, v36
  v_mfma_f32_16x16x32_bf16 v[44:47], a[156:159], v[140:143], v[44:47]
  v_exp_f32 v37, v37
  v_mfma_f32_16x16x32_bf16 a[32:35], a[160:163], v[52:55], a[32:35]
  v_exp_f32 v38, v38
  v_mfma_f32_16x16x32_bf16 a[36:39], a[164:167], v[52:55], a[36:39]
  v_exp_f32 v39, v39
  v_mfma_f32_16x16x32_bf16 a[40:43], a[168:171], v[52:55], a[40:43]
  v_cvt_pk_bf16_f32 v50, v36, v37
  v_cvt_pk_bf16_f32 v51, v38, v39
  v_mfma_f32_16x16x32_bf16 a[44:47], a[172:175], v[52:55], a[44:47]
  v_mfma_f32_16x16x32_bf16 a[48:51], a[176:179], v[52:55], a[48:51]
  v_mfma_f32_16x16x32_bf16 a[52:55], a[180:183], v[52:55], a[52:55]
  v_mfma_f32_16x16x32_bf16 a[56:59], a[184:187], v[52:55], a[56:59]
  v_mfma_f32_16x16x32_bf16 a[60:63], a[188:191], v[52:55], a[60:63]
  v_mfma_f32_16x16x32_bf16 a[196:199], a[216:219], v[52:55], a[196:199]
  v_mfma_f32_16x16x32_bf16 v[32:35], a[128:131], v[144:147], v[72:75]
  v_exp_f32 v40, v40
  v_mfma_f32_16x16x32_bf16 v[32:35], a[132:135], v[148:151], v[32:35]
  v_exp_f32 v41, v41
  v_mfma_f32_16x16x32_bf16 v[32:35], a[136:139], v[152:155], v[32:35]
  buffer_load_dwordx4 v18, s[16:19], s28 offen offset:3072 nt lds
  v_mfma_f32_16x16x32_bf16 v[32:35], a[140:143], v[156:159], v[32:35]
  v_exp_f32 v42, v42
  v_mfma_f32_16x16x32_bf16 v[36:39], a[144:147], v[144:147], v[72:75]
  v_exp_f32 v43, v43
  v_mfma_f32_16x16x32_bf16 v[36:39], a[148:151], v[148:151], v[36:39]
  v_cvt_pk_bf16_f32 v52, v40, v41
  v_cvt_pk_bf16_f32 v53, v42, v43
  v_mfma_f32_16x16x32_bf16 v[36:39], a[152:155], v[152:155], v[36:39]
  v_exp_f32 v44, v44
  v_mfma_f32_16x16x32_bf16 v[36:39], a[156:159], v[156:159], v[36:39]
  v_exp_f32 v45, v45
  v_mfma_f32_16x16x32_bf16 a[64:67], a[160:163], v[48:51], a[64:67]
  v_exp_f32 v46, v46
  v_mfma_f32_16x16x32_bf16 a[68:71], a[164:167], v[48:51], a[68:71]
  v_exp_f32 v47, v47
  v_mfma_f32_16x16x32_bf16 a[72:75], a[168:171], v[48:51], a[72:75]
  v_cvt_pk_bf16_f32 v54, v44, v45
  v_cvt_pk_bf16_f32 v55, v46, v47
  v_mfma_f32_16x16x32_bf16 a[76:79], a[172:175], v[48:51], a[76:79]
  v_mfma_f32_16x16x32_bf16 a[80:83], a[176:179], v[48:51], a[80:83]
  s_cmp_eq_u32 s30, s63
  s_cbranch_scc0 L_q2
  s_waitcnt vmcnt(5)
  s_add_u32 s48, s65, 0
  v_add_u32 v240, s48, v1
  v_add_u32 v241, s48, v2
  v_add_u32 v242, s48, v3
  v_add_u32 v243, s48, v4
  ds_read_b128 a[220:223], v240 offset:0
  ds_read_b128 a[224:227], v241 offset:0
  ds_read_b128 a[228:231], v242 offset:0
  ds_read_b128 a[232:235], v243 offset:0
  ds_read_b128 a[236:239], v240 offset:4096
  ds_read_b128 a[240:243], v241 offset:4096
  ds_read_b128 a[244:247], v242 offset:4096
  ds_read_b128 a[248:251], v243 offset:4096
L_q2:
  v_mfma_f32_16x16x32_bf16 a[84:87], a[180:183], v[48:51], a[84:87]
  v_mfma_f32_16x16x32_bf16 a[88:91], a[184:187], v[48:51], a[88:91]
  v_mfma_f32_16x16x32_bf16 a[92:95], a[188:191], v[48:51], a[92:95]
  v_mfma_f32_16x16x32_bf16 a[200:203], a[216:219], v[48:51], a[200:203]
  s_waitcnt vmcnt(16)
  s_barrier
  v_mfma_f32_16x16x32_bf16 v[40:43], a[128:131], v[160:163], v[76:79]
  v_exp_f32 v32, v32
  v_mfma_f32_16x16x32_bf16 v[40:43], a[132:135], v[164:167], v[40:43]
  ds_read_b128 a[128:131], v1 offset:32768
  ds_read_b128 a[132:135], v2 offset:32768
  v_mfma_f32_16x16x32_bf16 v[40:43], a[136:139], v[168:171], v[40:43]
  v_exp_f32 v33, v33
  v_mfma_f32_16x16x32_bf16 v[40:43], a[140:143], v[172:175], v[40:43]
  ds_read_b128 a[136:139], v3 offset:32768
  ds_read_b128 a[140:143], v4 offset:32768
  v_mfma_f32_16x16x32_bf16 v[44:47], a[144:147], v[160:163], v[76:79]
  v_exp_f32 v34, v34
  v_mfma_f32_16x16x32_bf16 v[44:47], a[148:151], v[164:167], v[44:47]
  ds_read_b128 a[144:147], v1 offset:36864
  ds_read_b128 a[148:151], v2 offset:36864
  v_mfma_f32_16x16x32_bf16 v[44:47], a[152:155], v[168:171], v[44:47]
  v_exp_f32 v35, v35
  v_mfma_f32_16x16x32_bf16 v[44:47], a[156:159], v[172:175], v[44:47]
  ds_read_b128 a[152:155], v3 offset:36864
  ds_read_b128 a[156:159], v4 offset:36864
  v_mfma_f32_16x16x32_bf16 a[96:99], a[160:163], v[52:55], a[96:99]
  v_cvt_pk_bf16_f32 v48, v32, v33
  v_cvt_pk_bf16_f32 v49, v34, v35
  v_mfma_f32_16x16x32_bf16 a[100:103], a[164:167], v[52:55], a[100:103]
  v_exp_f32 v36, v36
  v_mfma_f32_16x16x32_bf16 a[104:107], a[168:171], v[52:55], a[104:107]
  v_exp_f32 v37, v37
  v_mfma_f32_16x16x32_bf16 a[108:111], a[172:175], v[52:55], a[108:111]
  v_exp_f32 v38, v38
  v_mfma_f32_16x16x32_bf16 a[112:115], a[176:179], v[52:55], a[112:115]
  v_exp_f32 v39, v39
  v_mfma_f32_16x16x32_bf16 a[116:119], a[180:183], v[52:55], a[116:119]
  v_cvt_pk_bf16_f32 v50, v36, v37
  v_cvt_pk_bf16_f32 v51, v38, v39
  v_mfma_f32_16x16x32_bf16 a[120:123], a[184:187], v[52:55], a[120:123]
  v_mfma_f32_16x16x32_bf16 a[124:127], a[188:191], v[52:55], a[124:127]
  v_mfma_f32_16x16x32_bf16 a[204:207], a[216:219], v[52:55], a[204:207]
  s_waitcnt lgkmcnt(0)
  v_mfma_f32_16x16x32_bf16 v[32:35], a[128:131], v[80:83], v[56:59]
  s_add_u32 s28, s28, 16384
  v_mfma_f32_16x16x32_bf16 v[32:35], a[132:135], v[84:87], v[32:35]
  s_add_u32 m0, s25, 16384
  v_mfma_f32_16x16x32_bf16 v[32:35], a[136:139], v[88:91], v[32:35]
  buffer_load_dwordx4 v13, s[12:15], s28 offen offset:0 nt lds
  v_mfma_f32_16x16x32_bf16 v[32:35], a[140:143], v[92:95], v[32:35]
  v_exp_f32 v40, v40
  v_mfma_f32_16x16x32_bf16 v[36:39], a[144:147], v[80:83], v[56:59]
  v_exp_f32 v41, v41
  v_mfma_f32_16x16x32_bf16 v[36:39], a[148:151], v[84:87], v[36:39]
  v_exp_f32 v42, v42
  v_mfma_f32_16x16x32_bf16 v[36:39], a[152:155], v[88:91], v[36:39]
  v_exp_f32 v43, v43
  v_mfma_f32_16x16x32_bf16 v[36:39], a[156:159], v[92:95], v[36:39]
  v_cvt_pk_bf16_f32 v52, v40, v41
  v_cvt_pk_bf16_f32 v53, v42, v43
  v_mfma_f32_16x16x32_bf16 v[176:179], a[160:163], v[48:51], v[176:179]
  v_exp_f32 v44, v44
  v_mfma_f32_16x16x32_bf16 v[180:183], a[164:167], v[48:51], v[180:183]
  v_exp_f32 v45, v45
  v_mfma_f32_16x16x32_bf16 v[184:187], a[168:171], v[48:51], v[184:187]
  v_exp_f32 v46, v46
  v_mfma_f32_16x16x32_bf16 v[188:191], a[172:175], v[48:51], v[188:191]
  v_exp_f32 v47, v47
  v_mfma_f32_16x16x32_bf16 v[192:195], a[176:179], v[48:51], v[192:195]
  v_cvt_pk_bf16_f32 v54, v44, v45
  v_cvt_pk_bf16_f32 v55, v46, v47
  v_mfma_f32_16x16x32_bf16 v[196:199], a[180:183], v[48:51], v[196:199]
  v_exp_f32 v32, v32
  v_mfma_f32_16x16x32_bf16 v[200:203], a[184:187], v[48:51], v[200:203]
  v_exp_f32 v33, v33
  v_mfma_f32_16x16x32_bf16 v[204:207], a[188:191], v[48:51], v[204:207]
  v_mfma_f32_16x16x32_bf16 a[208:211], a[216:219], v[48:51], a[208:211]
L_body2:
  s_cmp_eq_u32 s30, s74
  s_cbranch_scc1 L_tail
  v_mfma_f32_16x16x32_bf16 v[40:43], a[128:131], v[96:99], v[60:63]
  v_exp_f32 v34, v34
  v_mfma_f32_16x16x32_bf16 v[40:43], a[132:135], v[100:103], v[40:43]
  v_exp_f32 v35, v35
  v_mfma_f32_16x16x32_bf16 v[40:43], a[136:139], v[104:107], v[40:43]
  v_cvt_pk_bf16_f32 v48, v32, v33
  v_cvt_pk_bf16_f32 v49, v34, v35
  v_mfma_f32_16x16x32_bf16 v[40:43], a[140:143], v[108:111], v[40:43]
  v_exp_f32 v36, v36
  v_mfma_f32_16x16x32_bf16 v[44:47], a[144:147], v[96:99], v[60:63]
  v_exp_f32 v37, v37
  v_mfma_f32_16x16x32_bf16 v[44:47], a[148:151], v[100:103], v[44:47]
  v_exp_f32 v38, v38
  v_mfma_f32_16x16x32_bf16 v[44:47], a[152:155], v[104:107], v[44:47]
  v_exp_f32 v39, v39
  v_mfma_f32_16x16x32_bf16 v[44:47], a[156:159], v[108:111], v[44:47]
  v_cvt_pk_bf16_f32 v50, v36, v37
  v_cvt_pk_bf16_f32 v51, v38, v39
  v_mfma_f32_16x16x32_bf16 v[208:211], a[160:163], v[52:55], v[208:211]
  ds_read_b64_tr_b16 a[160:161], v5 offset:32768
  ds_read_b64_tr_b16 a[162:163], v5 offset:36864
  v_mfma_f32_16x16x32_bf16 v[212:215], a[164:167], v[52:55], v[212:215]
  ds_read_b64_tr_b16 a[164:165], v6 offset:32768
  ds_read_b64_tr_b16 a[166:167], v6 offset:36864
  v_mfma_f32_16x16x32_bf16 v[216:219], a[168:171], v[52:55], v[216:219]
  ds_read_b64_tr_b16 a[168:169], v7 offset:32768
  ds_read_b64_tr_b16 a[170:171], v7 offset:36864
  v_mfma_f32_16x16x32_bf16 v[220:223], a[172:175], v[52:55], v[220:223]
  ds_read_b64_tr_b16 a[172:173], v8 offset:32768
  ds_read_b64_tr_b16 a[174:175], v8 offset:36864
  v_mfma_f32_16x16x32_bf16 v[224:227], a[176:179], v[52:55], v[224:227]
  ds_read_b64_tr_b16 a[176:177], v9 offset:32768
  ds_read_b64_tr_b16 a[178:179], v9 offset:36864
  v_mfma_f32_16x16x32_bf16 v[228:231], a[180:183], v[52:55], v[228:231]
  ds_read_b64_tr_b16 a[180:181], v10 offset:32768
  ds_read_b64_tr_b16 a[182:183], v10 offset:36864
  v_mfma_f32_16x16x32_bf16 v[232:235], a[184:187], v[52:55], v[232:235]
  ds_read_b64_tr_b16 a[184:185], v11 offset:32768
  ds_read_b64_tr_b16 a[186:187], v11 offset:36864
  v_mfma_f32_16x16x32_bf16 v[236:239], a[188:191], v[52:55], v[236:239]
  ds_read_b64_tr_b16 a[188:189], v12 offset:32768
  ds_read_b64_tr_b16 a[190:191], v12 offset:36864
  v_mfma_f32_16x16x32_bf16 a[212:215], a[216:219], v[52:55], a[212:215]
  v_mfma_f32_16x16x32_bf16 v[32:35], a[128:131], v[112:115], v[64:67]
  v_exp_f32 v40, v40
  v_mfma_f32_16x16x32_bf16 v[32:35], a[132:135], v[116:119], v[32:35]
  v_exp_f32 v41, v41
  v_mfma_f32_16x16x32_bf16 v[32:35], a[136:139], v[120:123], v[32:35]
  buffer_load_dwordx4 v14, s[12:15], s28 offen offset:1024 nt lds
  v_mfma_f32_16x16x32_bf16 v[32:35], a[140:143], v[124:127], v[32:35]
  v_exp_f32 v42, v42
  v_mfma_f32_16x16x32_bf16 v[36:39], a[144:147], v[112:115], v[64:67]
  v_exp_f32 v43, v43
  v_mfma_f32_16x16x32_bf16 v[36:39], a[148:151], v[116:119], v[36:39]
  v_cvt_pk_bf16_f32 v52, v40, v41
  v_cvt_pk_bf16_f32 v53, v42, v43
  v_mfma_f32_16x16x32_bf16 v[36:39], a[152:155], v[120:123], v[36:39]
  v_exp_f32 v44, v44
  v_mfma_f32_16x16x32_bf16 v[36:39], a[156:159], v[124:127], v[36:39]
  s_waitcnt lgkmcnt(0)
  v_mfma_f32_16x16x32_bf16 a[0:3], a[160:163], v[48:51], a[0:3]
  v_exp_f32 v45, v45
  v_mfma_f32_16x16x32_bf16 a[4:7], a[164:167], v[48:51], a[4:7]
  v_exp_f32 v46, v46
  v_mfma_f32_16x16x32_bf16 a[8:11], a[168:171], v[48:51], a[8:11]
  v_exp_f32 v47, v47
  v_mfma_f32_16x16x32_bf16 a[12:15], a[172:175], v[48:51], a[12:15]
  v_cvt_pk_bf16_f32 v54, v44, v45
  v_cvt_pk_bf16_f32 v55, v46, v47
  v_mfma_f32_16x16x32_bf16 a[16:19], a[176:179], v[48:51], a[16:19]
  v_mfma_f32_16x16x32_bf16 a[20:23], a[180:183], v[48:51], a[20:23]
  v_mfma_f32_16x16x32_bf16 a[24:27], a[184:187], v[48:51], a[24:27]
  v_mfma_f32_16x16x32_bf16 a[28:31], a[188:191], v[48:51], a[28:31]
  v_mfma_f32_16x16x32_bf16 a[192:195], a[216:219], v[48:51], a[192:195]
  v_mfma_f32_16x16x32_bf16 v[40:43], a[128:131], v[128:131], v[68:71]
  v_exp_f32 v32, v32
  v_mfma_f32_16x16x32_bf16 v[40:43], a[132:135], v[132:135], v[40:43]
  v_exp_f32 v33, v33
  v_mfma_f32_16x16x32_bf16 v[40:43], a[136:139], v[136:139], v[40:43]
  buffer_load_dwordx4 v15, s[12:15], s28 offen offset:2048 nt lds
  v_mfma_f32_16x16x32_bf16 v[40:43], a[140:143], v[140:143], v[40:43]
  v_exp_f32 v34, v34
  v_mfma_f32_16x16x32_bf16 v[44:47], a[144:147], v[128:131], v[68:71]
  v_exp_f32 v35, v35
  v_mfma_f32_16x16x32_bf16 v[44:47], a[148:151], v[132:135], v[44:47]
  v_cvt_pk_bf16_f32 v48, v32, v33
  v_cvt_pk_bf16_f32 v49, v34, v35
  v_mfma_f32_16x16x32_bf16 v[44:47], a[152:155], v[136:139], v[44:47]
  v_exp_f32 v36, v36
  v_mfma_f32_16x16x32_bf16 v[44:47], a[156:159], v[140:143], v[44:47]
  v_exp_f32 v37, v37
  v_mfma_f32_16x16x32_bf16 a[32:35], a[160:163], v[52:55], a[32:35]
  v_exp_f32 v38, v38
  v_mfma_f32_16x16x32_bf16 a[36:39], a[164:167], v[52:55], a[36:39]
  v_exp_f32 v39, v39
  v_mfma_f32_16x16x32_bf16 a[40:43], a[168:171], v[52:55], a[40:43]
  v_cvt_pk_bf16_f32 v50, v36, v37
  v_cvt_pk_bf16_f32 v51, v38, v39
  v_mfma_f32_16x16x32_bf16 a[44:47], a[172:175], v[52:55], a[44:47]
  v_mfma_f32_16x16x32_bf16 a[48:51], a[176:179], v[52:55], a[48:51]
  s_cmp_eq_u32 s30, s63
  s_cbranch_scc0 L_q3
  s_waitcnt lgkmcnt(15)
  s_add_u32 s33, s62, 8192
  s_add_u32 m0, s65, 0
  s_nop 0
  buffer_load_dwordx4 v13, s[8:11], s33 offen offset:0 nt lds
  buffer_load_dwordx4 v14, s[8:11], s33 offen offset:1024 nt lds
  buffer_load_dwordx4 v15, s[8:11], s33 offen offset:2048 nt lds
  buffer_load_dwordx4 v16, s[8:11], s33 offen offset:3072 nt lds
  s_add_u32 m0, s25, 16384
L_q3:
  v_mfma_f32_16x16x32_bf16 a[52:55], a[180:183], v[52:55], a[52:55]
  v_mfma_f32_16x16x32_bf16 a[56:59], a[184:187], v[52:55], a[56:59]
  v_mfma_f32_16x16x32_bf16 a[60:63], a[188:191], v[52:55], a[60:63]
  v_mfma_f32_16x16x32_bf16 a[196:199], a[216:219], v[52:55], a[196:199]
  v_mfma_f32_16x16x32_bf16 v[32:35], a[128:131], v[144:147], v[72:75]
  v_exp_f32 v40, v40
  v_mfma_f32_16x16x32_bf16 v[32:35], a[132:135], v[148:151], v[32:35]
  v_exp_f32 v41, v41
  v_mfma_f32_16x16x32_bf16 v[32:35], a[136:139], v[152:155], v[32:35]
  buffer_load_dwordx4 v16, s[12:15], s28 offen offset:3072 nt lds
  v_mfma_f32_16x16x32_bf16 v[32:35], a[140:143], v[156:159], v[32:35]
  v_exp_f32 v42, v42
  v_mfma_f32_16x16x32_bf16 v[36:39], a[144:147], v[144:147], v[72:75]
  v_exp_f32 v43, v43
  v_mfma_f32_16x16x32_bf16 v[36:39], a[148:151], v[148:151], v[36:39]
  v_cvt_pk_bf16_f32 v52, v40, v41
  v_cvt_pk_bf16_f32 v53, v42, v43
  v_mfma_f32_16x16x32_bf16 v[36:39], a[152:155], v[152:155], v[36:39]
  v_exp_f32 v44, v44
  v_mfma_f32_16x16x32_bf16 v[36:39], a[156:159], v[156:159], v[36:39]
  v_exp_f32 v45, v45
  v_mfma_f32_16x16x32_bf16 a[64:67], a[160:163], v[48:51], a[64:67]
  v_exp_f32 v46, v46
  v_mfma_f32_16x16x32_bf16 a[68:71], a[164:167], v[48:51], a[68:71]
  v_exp_f32 v47, v47
  v_mfma_f32_16x16x32_bf16 a[72:75], a[168:171], v[48:51], a[72:75]
  v_cvt_pk_bf16_f32 v54, v44, v45
  v_cvt_pk_bf16_f32 v55, v46, v47
  v_mfma_f32_16x16x32_bf16 a[76:79], a[172:175], v[48:51], a[76:79]
  v_mfma_f32_16x16x32_bf16 a[80:83], a[176:179], v[48:51], a[80:83]
  v_mfma_f32_16x16x32_bf16 a[84:87], a[180:183], v[48:51], a[84:87]
  v_mfma_f32_16x16x32_bf16 a[88:91], a[184:187], v[48:51], a[88:91]
  v_mfma_f32_16x16x32_bf16 a[92:95], a[188:191], v[48:51], a[92:95]
  v_mfma_f32_16x16x32_bf16 a[200:203], a[216:219], v[48:51], a[200:203]
  v_mfma_f32_16x16x32_bf16 v[40:43], a[128:131], v[160:163], v[76:79]
  v_exp_f32 v32, v32
  v_mfma_f32_16x16x32_bf16 v[40:43], a[132:135], v[164:167], v[40:43]
  ds_read_b128 a[128:131], v1 offset:40960
  ds_read_b128 a[132:135], v2 offset:40960
  v_mfma_f32_16x16x32_bf16 v[40:43], a[136:139], v[168:171], v[40:43]
  v_exp_f32 v33, v33
  v_mfma_f32_16x16x32_bf16 v[40:43], a[140:143], v[172:175], v[40:43]
  ds_read_b128 a[136:139], v3 offset:40960
  ds_read_b128 a[140:143], v4 offset:40960
  v_mfma_f32_16x16x32_bf16 v[44:47], a[144:147], v[160:163], v[76:79]
  v_exp_f32 v34, v34
  v_mfma_f32_16x16x32_bf16 v[44:47], a[148:151], v[164:167], v[44:47]
  ds_read_b128 a[144:147], v1 offset:45056
  ds_read_b128 a[148:151], v2 offset:45056
  v_mfma_f32_16x16x32_bf16 v[44:47], a[152:155], v[168:171], v[44:47]
  v_exp_f32 v35, v35
  v_mfma_f32_16x16x32_bf16 v[44:47], a[156:159], v[172:175], v[44:47]
  ds_read_b128 a[152:155], v3 offset:45056
  ds_read_b128 a[156:159], v4 offset:45056
  v_mfma_f32_16x16x32_bf16 a[96:99], a[160:163], v[52:55], a[96:99]
  v_cvt_pk_bf16_f32 v48, v32, v33
  v_cvt_pk_bf16_f32 v49, v34, v35
  v_mfma_f32_16x16x32_bf16 a[100:103], a[164:167], v[52:55], a[100:103]
  v_exp_f32 v36, v36
  v_mfma_f32_16x16x32_bf16 a[104:107], a[168:171], v[52:55], a[104:107]
  v_exp_f32 v37, v37
  v_mfma_f32_16x16x32_bf16 a[108:111], a[172:175], v[52:55], a[108:111]
  v_exp_f32 v38, v38
  v_mfma_f32_16x16x32_bf16 a[112:115], a[176:179], v[52:55], a[112:115]
  v_exp_f32 v39, v39
  v_mfma_f32_16x16x32_bf16 a[116:119], a[180:183], v[52:55], a[116:119]
  v_cvt_pk_bf16_f32 v50, v36, v37
  v_cvt_pk_bf16_f32 v51, v38, v39
  v_mfma_f32_16x16x32_bf16 a[120:123], a[184:187], v[52:55], a[120:123]
  v_mfma_f32_16x16x32_bf16 a[124:127], a[188:191], v[52:55], a[124:127]
  v_mfma_f32_16x16x32_bf16 a[204:207], a[216:219], v[52:55], a[204:207]
  s_waitcnt lgkmcnt(0)
  v_mfma_f32_16x16x32_bf16 v[32:35], a[128:131], v[80:83], v[56:59]
  v_exp_f32 v40, v40
  v_mfma_f32_16x16x32_bf16 v[32:35], a[132:135], v[84:87], v[32:35]
  s_add_u32 m0, s25, 81920
  v_mfma_f32_16x16x32_bf16 v[32:35], a[136:139], v[88:91], v[32:35]
  buffer_load_dwordx4 v17, s[16:19], s28 offen offset:0 nt lds
  v_mfma_f32_16x16x32_bf16 v[32:35], a[140:143], v[92:95], v[32:35]
  v_exp_f32 v41, v41
  v_mfma_f32_16x16x32_bf16 v[36:39], a[144:147], v[80:83], v[56:59]
  v_exp_f32 v42, v42
  v_mfma_f32_16x16x32_bf16 v[36:39], a[148:151], v[84:87], v[36:39]
  v_exp_f32 v43, v43
  v_mfma_f32_16x16x32_bf16 v[36:39], a[152:155], v[88:91], v[36:39]
  v_cvt_pk_bf16_f32 v52, v40, v41
  v_cvt_pk_bf16_f32 v53, v42, v43
  v_mfma_f32_16x16x32_bf16 v[36:39], a[156:159], v[92:95], v[36:39]
  v_exp_f32 v44, v44
  v_mfma_f32_16x16x32_bf16 v[176:179], a[160:163], v[48:51], v[176:179]
  v_exp_f32 v45, v45
  v_mfma_f32_16x16x32_bf16 v[180:183], a[164:167], v[48:51], v[180:183]
  v_exp_f32 v46, v46
  v_mfma_f32_16x16x32_bf16 v[184:187], a[168:171], v[48:51], v[184:187]
  v_exp_f32 v47, v47
  v_mfma_f32_16x16x32_bf16 v[188:191], a[172:175], v[48:51], v[188:191]
  v_cvt_pk_bf16_f32 v54, v44, v45
  v_cvt_pk_bf16_f32 v55, v46, v47
  v_mfma_f32_16x16x32_bf16 v[192:195], a[176:179], v[48:51], v[192:195]
  v_exp_f32 v32, v32
  v_mfma_f32_16x16x32_bf16 v[196:199], a[180:183], v[48:51], v[196:199]
  v_exp_f32 v33, v33
  v_mfma_f32_16x16x32_bf16 v[200:203], a[184:187], v[48:51], v[200:203]
  v_mfma_f32_16x16x32_bf16 v[204:207], a[188:191], v[48:51], v[204:207]
  v_mfma_f32_16x16x32_bf16 a[208:211], a[216:219], v[48:51], a[208:211]
  v_mfma_f32_16x16x32_bf16 v[40:43], a[128:131], v[96:99], v[60:63]
  v_exp_f32 v34, v34
  v_mfma_f32_16x16x32_bf16 v[40:43], a[132:135], v[100:103], v[40:43]
  v_exp_f32 v35, v35
  v_mfma_f32_16x16x32_bf16 v[40:43], a[136:139], v[104:107], v[40:43]
  v_cvt_pk_bf16_f32 v48, v32, v33
  v_cvt_pk_bf16_f32 v49, v34, v35
  v_mfma_f32_16x16x32_bf16 v[40:43], a[140:143], v[108:111], v[40:43]
  v_exp_f32 v36, v36
  v_mfma_f32_16x16x32_bf16 v[44:47], a[144:147], v[96:99], v[60:63]
  v_exp_f32 v37, v37
  v_mfma_f32_16x16x32_bf16 v[44:47], a[148:151], v[100:103], v[44:47]
  v_exp_f32 v38, v38
  v_mfma_f32_16x16x32_bf16 v[44:47], a[152:155], v[104:107], v[44:47]
  v_exp_f32 v39, v39
  v_mfma_f32_16x16x32_bf16 v[44:47], a[156:159], v[108:111], v[44:47]
  v_cvt_pk_bf16_f32 v50, v36, v37
  v_cvt_pk_bf16_f32 v51, v38, v39
  v_mfma_f32_16x16x32_bf16 v[208:211], a[160:163], v[52:55], v[208:211]
  ds_read_b64_tr_b16 a[160:161], v5 offset:40960
  ds_read_b64_tr_b16 a[162:163], v5 offset:45056
  v_mfma_f32_16x16x32_bf16 v[212:215], a[164:167], v[52:55], v[212:215]
  ds_read_b64_tr_b16 a[164:165], v6 offset:40960
  ds_read_b64_tr_b16 a[166:167], v6 offset:45056
  v_mfma_f32_16x16x32_bf16 v[216:219], a[168:171], v[52:55], v[216:219]
  ds_read_b64_tr_b16 a[168:169], v7 offset:40960
  ds_read_b64_tr_b16 a[170:171], v7 offset:45056
  v_mfma_f32_16x16x32_bf16 v[220:223], a[172:175], v[52:55], v[220:223]
  ds_read_b64_tr_b16 a[172:173], v8 offset:40960
  ds_read_b64_tr_b16 a[174:175], v8 offset:45056
  v_mfma_f32_16x16x32_bf16 v[224:227], a[176:179], v[52:55], v[224:227]
  ds_read_b64_tr_b16 a[176:177], v9 offset:40960
  ds_read_b64_tr_b16 a[178:179], v9 offset:45056
  v_mfma_f32_16x16x32_bf16 v[228:231], a[180:183], v[52:55], v[228:231]
  ds_read_b64_tr_b16 a[180:181], v10 offset:40960
  ds_read_b64_tr_b16 a[182:183], v10 offset:45056
  v_mfma_f32_16x16x32_bf16 v[232:235], a[184:187], v[52:55], v[232:235]
  ds_read_b64_tr_b16 a[184:185], v11 offset:40960
  ds_read_b64_tr_b16 a[186:187], v11 offset:45056
  v_mfma_f32_16x16x32_bf16 v[236:239], a[188:191], v[52:55], v[236:239]
  ds_read_b64_tr_b16 a[188:189], v12 offset:40960
  ds_read_b64_tr_b16 a[190:191], v12 offset:45056
  v_mfma_f32_16x16x32_bf16 a[212:215], a[216:219], v[52:55], a[212:215]
  v_mfma_f32_16x16x32_bf16 v[32:35], a[128:131], v[112:115], v[64:67]
  v_exp_f32 v40, v40
  v_mfma_f32_16x16x32_bf16 v[32:35], a[132:135], v[116:119], v[32:35]
  v_exp_f32 v41, v41
  v_mfma_f32_16x16x32_bf16 v[32:35], a[136:139], v[120:123], v[32:35]
  buffer_load_dwordx4 v18, s[16:19], s28 offen offset:1024 nt lds
  v_mfma_f32_16x16x32_bf16 v[32:35], a[140:143], v[124:127], v[32:35]
  v_exp_f32 v42, v42
  v_mfma_f32_16x16x32_bf16 v[36:39], a[144:147], v[112:115], v[64:67]
  v_exp_f32 v43, v43
  v_mfma_f32_16x16x32_bf16 v[36:39], a[148:151], v[116:119], v[36:39]
  v_cvt_pk_bf16_f32 v52, v40, v41
  v_cvt_pk_bf16_f32 v53, v42, v43
  v_mfma_f32_16x16x32_bf16 v[36:39], a[152:155], v[120:123], v[36:39]
  v_exp_f32 v44, v44
  v_mfma_f32_16x16x32_bf16 v[36:39], a[156:159], v[124:127], v[36:39]
  s_waitcnt lgkmcnt(0)
  v_mfma_f32_16x16x32_bf16 a[0:3], a[160:163], v[48:51], a[0:3]
  v_exp_f32 v45, v45
  v_mfma_f32_16x16x32_bf16 a[4:7], a[164:167], v[48:51], a[4:7]
  v_exp_f32 v46, v46
  v_mfma_f32_16x16x32_bf16 a[8:11], a[168:171], v[48:51], a[8:11]
  v_exp_f32 v47, v47
  v_mfma_f32_16x16x32_bf16 a[12:15], a[172:175], v[48:51], a[12:15]
  v_cvt_pk_bf16_f32 v54, v44, v45
  v_cvt_pk_bf16_f32 v55, v46, v47
  v_mfma_f32_16x16x32_bf16 a[16:19], a[176:179], v[48:51], a[16:19]
  v_mfma_f32_16x16x32_bf16 a[20:23], a[180:183], v[48:51], a[20:23]
  v_mfma_f32_16x16x32_bf16 a[24:27], a[184:187], v[48:51], a[24:27]
  v_mfma_f32_16x16x32_bf16 a[28:31], a[188:191], v[48:51], a[28:31]
  v_mfma_f32_16x16x32_bf16 a[192:195], a[216:219], v[48:51], a[192:195]
  v_mfma_f32_16x16x32_bf16 v[40:43], a[128:131], v[128:131], v[68:71]
  v_exp_f32 v32, v32
  v_mfma_f32_16x16x32_bf16 v[40:43], a[132:135], v[132:135], v[40:43]
  v_exp_f32 v33, v33
  v_mfma_f32_16x16x32_bf16 v[40:43], a[136:139], v[136:139], v[40:43]
  buffer_load_dwordx4 v17, s[16:19], s28 offen offset:2048 nt lds
  v_mfma_f32_16x16x32_bf16 v[40:43], a[140:143], v[140:143], v[40:43]
  v_exp_f32 v34, v34
  v_mfma_f32_16x16x32_bf16 v[44:47], a[144:147], v[128:131], v[68:71]
  v_exp_f32 v35, v35
  v_mfma_f32_16x16x32_bf16 v[44:47], a[148:151], v[132:135], v[44:47]
  v_cvt_pk_bf16_f32 v48, v32, v33
  v_cvt_pk_bf16_f32 v49, v34, v35
  v_mfma_f32_16x16x32_bf16 v[44:47], a[152:155], v[136:139], v[44:47]
  v_exp_f32 v36, v36
  v_mfma_f32_16x16x32_bf16 v[44:47], a[156:159], v[140:143], v[44:47]
  v_exp_f32 v37, v37
  v_mfma_f32_16x16x32_bf16 a[32:35], a[160:163], v[52:55], a[32:35]
  v_exp_f32 v38, v38
  v_mfma_f32_16x16x32_bf16 a[36:39], a[164:167], v[52:55], a[36:39]
  v_exp_f32 v39, v39
  v_mfma_f32_16x16x32_bf16 a[40:43], a[168:171], v[52:55], a[40:43]
  v_cvt_pk_bf16_f32 v50, v36, v37
  v_cvt_pk_bf16_f32 v51, v38, v39
  v_mfma_f32_16x16x32_bf16 a[44:47], a[172:175], v[52:55], a[44:47]
  v_mfma_f32_16x16x32_bf16 a[48:51], a[176:179], v[52:55], a[48:51]
  s_cmp_eq_u32 s30, s63
  s_cbranch_scc0 L_q4
  s_add_u32 s33, s62, 12288
  s_add_u32 m0, s65, 4096
  s_nop 0
  buffer_load_dwordx4 v13, s[8:11], s33 offen offset:0 nt lds
  buffer_load_dwordx4 v14, s[8:11], s33 offen offset:1024 nt lds
  buffer_load_dwordx4 v15, s[8:11], s33 offen offset:2048 nt lds
  buffer_load_dwordx4 v16, s[8:11], s33 offen offset:3072 nt lds
  s_add_u32 m0, s25, 81920
L_q4:
  v_mfma_f32_16x16x32_bf16 a[52:55], a[180:183], v[52:55], a[52:55]
  v_mfma_f32_16x16x32_bf16 a[56:59], a[184:187], v[52:55], a[56:59]
  v_mfma_f32_16x16x32_bf16 a[60:63], a[188:191], v[52:55], a[60:63]
  v_mfma_f32_16x16x32_bf16 a[196:199], a[216:219], v[52:55], a[196:199]
  v_mfma_f32_16x16x32_bf16 v[32:35], a[128:131], v[144:147], v[72:75]
  v_exp_f32 v40, v40
  v_mfma_f32_16x16x32_bf16 v[32:35], a[132:135], v[148:151], v[32:35]
  v_exp_f32 v41, v41
  v_mfma_f32_16x16x32_bf16 v[32:35], a[136:139], v[152:155], v[32:35]
  buffer_load_dwordx4 v18, s[16:19], s28 offen offset:3072 nt lds
  v_mfma_f32_16x16x32_bf16 v[32:35], a[140:143], v[156:159], v[32:35]
  v_exp_f32 v42, v42
  v_mfma_f32_16x16x32_bf16 v[36:39], a[144:147], v[144:147], v[72:75]
  v_exp_f32 v43, v43
  v_mfma_f32_16x16x32_bf16 v[36:39], a[148:151], v[148:151], v[36:39]
  v_cvt_pk_bf16_f32 v52, v40, v41
  v_cvt_pk_bf16_f32 v53, v42, v43
  v_mfma_f32_16x16x32_bf16 v[36:39], a[152:155], v[152:155], v[36:39]
  v_exp_f32 v44, v44
  v_mfma_f32_16x16x32_bf16 v[36:39], a[156:159], v[156:159], v[36:39]
  v_exp_f32 v45, v45
  v_mfma_f32_16x16x32_bf16 a[64:67], a[160:163], v[48:51], a[64:67]
  v_exp_f32 v46, v46
  v_mfma_f32_16x16x32_bf16 a[68:71], a[164:167], v[48:51], a[68:71]
  v_exp_f32 v47, v47
  v_mfma_f32_16x16x32_bf16 a[72:75], a[168:171], v[48:51], a[72:75]
  v_cvt_pk_bf16_f32 v54, v44, v45
  v_cvt_pk_bf16_f32 v55, v46, v47
  v_mfma_f32_16x16x32_bf16 a[76:79], a[172:175], v[48:51], a[76:79]
  v_mfma_f32_16x16x32_bf16 a[80:83], a[176:179], v[48:51], a[80:83]
  v_mfma_f32_16x16x32_bf16 a[84:87], a[180:183], v[48:51], a[84:87]
  v_mfma_f32_16x16x32_bf16 a[88:91], a[184:187], v[48:51], a[88:91]
  v_mfma_f32_16x16x32_bf16 a[92:95], a[188:191], v[48:51], a[92:95]
  v_mfma_f32_16x16x32_bf16 a[200:203], a[216:219], v[48:51], a[200:203]
  s_waitcnt vmcnt(16)
  s_barrier
  v_mfma_f32_16x16x32_bf16 v[40:43], a[128:131], v[160:163], v[76:79]
  v_exp_f32 v32, v32
  v_mfma_f32_16x16x32_bf16 v[40:43], a[132:135], v[164:167], v[40:43]
  ds_read_b128 a[128:131], v1 offset:49152
  ds_read_b128 a[132:135], v2 offset:49152
  v_mfma_f32_16x16x32_bf16 v[40:43], a[136:139], v[168:171], v[40:43]
  v_exp_f32 v33, v33
  v_mfma_f32_16x16x32_bf16 v[40:43], a[140:143], v[172:175], v[40:43]
  ds_read_b128 a[136:139], v3 offset:49152
  ds_read_b128 a[140:143], v4 offset:49152
  v_mfma_f32_16x16x32_bf16 v[44:47], a[144:147], v[160:163], v[76:79]
  v_exp_f32 v34, v34
  v_mfma_f32_16x16x32_bf16 v[44:47], a[148:151], v[164:167], v[44:47]
  ds_read_b128 a[144:147], v1 offset:53248
  ds_read_b128 a[148:151], v2 offset:53248
  v_mfma_f32_16x16x32_bf16 v[44:47], a[152:155], v[168:171], v[44:47]
  v_exp_f32 v35, v35
  v_mfma_f32_16x16x32_bf16 v[44:47], a[156:159], v[172:175], v[44:47]
  ds_read_b128 a[152:155], v3 offset:53248
  ds_read_b128 a[156:159], v4 offset:53248
  v_mfma_f32_16x16x32_bf16 a[96:99], a[160:163], v[52:55], a[96:99]
  v_cvt_pk_bf16_f32 v48, v32, v33
  v_cvt_pk_bf16_f32 v49, v34, v35
  v_mfma_f32_16x16x32_bf16 a[100:103], a[164:167], v[52:55], a[100:103]
  v_exp_f32 v36, v36
  v_mfma_f32_16x16x32_bf16 a[104:107], a[168:171], v[52:55], a[104:107]
  v_exp_f32 v37, v37
  v_mfma_f32_16x16x32_bf16 a[108:111], a[172:175], v[52:55], a[108:111]
  v_exp_f32 v38, v38
  v_mfma_f32_16x16x32_bf16 a[112:115], a[176:179], v[52:55], a[112:115]
  v_exp_f32 v39, v39
  v_mfma_f32_16x16x32_bf16 a[116:119], a[180:183], v[52:55], a[116:119]
  v_cvt_pk_bf16_f32 v50, v36, v37
  v_cvt_pk_bf16_f32 v51, v38, v39
  v_mfma_f32_16x16x32_bf16 a[120:123], a[184:187], v[52:55], a[120:123]
  v_mfma_f32_16x16x32_bf16 a[124:127], a[188:191], v[52:55], a[124:127]
  v_mfma_f32_16x16x32_bf16 a[204:207], a[216:219], v[52:55], a[204:207]
  s_waitcnt lgkmcnt(0)
  v_mfma_f32_16x16x32_bf16 v[32:35], a[128:131], v[80:83], v[56:59]
  s_add_u32 s28, s28, 16384
  v_mfma_f32_16x16x32_bf16 v[32:35], a[132:135], v[84:87], v[32:35]
  s_add_u32 m0, s25, 32768
  v_mfma_f32_16x16x32_bf16 v[32:35], a[136:139], v[88:91], v[32:35]
  buffer_load_dwordx4 v13, s[12:15], s28 offen offset:0 nt lds
  v_mfma_f32_16x16x32_bf16 v[32:35], a[140:143], v[92:95], v[32:35]
  v_exp_f32 v40, v40
  v_mfma_f32_16x16x32_bf16 v[36:39], a[144:147], v[80:83], v[56:59]
  v_exp_f32 v41, v41
  v_mfma_f32_16x16x32_bf16 v[36:39], a[148:151], v[84:87], v[36:39]
  v_exp_f32 v42, v42
  v_mfma_f32_16x16x32_bf16 v[36:39], a[152:155], v[88:91], v[36:39]
  v_exp_f32 v43, v43
  v_mfma_f32_16x16x32_bf16 v[36:39], a[156:159], v[92:95], v[36:39]
  v_cvt_pk_bf16_f32 v52, v40, v41
  v_cvt_pk_bf16_f32 v53, v42, v43
  v_mfma_f32_16x16x32_bf16 v[176:179], a[160:163], v[48:51], v[176:179]
  v_exp_f32 v44, v44
  v_mfma_f32_16x16x32_bf16 v[180:183], a[164:167], v[48:51], v[180:183]
  v_exp_f32 v45, v45
  v_mfma_f32_16x16x32_bf16 v[184:187], a[168:171], v[48:51], v[184:187]
  v_exp_f32 v46, v46
  v_mfma_f32_16x16x32_bf16 v[188:191], a[172:175], v[48:51], v[188:191]
  v_exp_f32 v47, v47
  v_mfma_f32_16x16x32_bf16 v[192:195], a[176:179], v[48:51], v[192:195]
  v_cvt_pk_bf16_f32 v54, v44, v45
  v_cvt_pk_bf16_f32 v55, v46, v47
  v_mfma_f32_16x16x32_bf16 v[196:199], a[180:183], v[48:51], v[196:199]
  v_exp_f32 v32, v32
  v_mfma_f32_16x16x32_bf16 v[200:203], a[184:187], v[48:51], v[200:203]
  v_exp_f32 v33, v33
  v_mfma_f32_16x16x32_bf16 v[204:207], a[188:191], v[48:51], v[204:207]
  v_mfma_f32_16x16x32_bf16 a[208:211], a[216:219], v[48:51], a[208:211]
  v_mfma_f32_16x16x32_bf16 v[40:43], a[128:131], v[96:99], v[60:63]
  v_exp_f32 v34, v34
  v_mfma_f32_16x16x32_bf16 v[40:43], a[132:135], v[100:103], v[40:43]
  v_exp_f32 v35, v35
  v_mfma_f32_16x16x32_bf16 v[40:43], a[136:139], v[104:107], v[40:43]
  v_cvt_pk_bf16_f32 v48, v32, v33
  v_cvt_pk_bf16_f32 v49, v34, v35
  v_mfma_f32_16x16x32_bf16 v[40:43], a[140:143], v[108:111], v[40:43]
  v_exp_f32 v36, v36
  v_mfma_f32_16x16x32_bf16 v[44:47], a[144:147], v[96:99], v[60:63]
  v_exp_f32 v37, v37
  v_mfma_f32_16x16x32_bf16 v[44:47], a[148:151], v[100:103], v[44:47]
  v_exp_f32 v38, v38
  v_mfma_f32_16x16x32_bf16 v[44:47], a[152:155], v[104:107], v[44:47]
  v_exp_f32 v39, v39
  v_mfma_f32_16x16x32_bf16 v[44:47], a[156:159], v[108:111], v[44:47]
  v_cvt_pk_bf16_f32 v50, v36, v37
  v_cvt_pk_bf16_f32 v51, v38, v39
  v_mfma_f32_16x16x32_bf16 v[208:211], a[160:163], v[52:55], v[208:211]
  ds_read_b64_tr_b16 a[160:161], v5 offset:49152
  ds_read_b64_tr_b16 a[162:163], v5 offset:53248
  v_mfma_f32_16x16x32_bf16 v[212:215], a[164:167], v[52:55], v[212:215]
  ds_read_b64_tr_b16 a[164:165], v6 offset:49152
  ds_read_b64_tr_b16 a[166:167], v6 offset:53248
  v_mfma_f32_16x16x32_bf16 v[216:219], a[168:171], v[52:55], v[216:219]
  ds_read_b64_tr_b16 a[168:169], v7 offset:49152
  ds_read_b64_tr_b16 a[170:171], v7 offset:53248
  v_mfma_f32_16x16x32_bf16 v[220:223], a[172:175], v[52:55], v[220:223]
  ds_read_b64_tr_b16 a[172:173], v8 offset:49152
  ds_read_b64_tr_b16 a[174:175], v8 offset:53248
  v_mfma_f32_16x16x32_bf16 v[224:227], a[176:179], v[52:55], v[224:227]
  ds_read_b64_tr_b16 a[176:177], v9 offset:49152
  ds_read_b64_tr_b16 a[178:179], v9 offset:53248
  v_mfma_f32_16x16x32_bf16 v[228:231], a[180:183], v[52:55], v[228:231]
  ds_read_b64_tr_b16 a[180:181], v10 offset:49152
  ds_read_b64_tr_b16 a[182:183], v10 offset:53248
  v_mfma_f32_16x16x32_bf16 v[232:235], a[184:187], v[52:55], v[232:235]
  ds_read_b64_tr_b16 a[184:185], v11 offset:49152
  ds_read_b64_tr_b16 a[186:187], v11 offset:53248
  v_mfma_f32_16x16x32_bf16 v[236:239], a[188:191], v[52:55], v[236:239]
  ds_read_b64_tr_b16 a[188:189], v12 offset:49152
  ds_read_b64_tr_b16 a[190:191], v12 offset:53248
  v_mfma_f32_16x16x32_bf16 a[212:215], a[216:219], v[52:55], a[212:215]
  v_mfma_f32_16x16x32_bf16 v[32:35], a[128:131], v[112:115], v[64:67]
  v_exp_f32 v40, v40
  v_mfma_f32_16x16x32_bf16 v[32:35], a[132:135], v[116:119], v[32:35]
  v_exp_f32 v41, v41
  v_mfma_f32_16x16x32_bf16 v[32:35], a[136:139], v[120:123], v[32:35]
  buffer_load_dwordx4 v14, s[12:15], s28 offen offset:1024 nt lds
  v_mfma_f32_16x16x32_bf16 v[32:35], a[140:143], v[124:127], v[32:35]
  v_exp_f32 v42, v42
  v_mfma_f32_16x16x32_bf16 v[36:39], a[144:147], v[112:115], v[64:67]
  v_exp_f32 v43, v43
  v_mfma_f32_16x16x32_bf16 v[36:39], a[148:151], v[116:119], v[36:39]
  v_cvt_pk_bf16_f32 v52, v40, v41
  v_cvt_pk_bf16_f32 v53, v42, v43
  v_mfma_f32_16x16x32_bf16 v[36:39], a[152:155], v[120:123], v[36:39]
  v_exp_f32 v44, v44
  v_mfma_f32_16x16x32_bf16 v[36:39], a[156:159], v[124:127], v[36:39]
  s_waitcnt lgkmcnt(0)
  v_mfma_f32_16x16x32_bf16 a[0:3], a[160:163], v[48:51], a[0:3]
  v_exp_f32 v45, v45
  v_mfma_f32_16x16x32_bf16 a[4:7], a[164:167], v[48:51], a[4:7]
  v_exp_f32 v46, v46
  v_mfma_f32_16x16x32_bf16 a[8:11], a[168:171], v[48:51], a[8:11]
  v_exp_f32 v47, v47
  v_mfma_f32_16x16x32_bf16 a[12:15], a[172:175], v[48:51], a[12:15]
  v_cvt_pk_bf16_f32 v54, v44, v45
  v_cvt_pk_bf16_f32 v55, v46, v47
  v_mfma_f32_16x16x32_bf16 a[16:19], a[176:179], v[48:51], a[16:19]
  v_mfma_f32_16x16x32_bf16 a[20:23], a[180:183], v[48:51], a[20:23]
  v_mfma_f32_16x16x32_bf16 a[24:27], a[184:187], v[48:51], a[24:27]
  v_mfma_f32_16x16x32_bf16 a[28:31], a[188:191], v[48:51], a[28:31]
  v_mfma_f32_16x16x32_bf16 a[192:195], a[216:219], v[48:51], a[192:195]
  v_mfma_f32_16x16x32_bf16 v[40:43], a[128:131], v[128:131], v[68:71]
  v_exp_f32 v32, v32
  v_mfma_f32_16x16x32_bf16 v[40:43], a[132:135], v[132:135], v[40:43]
  v_exp_f32 v33, v33
  v_mfma_f32_16x16x32_bf16 v[40:43], a[136:139], v[136:139], v[40:43]
  buffer_load_dwordx4 v15, s[12:15], s28 offen offset:2048 nt lds
  v_mfma_f32_16x16x32_bf16 v[40:43], a[140:143], v[140:143], v[40:43]
  v_exp_f32 v34, v34
  v_mfma_f32_16x16x32_bf16 v[44:47], a[144:147], v[128:131], v[68:71]
  v_exp_f32 v35, v35
  v_mfma_f32_16x16x32_bf16 v[44:47], a[148:151], v[132:135], v[44:47]
  v_cvt_pk_bf16_f32 v48, v32, v33
  v_cvt_pk_bf16_f32 v49, v34, v35
  v_mfma_f32_16x16x32_bf16 v[44:47], a[152:155], v[136:139], v[44:47]
  v_exp_f32 v36, v36
  v_mfma_f32_16x16x32_bf16 v[44:47], a[156:159], v[140:143], v[44:47]
  v_exp_f32 v37, v37
  v_mfma_f32_16x16x32_bf16 a[32:35], a[160:163], v[52:55], a[32:35]
  v_exp_f32 v38, v38
  v_mfma_f32_16x16x32_bf16 a[36:39], a[164:167], v[52:55], a[36:39]
  v_exp_f32 v39, v39
  v_mfma_f32_16x16x32_bf16 a[40:43], a[168:171], v[52:55], a[40:43]
  v_cvt_pk_bf16_f32 v50, v36, v37
  v_cvt_pk_bf16_f32 v51, v38, v39
  v_mfma_f32_16x16x32_bf16 a[44:47], a[172:175], v[52:55], a[44:47]
  v_mfma_f32_16x16x32_bf16 a[48:51], a[176:179], v[52:55], a[48:51]
  v_mfma_f32_16x16x32_bf16 a[52:55], a[180:183], v[52:55], a[52:55]
  v_mfma_f32_16x16x32_bf16 a[56:59], a[184:187], v[52:55], a[56:59]
  v_mfma_f32_16x16x32_bf16 a[60:63], a[188:191], v[52:55], a[60:63]
  v_mfma_f32_16x16x32_bf16 a[196:199], a[216:219], v[52:55], a[196:199]
  v_mfma_f32_16x16x32_bf16 v[32:35], a[128:131], v[144:147], v[72:75]
  v_exp_f32 v40, v40
  v_mfma_f32_16x16x32_bf16 v[32:35], a[132:135], v[148:151], v[32:35]
  v_exp_f32 v41, v41
  v_mfma_f32_16x16x32_bf16 v[32:35], a[136:139], v[152:155], v[32:35]
  buffer_load_dwordx4 v16, s[12:15], s28 offen offset:3072 nt lds
  v_mfma_f32_16x16x32_bf16 v[32:35], a[140:143], v[156:159], v[32:35]
  v_exp_f32 v42, v42
  v_mfma_f32_16x16x32_bf16 v[36:39], a[144:147], v[144:147], v[72:75]
  v_exp_f32 v43, v43
  v_mfma_f32_16x16x32_bf16 v[36:39], a[148:151], v[148:151], v[36:39]
  v_cvt_pk_bf16_f32 v52, v40, v41
  v_cvt_pk_bf16_f32 v53, v42, v43
  v_mfma_f32_16x16x32_bf16 v[36:39], a[152:155], v[152:155], v[36:39]
  v_exp_f32 v44, v44
  v_mfma_f32_16x16x32_bf16 v[36:39], a[156:159], v[156:159], v[36:39]
  v_exp_f32 v45, v45
  v_mfma_f32_16x16x32_bf16 a[64:67], a[160:163], v[48:51], a[64:67]
  v_exp_f32 v46, v46
  v_mfma_f32_16x16x32_bf16 a[68:71], a[164:167], v[48:51], a[68:71]
  v_exp_f32 v47, v47
  v_mfma_f32_16x16x32_bf16 a[72:75], a[168:171], v[48:51], a[72:75]
  v_cvt_pk_bf16_f32 v54, v44, v45
  v_cvt_pk_bf16_f32 v55, v46, v47
  v_mfma_f32_16x16x32_bf16 a[76:79], a[172:175], v[48:51], a[76:79]
  v_mfma_f32_16x16x32_bf16 a[80:83], a[176:179], v[48:51], a[80:83]
  v_mfma_f32_16x16x32_bf16 a[84:87], a[180:183], v[48:51], a[84:87]
  v_mfma_f32_16x16x32_bf16 a[88:91], a[184:187], v[48:51], a[88:91]
  v_mfma_f32_16x16x32_bf16 a[92:95], a[188:191], v[48:51], a[92:95]
  v_mfma_f32_16x16x32_bf16 a[200:203], a[216:219], v[48:51], a[200:203]
  v_mfma_f32_16x16x32_bf16 v[40:43], a[128:131], v[160:163], v[76:79]
  v_exp_f32 v32, v32
  v_mfma_f32_16x16x32_bf16 v[40:43], a[132:135], v[164:167], v[40:43]
  ds_read_b128 a[128:131], v1 offset:57344
  ds_read_b128 a[132:135], v2 offset:57344
  v_mfma_f32_16x16x32_bf16 v[40:43], a[136:139], v[168:171], v[40:43]
  v_exp_f32 v33, v33
  v_mfma_f32_16x16x32_bf16 v[40:43], a[140:143], v[172:175], v[40:43]
  ds_read_b128 a[136:139], v3 offset:57344
  ds_read_b128 a[140:143], v4 offset:57344
  v_mfma_f32_16x16x32_bf16 v[44:47], a[144:147], v[160:163], v[76:79]
  v_exp_f32 v34, v34
  v_mfma_f32_16x16x32_bf16 v[44:47], a[148:151], v[164:167], v[44:47]
  ds_read_b128 a[144:147], v1 offset:61440
  ds_read_b128 a[148:151], v2 offset:61440
  v_mfma_f32_16x16x32_bf16 v[44:47], a[152:155], v[168:171], v[44:47]
  v_exp_f32 v35, v35
  v_mfma_f32_16x16x32_bf16 v[44:47], a[156:159], v[172:175], v[44:47]
  ds_read_b128 a[152:155], v3 offset:61440
  ds_read_b128 a[156:159], v4 offset:61440
  v_mfma_f32_16x16x32_bf16 a[96:99], a[160:163], v[52:55], a[96:99]
  v_cvt_pk_bf16_f32 v48, v32, v33
  v_cvt_pk_bf16_f32 v49, v34, v35
  v_mfma_f32_16x16x32_bf16 a[100:103], a[164:167], v[52:55], a[100:103]
  v_exp_f32 v36, v36
  v_mfma_f32_16x16x32_bf16 a[104:107], a[168:171], v[52:55], a[104:107]
  v_exp_f32 v37, v37
  v_mfma_f32_16x16x32_bf16 a[108:111], a[172:175], v[52:55], a[108:111]
  v_exp_f32 v38, v38
  v_mfma_f32_16x16x32_bf16 a[112:115], a[176:179], v[52:55], a[112:115]
  v_exp_f32 v39, v39
  v_mfma_f32_16x16x32_bf16 a[116:119], a[180:183], v[52:55], a[116:119]
  v_cvt_pk_bf16_f32 v50, v36, v37
  v_cvt_pk_bf16_f32 v51, v38, v39
  v_mfma_f32_16x16x32_bf16 a[120:123], a[184:187], v[52:55], a[120:123]
  v_mfma_f32_16x16x32_bf16 a[124:127], a[188:191], v[52:55], a[124:127]
  v_mfma_f32_16x16x32_bf16 a[204:207], a[216:219], v[52:55], a[204:207]
  s_waitcnt lgkmcnt(0)
  v_mfma_f32_16x16x32_bf16 v[32:35], a[128:131], v[80:83], v[56:59]
  v_exp_f32 v40, v40
  v_mfma_f32_16x16x32_bf16 v[32:35], a[132:135], v[84:87], v[32:35]
  s_add_u32 m0, s25, 98304
  v_mfma_f32_16x16x32_bf16 v[32:35], a[136:139], v[88:91], v[32:35]
  buffer_load_dwordx4 v17, s[16:19], s28 offen offset:0 nt lds
  v_mfma_f32_16x16x32_bf16 v[32:35], a[140:143], v[92:95], v[32:35]
  v_exp_f32 v41, v41
  v_mfma_f32_16x16x32_bf16 v[36:39], a[144:147], v[80:83], v[56:59]
  v_exp_f32 v42, v42
  v_mfma_f32_16x16x32_bf16 v[36:39], a[148:151], v[84:87], v[36:39]
  v_exp_f32 v43, v43
  v_mfma_f32_16x16x32_bf16 v[36:39], a[152:155], v[88:91], v[36:39]
  v_cvt_pk_bf16_f32 v52, v40, v41
  v_cvt_pk_bf16_f32 v53, v42, v43
  v_mfma_f32_16x16x32_bf16 v[36:39], a[156:159], v[92:95], v[36:39]
  v_exp_f32 v44, v44
  v_mfma_f32_16x16x32_bf16 v[176:179], a[160:163], v[48:51], v[176:179]
  v_exp_f32 v45, v45
  v_mfma_f32_16x16x32_bf16 v[180:183], a[164:167], v[48:51], v[180:183]
  v_exp_f32 v46, v46
  v_mfma_f32_16x16x32_bf16 v[184:187], a[168:171], v[48:51], v[184:187]
  v_exp_f32 v47, v47
  v_mfma_f32_16x16x32_bf16 v[188:191], a[172:175], v[48:51], v[188:191]
  v_cvt_pk_bf16_f32 v54, v44, v45
  v_cvt_pk_bf16_f32 v55, v46, v47
  v_mfma_f32_16x16x32_bf16 v[192:195], a[176:179], v[48:51], v[192:195]
  v_exp_f32 v32, v32
  v_mfma_f32_16x16x32_bf16 v[196:199], a[180:183], v[48:51], v[196:199]
  v_exp_f32 v33, v33
  v_mfma_f32_16x16x32_bf16 v[200:203], a[184:187], v[48:51], v[200:203]
  v_mfma_f32_16x16x32_bf16 v[204:207], a[188:191], v[48:51], v[204:207]
  v_mfma_f32_16x16x32_bf16 a[208:211], a[216:219], v[48:51], a[208:211]
  v_mfma_f32_16x16x32_bf16 v[40:43], a[128:131], v[96:99], v[60:63]
  v_exp_f32 v34, v34
  v_mfma_f32_16x16x32_bf16 v[40:43], a[132:135], v[100:103], v[40:43]
  v_exp_f32 v35, v35
  v_mfma_f32_16x16x32_bf16 v[40:43], a[136:139], v[104:107], v[40:43]
  v_cvt_pk_bf16_f32 v48, v32, v33
  v_cvt_pk_bf16_f32 v49, v34, v35
  v_mfma_f32_16x16x32_bf16 v[40:43], a[140:143], v[108:111], v[40:43]
  v_exp_f32 v36, v36
  v_mfma_f32_16x16x32_bf16 v[44:47], a[144:147], v[96:99], v[60:63]
  v_exp_f32 v37, v37
  v_mfma_f32_16x16x32_bf16 v[44:47], a[148:151], v[100:103], v[44:47]
  v_exp_f32 v38, v38
  v_mfma_f32_16x16x32_bf16 v[44:47], a[152:155], v[104:107], v[44:47]
  v_exp_f32 v39, v39
  v_mfma_f32_16x16x32_bf16 v[44:47], a[156:159], v[108:111], v[44:47]
  v_cvt_pk_bf16_f32 v50, v36, v37
  v_cvt_pk_bf16_f32 v51, v38, v39
  v_mfma_f32_16x16x32_bf16 v[208:211], a[160:163], v[52:55], v[208:211]
  ds_read_b64_tr_b16 a[160:161], v5 offset:57344
  ds_read_b64_tr_b16 a[162:163], v5 offset:61440
  v_mfma_f32_16x16x32_bf16 v[212:215], a[164:167], v[52:55], v[212:215]
  ds_read_b64_tr_b16 a[164:165], v6 offset:57344
  ds_read_b64_tr_b16 a[166:167], v6 offset:61440
  v_mfma_f32_16x16x32_bf16 v[216:219], a[168:171], v[52:55], v[216:219]
  ds_read_b64_tr_b16 a[168:169], v7 offset:57344
  ds_read_b64_tr_b16 a[170:171], v7 offset:61440
  v_mfma_f32_16x16x32_bf16 v[220:223], a[172:175], v[52:55], v[220:223]
  ds_read_b64_tr_b16 a[172:173], v8 offset:57344
  ds_read_b64_tr_b16 a[174:175], v8 offset:61440
  v_mfma_f32_16x16x32_bf16 v[224:227], a[176:179], v[52:55], v[224:227]
  ds_read_b64_tr_b16 a[176:177], v9 offset:57344
  ds_read_b64_tr_b16 a[178:179], v9 offset:61440
  v_mfma_f32_16x16x32_bf16 v[228:231], a[180:183], v[52:55], v[228:231]
  ds_read_b64_tr_b16 a[180:181], v10 offset:57344
  ds_read_b64_tr_b16 a[182:183], v10 offset:61440
  v_mfma_f32_16x16x32_bf16 v[232:235], a[184:187], v[52:55], v[232:235]
  ds_read_b64_tr_b16 a[184:185], v11 offset:57344
  ds_read_b64_tr_b16 a[186:187], v11 offset:61440
  v_mfma_f32_16x16x32_bf16 v[236:239], a[188:191], v[52:55], v[236:239]
  ds_read_b64_tr_b16 a[188:189], v12 offset:57344
  ds_read_b64_tr_b16 a[190:191], v12 offset:61440
  v_mfma_f32_16x16x32_bf16 a[212:215], a[216:219], v[52:55], a[212:215]
  v_mfma_f32_16x16x32_bf16 v[32:35], a[128:131], v[112:115], v[64:67]
  v_exp_f32 v40, v40
  v_mfma_f32_16x16x32_bf16 v[32:35], a[132:135], v[116:119], v[32:35]
  v_exp_f32 v41, v41
  v_mfma_f32_16x16x32_bf16 v[32:35], a[136:139], v[120:123], v[32:35]
  buffer_load_dwordx4 v18, s[16:19], s28 offen offset:1024 nt lds
  v_mfma_f32_16x16x32_bf16 v[32:35], a[140:143], v[124:127], v[32:35]
  v_exp_f32 v42, v42
  v_mfma_f32_16x16x32_bf16 v[36:39], a[144:147], v[112:115], v[64:67]
  v_exp_f32 v43, v43
  v_mfma_f32_16x16x32_bf16 v[36:39], a[148:151], v[116:119], v[36:39]
  v_cvt_pk_bf16_f32 v52, v40, v41
  v_cvt_pk_bf16_f32 v53, v42, v43
  v_mfma_f32_16x16x32_bf16 v[36:39], a[152:155], v[120:123], v[36:39]
  v_exp_f32 v44, v44
  v_mfma_f32_16x16x32_bf16 v[36:39], a[156:159], v[124:127], v[36:39]
  s_waitcnt lgkmcnt(0)
  v_mfma_f32_16x16x32_bf16 a[0:3], a[160:163], v[48:51], a[0:3]
  v_exp_f32 v45, v45
  v_mfma_f32_16x16x32_bf16 a[4:7], a[164:167], v[48:51], a[4:7]
  v_exp_f32 v46, v46
  v_mfma_f32_16x16x32_bf16 a[8:11], a[168:171], v[48:51], a[8:11]
  v_exp_f32 v47, v47
  v_mfma_f32_16x16x32_bf16 a[12:15], a[172:175], v[48:51], a[12:15]
  v_cvt_pk_bf16_f32 v54, v44, v45
  v_cvt_pk_bf16_f32 v55, v46, v47
  v_mfma_f32_16x16x32_bf16 a[16:19], a[176:179], v[48:51], a[16:19]
  v_mfma_f32_16x16x32_bf16 a[20:23], a[180:183], v[48:51], a[20:23]
  v_mfma_f32_16x16x32_bf16 a[24:27], a[184:187], v[48:51], a[24:27]
  v_mfma_f32_16x16x32_bf16 a[28:31], a[188:191], v[48:51], a[28:31]
  v_mfma_f32_16x16x32_bf16 a[192:195], a[216:219], v[48:51], a[192:195]
  v_mfma_f32_16x16x32_bf16 v[40:43], a[128:131], v[128:131], v[68:71]
  v_exp_f32 v32, v32
  v_mfma_f32_16x16x32_bf16 v[40:43], a[132:135], v[132:135], v[40:43]
  v_exp_f32 v33, v33
  v_mfma_f32_16x16x32_bf16 v[40:43], a[136:139], v[136:139], v[40:43]
  buffer_load_dwordx4 v17, s[16:19], s28 offen offset:2048 nt lds
  v_mfma_f32_16x16x32_bf16 v[40:43], a[140:143], v[140:143], v[40:43]
  v_exp_f32 v34, v34
  v_mfma_f32_16x16x32_bf16 v[44:47], a[144:147], v[128:131], v[68:71]
  v_exp_f32 v35, v35
  v_mfma_f32_16x16x32_bf16 v[44:47], a[148:151], v[132:135], v[44:47]
  v_cvt_pk_bf16_f32 v48, v32, v33
  v_cvt_pk_bf16_f32 v49, v34, v35
  v_mfma_f32_16x16x32_bf16 v[44:47], a[152:155], v[136:139], v[44:47]
  v_exp_f32 v36, v36
  v_mfma_f32_16x16x32_bf16 v[44:47], a[156:159], v[140:143], v[44:47]
  v_exp_f32 v37, v37
  v_mfma_f32_16x16x32_bf16 a[32:35], a[160:163], v[52:55], a[32:35]
  v_exp_f32 v38, v38
  v_mfma_f32_16x16x32_bf16 a[36:39], a[164:167], v[52:55], a[36:39]
  v_exp_f32 v39, v39
  v_mfma_f32_16x16x32_bf16 a[40:43], a[168:171], v[52:55], a[40:43]
  v_cvt_pk_bf16_f32 v50, v36, v37
  v_cvt_pk_bf16_f32 v51, v38, v39
  v_mfma_f32_16x16x32_bf16 a[44:47], a[172:175], v[52:55], a[44:47]
  v_mfma_f32_16x16x32_bf16 a[48:51], a[176:179], v[52:55], a[48:51]
  v_mfma_f32_16x16x32_bf16 a[52:55], a[180:183], v[52:55], a[52:55]
  v_mfma_f32_16x16x32_bf16 a[56:59], a[184:187], v[52:55], a[56:59]
  v_mfma_f32_16x16x32_bf16 a[60:63], a[188:191], v[52:55], a[60:63]
  v_mfma_f32_16x16x32_bf16 a[196:199], a[216:219], v[52:55], a[196:199]
  v_mfma_f32_16x16x32_bf16 v[32:35], a[128:131], v[144:147], v[72:75]
  v_exp_f32 v40, v40
  v_mfma_f32_16x16x32_bf16 v[32:35], a[132:135], v[148:151], v[32:35]
  v_exp_f32 v41, v41
  v_mfma_f32_16x16x32_bf16 v[32:35], a[136:139], v[152:155], v[32:35]
  buffer_load_dwordx4 v18, s[16:19], s28 offen offset:3072 nt lds
  v_mfma_f32_16x16x32_bf16 v[32:35], a[140:143], v[156:159], v[32:35]
  v_exp_f32 v42, v42
  v_mfma_f32_16x16x32_bf16 v[36:39], a[144:147], v[144:147], v[72:75]
  v_exp_f32 v43, v43
  v_mfma_f32_16x16x32_bf16 v[36:39], a[148:151], v[148:151], v[36:39]
  v_cvt_pk_bf16_f32 v52, v40, v41
  v_cvt_pk_bf16_f32 v53, v42, v43
  v_mfma_f32_16x16x32_bf16 v[36:39], a[152:155], v[152:155], v[36:39]
  v_exp_f32 v44, v44
  v_mfma_f32_16x16x32_bf16 v[36:39], a[156:159], v[156:159], v[36:39]
  v_exp_f32 v45, v45
  v_mfma_f32_16x16x32_bf16 a[64:67], a[160:163], v[48:51], a[64:67]
  v_exp_f32 v46, v46
  v_mfma_f32_16x16x32_bf16 a[68:71], a[164:167], v[48:51], a[68:71]
  v_exp_f32 v47, v47
  v_mfma_f32_16x16x32_bf16 a[72:75], a[168:171], v[48:51], a[72:75]
  v_cvt_pk_bf16_f32 v54, v44, v45
  v_cvt_pk_bf16_f32 v55, v46, v47
  v_mfma_f32_16x16x32_bf16 a[76:79], a[172:175], v[48:51], a[76:79]
  v_mfma_f32_16x16x32_bf16 a[80:83], a[176:179], v[48:51], a[80:83]
  v_mfma_f32_16x16x32_bf16 a[84:87], a[180:183], v[48:51], a[84:87]
  v_mfma_f32_16x16x32_bf16 a[88:91], a[184:187], v[48:51], a[88:91]
  v_mfma_f32_16x16x32_bf16 a[92:95], a[188:191], v[48:51], a[92:95]
  v_mfma_f32_16x16x32_bf16 a[200:203], a[216:219], v[48:51], a[200:203]
  s_waitcnt vmcnt(16)
  s_barrier
  v_mfma_f32_16x16x32_bf16 v[40:43], a[128:131], v[160:163], v[76:79]
  v_exp_f32 v32, v32
  v_mfma_f32_16x16x32_bf16 v[40:43], a[132:135], v[164:167], v[40:43]
  ds_read_b128 a[128:131], v1 offset:0
  ds_read_b128 a[132:135], v2 offset:0
  v_mfma_f32_16x16x32_bf16 v[40:43], a[136:139], v[168:171], v[40:43]
  v_exp_f32 v33, v33
  v_mfma_f32_16x16x32_bf16 v[40:43], a[140:143], v[172:175], v[40:43]
  ds_read_b128 a[136:139], v3 offset:0
  ds_read_b128 a[140:143], v4 offset:0
  v_mfma_f32_16x16x32_bf16 v[44:47], a[144:147], v[160:163], v[76:79]
  v_exp_f32 v34, v34
  v_mfma_f32_16x16x32_bf16 v[44:47], a[148:151], v[164:167], v[44:47]
  ds_read_b128 a[144:147], v1 offset:4096
  ds_read_b128 a[148:151], v2 offset:4096
  v_mfma_f32_16x16x32_bf16 v[44:47], a[152:155], v[168:171], v[44:47]
  v_exp_f32 v35, v35
  v_mfma_f32_16x16x32_bf16 v[44:47], a[156:159], v[172:175], v[44:47]
  ds_read_b128 a[152:155], v3 offset:4096
  ds_read_b128 a[156:159], v4 offset:4096
  v_mfma_f32_16x16x32_bf16 a[96:99], a[160:163], v[52:55], a[96:99]
  v_cvt_pk_bf16_f32 v48, v32, v33
  v_cvt_pk_bf16_f32 v49, v34, v35
  v_mfma_f32_16x16x32_bf16 a[100:103], a[164:167], v[52:55], a[100:103]
  v_exp_f32 v36, v36
  v_mfma_f32_16x16x32_bf16 a[104:107], a[168:171], v[52:55], a[104:107]
  v_exp_f32 v37, v37
  v_mfma_f32_16x16x32_bf16 a[108:111], a[172:175], v[52:55], a[108:111]
  v_exp_f32 v38, v38
  v_mfma_f32_16x16x32_bf16 a[112:115], a[176:179], v[52:55], a[112:115]
  s_cmp_eq_u32 s30, s63
  s_cbranch_scc0 L_q5
  s_add_u32 s33, s62, 16384
  s_add_u32 m0, s25, 114688
  s_nop 0
  buffer_load_dwordx4 v13, s[8:11], s33 offen offset:0 nt lds
  buffer_load_dwordx4 v14, s[8:11], s33 offen offset:1024 nt lds
  buffer_load_dwordx4 v15, s[8:11], s33 offen offset:2048 nt lds
  buffer_load_dwordx4 v16, s[8:11], s33 offen offset:3072 nt lds
L_q5:
  v_mfma_f32_16x16x32_bf16 a[116:119], a[180:183], v[52:55], a[116:119]
  v_exp_f32 v39, v39
  v_mfma_f32_16x16x32_bf16 a[120:123], a[184:187], v[52:55], a[120:123]
  v_cvt_pk_bf16_f32 v50, v36, v37
  v_cvt_pk_bf16_f32 v51, v38, v39
  v_mfma_f32_16x16x32_bf16 a[124:127], a[188:191], v[52:55], a[124:127]
  v_mfma_f32_16x16x32_bf16 a[204:207], a[216:219], v[52:55], a[204:207]
  s_waitcnt lgkmcnt(0)
  v_mfma_f32_16x16x32_bf16 v[32:35], a[128:131], v[80:83], v[56:59]
  s_add_u32 s28, s28, 16384
  v_mfma_f32_16x16x32_bf16 v[32:35], a[132:135], v[84:87], v[32:35]
  v_exp_f32 v40, v40
  v_mfma_f32_16x16x32_bf16 v[32:35], a[136:139], v[88:91], v[32:35]
  s_cmp_eq_u32 s30, 3
  s_cbranch_scc1 L_nl
  s_add_u32 m0, s25, 49152
  s_nop 0
  buffer_load_dwordx4 v13, s[12:15], s28 offen offset:0 nt lds
L_nl:
  v_mfma_f32_16x16x32_bf16 v[32:35], a[140:143], v[92:95], v[32:35]
  v_exp_f32 v41, v41
  v_mfma_f32_16x16x32_bf16 v[36:39], a[144:147], v[80:83], v[56:59]
  v_exp_f32 v42, v42
  v_mfma_f32_16x16x32_bf16 v[36:39], a[148:151], v[84:87], v[36:39]
  v_exp_f32 v43, v43
  v_mfma_f32_16x16x32_bf16 v[36:39], a[152:155], v[88:91], v[36:39]
  v_cvt_pk_bf16_f32 v52, v40, v41
  v_cvt_pk_bf16_f32 v53, v42, v43
  v_mfma_f32_16x16x32_bf16 v[36:39], a[156:159], v[92:95], v[36:39]
  v_exp_f32 v44, v44
  v_mfma_f32_16x16x32_bf16 v[176:179], a[160:163], v[48:51], v[176:179]
  v_exp_f32 v45, v45
  v_mfma_f32_16x16x32_bf16 v[180:183], a[164:167], v[48:51], v[180:183]
  v_exp_f32 v46, v46
  v_mfma_f32_16x16x32_bf16 v[184:187], a[168:171], v[48:51], v[184:187]
  v_exp_f32 v47, v47
  v_mfma_f32_16x16x32_bf16 v[188:191], a[172:175], v[48:51], v[188:191]
  v_cvt_pk_bf16_f32 v54, v44, v45
  v_cvt_pk_bf16_f32 v55, v46, v47
  v_mfma_f32_16x16x32_bf16 v[192:195], a[176:179], v[48:51], v[192:195]
  s_cmp_eq_u32 s30, s63
  s_cbranch_scc0 L_q6
  s_add_u32 s33, s62, 20480
  s_add_u32 m0, s25, 49152
  s_nop 0
  buffer_load_dwordx4 v13, s[8:11], s33 offen offset:0 nt lds
  buffer_load_dwordx4 v14, s[8:11], s33 offen offset:1024 nt lds
  buffer_load_dwordx4 v15, s[8:11], s33 offen offset:2048 nt lds
  buffer_load_dwordx4 v16, s[8:11], s33 offen offset:3072 nt lds
L_q6:
  v_mfma_f32_16x16x32_bf16 v[196:199], a[180:183], v[48:51], v[196:199]
  v_exp_f32 v32, v32
  v_mfma_f32_16x16x32_bf16 v[200:203], a[184:187], v[48:51], v[200:203]
  v_exp_f32 v33, v33
  v_mfma_f32_16x16x32_bf16 v[204:207], a[188:191], v[48:51], v[204:207]
  v_mfma_f32_16x16x32_bf16 a[208:211], a[216:219], v[48:51], a[208:211]
  s_add_u32 s30, s30, 1
  s_cmp_lt_u32 s30, 4
  s_cbranch_scc1 L_body0
  s_mul_i32 s51, s26, 98304
  s_cmp_ge_u32 s27, 512
  s_cbranch_scc1 L_drain
  s_mov_b32 s26, s27
  s_mov_b32 s27, 0xffff
  s_mov_b32 s29, 268435456
  s_mov_b32 s66, 2
  s_mov_b32 s63, 99
  s_mov_b32 s71, 99
  s_mov_b32 s74, 3
  v_mov_b32 v59, 0xff800000
  v_mov_b32 v63, 0xff800000
  v_mov_b32 v67, 0xff800000
  v_mov_b32 v71, 0xff800000
  v_mov_b32 v75, 0xff800000
  v_mov_b32 v79, 0xff800000
  s_branch L_fuse
L_drain:
  v_mfma_f32_16x16x32_bf16 v[208:211], a[160:163], v[52:55], v[208:211]
  v_mfma_f32_16x16x32_bf16 v[212:215], a[164:167], v[52:55], v[212:215]
  v_mfma_f32_16x16x32_bf16 v[216:219], a[168:171], v[52:55], v[216:219]
  v_mfma_f32_16x16x32_bf16 v[220:223], a[172:175], v[52:55], v[220:223]
  v_mfma_f32_16x16x32_bf16 v[224:227], a[176:179], v[52:55], v[224:227]
  v_mfma_f32_16x16x32_bf16 v[228:231], a[180:183], v[52:55], v[228:231]
  v_mfma_f32_16x16x32_bf16 v[232:235], a[184:187], v[52:55], v[232:235]
  v_mfma_f32_16x16x32_bf16 v[236:239], a[188:191], v[52:55], v[236:239]
  v_mfma_f32_16x16x32_bf16 a[212:215], a[216:219], v[52:55], a[212:215]
  s_mov_b32 s68, 1
  s_branch L_epi0
L_tail:
  s_mul_i32 s51, s26, 98304
  v_mfma_f32_16x16x32_bf16 v[40:43], a[128:131], v[96:99], v[60:63]
  v_exp_f32 v34, v34
  v_mfma_f32_16x16x32_bf16 v[40:43], a[132:135], v[100:103], v[40:43]
  v_exp_f32 v35, v35
  v_mfma_f32_16x16x32_bf16 v[40:43], a[136:139], v[104:107], v[40:43]
  v_cvt_pk_bf16_f32 v48, v32, v33
  v_cvt_pk_bf16_f32 v49, v34, v35
  v_mfma_f32_16x16x32_bf16 v[40:43], a[140:143], v[108:111], v[40:43]
  v_exp_f32 v36, v36
  v_mfma_f32_16x16x32_bf16 v[44:47], a[144:147], v[96:99], v[60:63]
  v_exp_f32 v37, v37
  v_mfma_f32_16x16x32_bf16 v[44:47], a[148:151], v[100:103], v[44:47]
  v_exp_f32 v38, v38
  v_mfma_f32_16x16x32_bf16 v[44:47], a[152:155], v[104:107], v[44:47]
  v_exp_f32 v39, v39
  v_mfma_f32_16x16x32_bf16 v[44:47], a[156:159], v[108:111], v[44:47]
  v_cvt_pk_bf16_f32 v50, v36, v37
  v_cvt_pk_bf16_f32 v51, v38, v39
  v_mfma_f32_16x16x32_bf16 v[208:211], a[160:163], v[52:55], v[208:211]
  ds_read_b64_tr_b16 a[160:161], v5 offset:32768
  ds_read_b64_tr_b16 a[162:163], v5 offset:36864
  v_mfma_f32_16x16x32_bf16 v[212:215], a[164:167], v[52:55], v[212:215]
  ds_read_b64_tr_b16 a[164:165], v6 offset:32768
  ds_read_b64_tr_b16 a[166:167], v6 offset:36864
  v_mfma_f32_16x16x32_bf16 v[216:219], a[168:171], v[52:55], v[216:219]
  ds_read_b64_tr_b16 a[168:169], v7 offset:32768
  ds_read_b64_tr_b16 a[170:171], v7 offset:36864
  v_mfma_f32_16x16x32_bf16 v[220:223], a[172:175], v[52:55], v[220:223]
  ds_read_b64_tr_b16 a[172:173], v8 offset:32768
  ds_read_b64_tr_b16 a[174:175], v8 offset:36864
  v_mfma_f32_16x16x32_bf16 v[224:227], a[176:179], v[52:55], v[224:227]
  ds_read_b64_tr_b16 a[176:177], v9 offset:32768
  ds_read_b64_tr_b16 a[178:179], v9 offset:36864
  v_mfma_f32_16x16x32_bf16 v[228:231], a[180:183], v[52:55], v[228:231]
  ds_read_b64_tr_b16 a[180:181], v10 offset:32768
  ds_read_b64_tr_b16 a[182:183], v10 offset:36864
  v_mfma_f32_16x16x32_bf16 v[232:235], a[184:187], v[52:55], v[232:235]
  ds_read_b64_tr_b16 a[184:185], v11 offset:32768
  ds_read_b64_tr_b16 a[186:187], v11 offset:36864
  v_mfma_f32_16x16x32_bf16 v[236:239], a[188:191], v[52:55], v[236:239]
  ds_read_b64_tr_b16 a[188:189], v12 offset:32768
  ds_read_b64_tr_b16 a[190:191], v12 offset:36864
  v_mfma_f32_16x16x32_bf16 a[212:215], a[216:219], v[52:55], a[212:215]
  v_mfma_f32_16x16x32_bf16 v[32:35], a[128:131], v[112:115], v[64:67]
  v_exp_f32 v40, v40
  v_mfma_f32_16x16x32_bf16 v[32:35], a[132:135], v[116:119], v[32:35]
  ds_read_b128 a[128:131], v1 offset:40960
  ds_read_b128 a[132:135], v2 offset:40960
  v_mfma_f32_16x16x32_bf16 v[32:35], a[136:139], v[120:123], v[32:35]
  v_exp_f32 v41, v41
  v_mfma_f32_16x16x32_bf16 v[32:35], a[140:143], v[124:127], v[32:35]
  ds_read_b128 a[136:139], v3 offset:40960
  ds_read_b128 a[140:143], v4 offset:40960
  v_mfma_f32_16x16x32_bf16 v[36:39], a[144:147], v[112:115], v[64:67]
  v_exp_f32 v42, v42
  v_mfma_f32_16x16x32_bf16 v[36:39], a[148:151], v[116:119], v[36:39]
  ds_read_b128 a[144:147], v1 offset:45056
  ds_read_b128 a[148:151], v2 offset:45056
  v_mfma_f32_16x16x32_bf16 v[36:39], a[152:155], v[120:123], v[36:39]
  s_waitcnt lgkmcnt(6)
  v_cvt_pk_bf16_f32 v52, v40, v41
  v_mfma_f32_16x16x32_bf16 v[36:39], a[156:159], v[124:127], v[36:39]
  ds_read_b128 a[152:155], v3 offset:45056
  ds_read_b128 a[156:159], v4 offset:45056
  v_mfma_f32_16x16x32_bf16 a[0:3], a[160:163], v[48:51], a[0:3]
  v_exp_f32 v43, v43
  v_mfma_f32_16x16x32_bf16 a[4:7], a[164:167], v[48:51], a[4:7]
  v_exp_f32 v44, v44
  v_mfma_f32_16x16x32_bf16 a[8:11], a[168:171], v[48:51], a[8:11]
  v_exp_f32 v45, v45
  v_mfma_f32_16x16x32_bf16 a[12:15], a[172:175], v[48:51], a[12:15]
  v_cvt_pk_bf16_f32 v53, v42, v43
  v_cvt_pk_bf16_f32 v54, v44, v45
  v_mfma_f32_16x16x32_bf16 a[16:19], a[176:179], v[48:51], a[16:19]
  v_exp_f32 v46, v46
  v_mfma_f32_16x16x32_bf16 a[20:23], a[180:183], v[48:51], a[20:23]
  v_exp_f32 v47, v47
  v_mfma_f32_16x16x32_bf16 a[24:27], a[184:187], v[48:51], a[24:27]
  v_cvt_pk_bf16_f32 v55, v46, v47
  v_mfma_f32_16x16x32_bf16 a[28:31], a[188:191], v[48:51], a[28:31]
  v_mfma_f32_16x16x32_bf16 a[192:195], a[216:219], v[48:51], a[192:195]
  s_waitcnt lgkmcnt(0)
  v_mfma_f32_16x16x32_bf16 v[40:43], a[128:131], v[80:83], v[56:59]
  v_exp_f32 v32, v32
  v_mfma_f32_16x16x32_bf16 v[40:43], a[132:135], v[84:87], v[40:43]
  v_exp_f32 v33, v33
  v_mfma_f32_16x16x32_bf16 v[40:43], a[136:139], v[88:91], v[40:43]
  v_exp_f32 v34, v34
  v_mfma_f32_16x16x32_bf16 v[40:43], a[140:143], v[92:95], v[40:43]
  v_exp_f32 v35, v35
  v_mfma_f32_16x16x32_bf16 v[44:47], a[144:147], v[80:83], v[56:59]
  v_cvt_pk_bf16_f32 v48, v32, v33
  v_cvt_pk_bf16_f32 v49, v34, v35
  v_mfma_f32_16x16x32_bf16 v[44:47], a[148:151], v[84:87], v[44:47]
  v_exp_f32 v36, v36
  v_mfma_f32_16x16x32_bf16 v[44:47], a[152:155], v[88:91], v[44:47]
  v_exp_f32 v37, v37
  v_mfma_f32_16x16x32_bf16 v[44:47], a[156:159], v[92:95], v[44:47]
  v_exp_f32 v38, v38
  v_mfma_f32_16x16x32_bf16 a[32:35], a[160:163], v[52:55], a[32:35]
  v_exp_f32 v39, v39
  v_mfma_f32_16x16x32_bf16 a[36:39], a[164:167], v[52:55], a[36:39]
  v_cvt_pk_bf16_f32 v50, v36, v37
  v_cvt_pk_bf16_f32 v51, v38, v39
  v_mfma_f32_16x16x32_bf16 a[40:43], a[168:171], v[52:55], a[40:43]
  v_exp_f32 v40, v40
  v_mfma_f32_16x16x32_bf16 a[44:47], a[172:175], v[52:55], a[44:47]
  v_exp_f32 v41, v41
  v_mfma_f32_16x16x32_bf16 a[48:51], a[176:179], v[52:55], a[48:51]
  v_mfma_f32_16x16x32_bf16 a[52:55], a[180:183], v[52:55], a[52:55]
  v_mfma_f32_16x16x32_bf16 a[56:59], a[184:187], v[52:55], a[56:59]
  v_mfma_f32_16x16x32_bf16 a[60:63], a[188:191], v[52:55], a[60:63]
  v_mfma_f32_16x16x32_bf16 a[196:199], a[216:219], v[52:55], a[196:199]
  v_mfma_f32_16x16x32_bf16 v[32:35], a[128:131], v[96:99], v[60:63]
  v_exp_f32 v42, v42
  v_mfma_f32_16x16x32_bf16 v[32:35], a[132:135], v[100:103], v[32:35]
  v_exp_f32 v43, v43
  v_mfma_f32_16x16x32_bf16 v[32:35], a[136:139], v[104:107], v[32:35]
  v_cvt_pk_bf16_f32 v52, v40, v41
  v_cvt_pk_bf16_f32 v53, v42, v43
  v_mfma_f32_16x16x32_bf16 v[32:35], a[140:143], v[108:111], v[32:35]
  v_exp_f32 v44, v44
  v_mfma_f32_16x16x32_bf16 v[36:39], a[144:147], v[96:99], v[60:63]
  v_exp_f32 v45, v45
  v_mfma_f32_16x16x32_bf16 v[36:39], a[148:151], v[100:103], v[36:39]
  v_exp_f32 v46, v46
  v_mfma_f32_16x16x32_bf16 v[36:39], a[152:155], v[104:107], v[36:39]
  v_exp_f32 v47, v47
  v_mfma_f32_16x16x32_bf16 v[36:39], a[156:159], v[108:111], v[36:39]
  v_cvt_pk_bf16_f32 v54, v44, v45
  v_cvt_pk_bf16_f32 v55, v46, v47
  v_mfma_f32_16x16x32_bf16 a[64:67], a[160:163], v[48:51], a[64:67]
  ds_read_b64_tr_b16 a[160:161], v5 offset:40960
  ds_read_b64_tr_b16 a[162:163], v5 offset:45056
  v_mfma_f32_16x16x32_bf16 a[68:71], a[164:167], v[48:51], a[68:71]
  ds_read_b64_tr_b16 a[164:165], v6 offset:40960
  ds_read_b64_tr_b16 a[166:167], v6 offset:45056
  v_mfma_f32_16x16x32_bf16 a[72:75], a[168:171], v[48:51], a[72:75]
  ds_read_b64_tr_b16 a[168:169], v7 offset:40960
  ds_read_b64_tr_b16 a[170:171], v7 offset:45056
  v_mfma_f32_16x16x32_bf16 a[76:79], a[172:175], v[48:51], a[76:79]
  ds_read_b64_tr_b16 a[172:173], v8 offset:40960
  ds_read_b64_tr_b16 a[174:175], v8 offset:45056
  v_mfma_f32_16x16x32_bf16 a[80:83], a[176:179], v[48:51], a[80:83]
  ds_read_b64_tr_b16 a[176:177], v9 offset:40960
  ds_read_b64_tr_b16 a[178:179], v9 offset:45056
  v_mfma_f32_16x16x32_bf16 a[84:87], a[180:183], v[48:51], a[84:87]
  ds_read_b64_tr_b16 a[180:181], v10 offset:40960
  ds_read_b64_tr_b16 a[182:183], v10 offset:45056
  v_mfma_f32_16x16x32_bf16 a[88:91], a[184:187], v[48:51], a[88:91]
  ds_read_b64_tr_b16 a[184:185], v11 offset:40960
  ds_read_b64_tr_b16 a[186:187], v11 offset:45056
  v_mfma_f32_16x16x32_bf16 a[92:95], a[188:191], v[48:51], a[92:95]
  ds_read_b64_tr_b16 a[188:189], v12 offset:40960
  ds_read_b64_tr_b16 a[190:191], v12 offset:45056
  v_mfma_f32_16x16x32_bf16 a[200:203], a[216:219], v[48:51], a[200:203]
  s_waitcnt vmcnt(9)
  s_barrier
  v_mfma_f32_16x16x32_bf16 v[40:43], a[128:131], v[112:115], v[64:67]
  v_exp_f32 v32, v32
  v_mfma_f32_16x16x32_bf16 v[40:43], a[132:135], v[116:119], v[40:43]
  ds_read_b128 a[128:131], v1 offset:49152
  ds_read_b128 a[132:135], v2 offset:49152
  v_mfma_f32_16x16x32_bf16 v[40:43], a[136:139], v[120:123], v[40:43]
  v_exp_f32 v33, v33
  v_mfma_f32_16x16x32_bf16 v[40:43], a[140:143], v[124:127], v[40:43]
  ds_read_b128 a[136:139], v3 offset:49152
  ds_read_b128 a[140:143], v4 offset:49152
  v_mfma_f32_16x16x32_bf16 v[44:47], a[144:147], v[112:115], v[64:67]
  v_exp_f32 v34, v34
  v_mfma_f32_16x16x32_bf16 v[44:47], a[148:151], v[116:119], v[44:47]
  ds_read_b128 a[144:147], v1 offset:53248
  ds_read_b128 a[148:151], v2 offset:53248
  v_mfma_f32_16x16x32_bf16 v[44:47], a[152:155], v[120:123], v[44:47]
  s_waitcnt lgkmcnt(6)
  v_cvt_pk_bf16_f32 v48, v32, v33
  v_mfma_f32_16x16x32_bf16 v[44:47], a[156:159], v[124:127], v[44:47]
  ds_read_b128 a[152:155], v3 offset:53248
  ds_read_b128 a[156:159], v4 offset:53248
  v_mfma_f32_16x16x32_bf16 a[0:3], a[160:163], v[52:55], a[0:3]
  v_exp_f32 v35, v35
  v_mfma_f32_16x16x32_bf16 a[4:7], a[164:167], v[52:55], a[4:7]
  v_exp_f32 v36, v36
  v_mfma_f32_16x16x32_bf16 a[8:11], a[168:171], v[52:55], a[8:11]
  v_exp_f32 v37, v37
  v_mfma_f32_16x16x32_bf16 a[12:15], a[172:175], v[52:55], a[12:15]
  v_cvt_pk_bf16_f32 v49, v34, v35
  v_cvt_pk_bf16_f32 v50, v36, v37
  v_mfma_f32_16x16x32_bf16 a[16:19], a[176:179], v[52:55], a[16:19]
  v_exp_f32 v38, v38
  v_mfma_f32_16x16x32_bf16 a[20:23], a[180:183], v[52:55], a[20:23]
  v_exp_f32 v39, v39
  v_mfma_f32_16x16x32_bf16 a[24:27], a[184:187], v[52:55], a[24:27]
  v_cvt_pk_bf16_f32 v51, v38, v39
  v_mfma_f32_16x16x32_bf16 a[28:31], a[188:191], v[52:55], a[28:31]
  v_mfma_f32_16x16x32_bf16 a[192:195], a[216:219], v[52:55], a[192:195]
  s_waitcnt lgkmcnt(0)
  v_mfma_f32_16x16x32_bf16 v[32:35], a[128:131], v[80:83], v[56:59]
  v_exp_f32 v40, v40
  v_mfma_f32_16x16x32_bf16 v[32:35], a[132:135], v[84:87], v[32:35]
  v_exp_f32 v41, v41
  v_mfma_f32_16x16x32_bf16 v[32:35], a[136:139], v[88:91], v[32:35]
  v_exp_f32 v42, v42
  v_mfma_f32_16x16x32_bf16 v[32:35], a[140:143], v[92:95], v[32:35]
  v_exp_f32 v43, v43
  v_mfma_f32_16x16x32_bf16 v[36:39], a[144:147], v[80:83], v[56:59]
  v_cvt_pk_bf16_f32 v52, v40, v41
  v_cvt_pk_bf16_f32 v53, v42, v43
  v_mfma_f32_16x16x32_bf16 v[36:39], a[148:151], v[84:87], v[36:39]
  v_exp_f32 v44, v44
  v_mfma_f32_16x16x32_bf16 v[36:39], a[152:155], v[88:91], v[36:39]
  v_exp_f32 v45, v45
  v_mfma_f32_16x16x32_bf16 v[36:39], a[156:159], v[92:95], v[36:39]
  v_exp_f32 v46, v46
  v_mfma_f32_16x16x32_bf16 a[32:35], a[160:163], v[48:51], a[32:35]
  v_exp_f32 v47, v47
  v_mfma_f32_16x16x32_bf16 a[36:39], a[164:167], v[48:51], a[36:39]
  v_cvt_pk_bf16_f32 v54, v44, v45
  v_cvt_pk_bf16_f32 v55, v46, v47
  v_mfma_f32_16x16x32_bf16 a[40:43], a[168:171], v[48:51], a[40:43]
  v_exp_f32 v32, v32
  v_mfma_f32_16x16x32_bf16 a[44:47], a[172:175], v[48:51], a[44:47]
  v_exp_f32 v33, v33
  v_mfma_f32_16x16x32_bf16 a[48:51], a[176:179], v[48:51], a[48:51]
  v_mfma_f32_16x16x32_bf16 a[52:55], a[180:183], v[48:51], a[52:55]
  v_mfma_f32_16x16x32_bf16 a[56:59], a[184:187], v[48:51], a[56:59]
  v_mfma_f32_16x16x32_bf16 a[60:63], a[188:191], v[48:51], a[60:63]
  v_mfma_f32_16x16x32_bf16 a[196:199], a[216:219], v[48:51], a[196:199]
  v_mfma_f32_16x16x32_bf16 v[40:43], a[128:131], v[96:99], v[60:63]
  v_exp_f32 v34, v34
  v_mfma_f32_16x16x32_bf16 v[40:43], a[132:135], v[100:103], v[40:43]
  v_exp_f32 v35, v35
  v_mfma_f32_16x16x32_bf16 v[40:43], a[136:139], v[104:107], v[40:43]
  v_cvt_pk_bf16_f32 v48, v32, v33
  v_cvt_pk_bf16_f32 v49, v34, v35
  v_mfma_f32_16x16x32_bf16 v[40:43], a[140:143], v[108:111], v[40:43]
  v_exp_f32 v36, v36
  v_mfma_f32_16x16x32_bf16 v[44:47], a[144:147], v[96:99], v[60:63]
  v_exp_f32 v37, v37
  v_mfma_f32_16x16x32_bf16 v[44:47], a[148:151], v[100:103], v[44:47]
  v_exp_f32 v38, v38
  v_mfma_f32_16x16x32_bf16 v[44:47], a[152:155], v[104:107], v[44:47]
  v_exp_f32 v39, v39
  v_mfma_f32_16x16x32_bf16 v[44:47], a[156:159], v[108:111], v[44:47]
  v_cvt_pk_bf16_f32 v50, v36, v37
  v_cvt_pk_bf16_f32 v51, v38, v39
  v_mfma_f32_16x16x32_bf16 a[64:67], a[160:163], v[52:55], a[64:67]
  ds_read_b64_tr_b16 a[160:161], v5 offset:49152
  ds_read_b64_tr_b16 a[162:163], v5 offset:53248
  v_mfma_f32_16x16x32_bf16 a[68:71], a[164:167], v[52:55], a[68:71]
  ds_read_b64_tr_b16 a[164:165], v6 offset:49152
  ds_read_b64_tr_b16 a[166:167], v6 offset:53248
  v_mfma_f32_16x16x32_bf16 a[72:75], a[168:171], v[52:55], a[72:75]
  ds_read_b64_tr_b16 a[168:169], v7 offset:49152
  ds_read_b64_tr_b16 a[170:171], v7 offset:53248
  v_mfma_f32_16x16x32_bf16 a[76:79], a[172:175], v[52:55], a[76:79]
  ds_read_b64_tr_b16 a[172:173], v8 offset:49152
  ds_read_b64_tr_b16 a[174:175], v8 offset:53248
  v_mfma_f32_16x16x32_bf16 a[80:83], a[176:179], v[52:55], a[80:83]
  ds_read_b64_tr_b16 a[176:177], v9 offset:49152
  ds_read_b64_tr_b16 a[178:179], v9 offset:53248
  v_mfma_f32_16x16x32_bf16 a[84:87], a[180:183], v[52:55], a[84:87]
  ds_read_b64_tr_b16 a[180:181], v10 offset:49152
  ds_read_b64_tr_b16 a[182:183], v10 offset:53248
  v_mfma_f32_16x16x32_bf16 a[88:91], a[184:187], v[52:55], a[88:91]
  ds_read_b64_tr_b16 a[184:185], v11 offset:49152
  ds_read_b64_tr_b16 a[186:187], v11 offset:53248
  v_mfma_f32_16x16x32_bf16 a[92:95], a[188:191], v[52:55], a[92:95]
  ds_read_b64_tr_b16 a[188:189], v12 offset:49152
  ds_read_b64_tr_b16 a[190:191], v12 offset:53248
  v_mfma_f32_16x16x32_bf16 a[200:203], a[216:219], v[52:55], a[200:203]
  v_mfma_f32_16x16x32_bf16 v[32:35], a[128:131], v[112:115], v[64:67]
  v_exp_f32 v40, v40
  v_mfma_f32_16x16x32_bf16 v[32:35], a[132:135], v[116:119], v[32:35]
  ds_read_b128 a[128:131], v1 offset:57344
  ds_read_b128 a[132:135], v2 offset:57344
  v_mfma_f32_16x16x32_bf16 v[32:35], a[136:139], v[120:123], v[32:35]
  v_exp_f32 v41, v41
  v_mfma_f32_16x16x32_bf16 v[32:35], a[140:143], v[124:127], v[32:35]
  ds_read_b128 a[136:139], v3 offset:57344
  ds_read_b128 a[140:143], v4 offset:57344
  v_mfma_f32_16x16x32_bf16 v[36:39], a[144:147], v[112:115], v[64:67]
  v_exp_f32 v42, v42
  v_mfma_f32_16x16x32_bf16 v[36:39], a[148:151], v[116:119], v[36:39]
  ds_read_b128 a[144:147], v1 offset:61440
  ds_read_b128 a[148:151], v2 offset:61440
  v_mfma_f32_16x16x32_bf16 v[36:39], a[152:155], v[120:123], v[36:39]
  s_waitcnt lgkmcnt(6)
  v_cvt_pk_bf16_f32 v52, v40, v41
  v_mfma_f32_16x16x32_bf16 v[36:39], a[156:159], v[124:127], v[36:39]
  ds_read_b128 a[152:155], v3 offset:61440
  ds_read_b128 a[156:159], v4 offset:61440
  v_mfma_f32_16x16x32_bf16 a[0:3], a[160:163], v[48:51], a[0:3]
  v_exp_f32 v43, v43
  v_mfma_f32_16x16x32_bf16 a[4:7], a[164:167], v[48:51], a[4:7]
  v_exp_f32 v44, v44
  v_mfma_f32_16x16x32_bf16 a[8:11], a[168:171], v[48:51], a[8:11]
  v_exp_f32 v45, v45
  v_mfma_f32_16x16x32_bf16 a[12:15], a[172:175], v[48:51], a[12:15]
  v_cvt_pk_bf16_f32 v53, v42, v43
  v_cvt_pk_bf16_f32 v54, v44, v45
  v_mfma_f32_16x16x32_bf16 a[16:19], a[176:179], v[48:51], a[16:19]
  v_exp_f32 v46, v46
  v_mfma_f32_16x16x32_bf16 a[20:23], a[180:183], v[48:51], a[20:23]
  v_exp_f32 v47, v47
  v_mfma_f32_16x16x32_bf16 a[24:27], a[184:187], v[48:51], a[24:27]
  v_cvt_pk_bf16_f32 v55, v46, v47
  v_mfma_f32_16x16x32_bf16 a[28:31], a[188:191], v[48:51], a[28:31]
  v_mfma_f32_16x16x32_bf16 a[192:195], a[216:219], v[48:51], a[192:195]
  s_waitcnt lgkmcnt(0)
  v_mfma_f32_16x16x32_bf16 v[40:43], a[128:131], v[80:83], v[56:59]
  v_exp_f32 v32, v32
  v_mfma_f32_16x16x32_bf16 v[40:43], a[132:135], v[84:87], v[40:43]
  v_exp_f32 v33, v33
  v_mfma_f32_16x16x32_bf16 v[40:43], a[136:139], v[88:91], v[40:43]
  v_exp_f32 v34, v34
  v_mfma_f32_16x16x32_bf16 v[40:43], a[140:143], v[92:95], v[40:43]
  v_exp_f32 v35, v35
  v_mfma_f32_16x16x32_bf16 v[44:47], a[144:147], v[80:83], v[56:59]
  v_cvt_pk_bf16_f32 v48, v32, v33
  v_cvt_pk_bf16_f32 v49, v34, v35
  v_mfma_f32_16x16x32_bf16 v[44:47], a[148:151], v[84:87], v[44:47]
  v_exp_f32 v36, v36
  v_mfma_f32_16x16x32_bf16 v[44:47], a[152:155], v[88:91], v[44:47]
  v_exp_f32 v37, v37
  v_mfma_f32_16x16x32_bf16 v[44:47], a[156:159], v[92:95], v[44:47]
  v_exp_f32 v38, v38
  v_mfma_f32_16x16x32_bf16 a[32:35], a[160:163], v[52:55], a[32:35]
  v_exp_f32 v39, v39
  v_mfma_f32_16x16x32_bf16 a[36:39], a[164:167], v[52:55], a[36:39]
  v_cvt_pk_bf16_f32 v50, v36, v37
  v_cvt_pk_bf16_f32 v51, v38, v39
  v_mfma_f32_16x16x32_bf16 a[40:43], a[168:171], v[52:55], a[40:43]
  v_exp_f32 v40, v40
  v_mfma_f32_16x16x32_bf16 a[44:47], a[172:175], v[52:55], a[44:47]
  v_exp_f32 v41, v41
  v_mfma_f32_16x16x32_bf16 a[48:51], a[176:179], v[52:55], a[48:51]
  v_mfma_f32_16x16x32_bf16 a[52:55], a[180:183], v[52:55], a[52:55]
  v_mfma_f32_16x16x32_bf16 a[56:59], a[184:187], v[52:55], a[56:59]
  v_mfma_f32_16x16x32_bf16 a[60:63], a[188:191], v[52:55], a[60:63]
  v_mfma_f32_16x16x32_bf16 a[196:199], a[216:219], v[52:55], a[196:199]
  v_mfma_f32_16x16x32_bf16 v[32:35], a[128:131], v[96:99], v[60:63]
  v_exp_f32 v42, v42
  v_mfma_f32_16x16x32_bf16 v[32:35], a[132:135], v[100:103], v[32:35]
  v_exp_f32 v43, v43
  v_mfma_f32_16x16x32_bf16 v[32:35], a[136:139], v[104:107], v[32:35]
  v_cvt_pk_bf16_f32 v52, v40, v41
  v_cvt_pk_bf16_f32 v53, v42, v43
  v_mfma_f32_16x16x32_bf16 v[32:35], a[140:143], v[108:111], v[32:35]
  v_exp_f32 v44, v44
  v_mfma_f32_16x16x32_bf16 v[36:39], a[144:147], v[96:99], v[60:63]
  v_exp_f32 v45, v45
  v_mfma_f32_16x16x32_bf16 v[36:39], a[148:151], v[100:103], v[36:39]
  v_exp_f32 v46, v46
  v_mfma_f32_16x16x32_bf16 v[36:39], a[152:155], v[104:107], v[36:39]
  v_exp_f32 v47, v47
  v_mfma_f32_16x16x32_bf16 v[36:39], a[156:159], v[108:111], v[36:39]
  v_cvt_pk_bf16_f32 v54, v44, v45
  v_cvt_pk_bf16_f32 v55, v46, v47
  v_mfma_f32_16x16x32_bf16 a[64:67], a[160:163], v[48:51], a[64:67]
  ds_read_b64_tr_b16 a[160:161], v5 offset:57344
  ds_read_b64_tr_b16 a[162:163], v5 offset:61440
  v_mfma_f32_16x16x32_bf16 a[68:71], a[164:167], v[48:51], a[68:71]
  ds_read_b64_tr_b16 a[164:165], v6 offset:57344
  ds_read_b64_tr_b16 a[166:167], v6 offset:61440
  v_mfma_f32_16x16x32_bf16 a[72:75], a[168:171], v[48:51], a[72:75]
  ds_read_b64_tr_b16 a[168:169], v7 offset:57344
  ds_read_b64_tr_b16 a[170:171], v7 offset:61440
  v_mfma_f32_16x16x32_bf16 a[76:79], a[172:175], v[48:51], a[76:79]
  ds_read_b64_tr_b16 a[172:173], v8 offset:57344
  ds_read_b64_tr_b16 a[174:175], v8 offset:61440
  v_mfma_f32_16x16x32_bf16 a[80:83], a[176:179], v[48:51], a[80:83]
  ds_read_b64_tr_b16 a[176:177], v9 offset:57344
  ds_read_b64_tr_b16 a[178:179], v9 offset:61440
  v_mfma_f32_16x16x32_bf16 a[84:87], a[180:183], v[48:51], a[84:87]
  ds_read_b64_tr_b16 a[180:181], v10 offset:57344
  ds_read_b64_tr_b16 a[182:183], v10 offset:61440
  v_mfma_f32_16x16x32_bf16 a[88:91], a[184:187], v[48:51], a[88:91]
  ds_read_b64_tr_b16 a[184:185], v11 offset:57344
  ds_read_b64_tr_b16 a[186:187], v11 offset:61440
  v_mfma_f32_16x16x32_bf16 a[92:95], a[188:191], v[48:51], a[92:95]
  ds_read_b64_tr_b16 a[188:189], v12 offset:57344
  ds_read_b64_tr_b16 a[190:191], v12 offset:61440
  v_mfma_f32_16x16x32_bf16 a[200:203], a[216:219], v[48:51], a[200:203]
  v_mfma_f32_16x16x32_bf16 v[40:43], a[128:131], v[112:115], v[64:67]
  v_exp_f32 v32, v32
  v_mfma_f32_16x16x32_bf16 v[40:43], a[132:135], v[116:119], v[40:43]
  ds_read_b128 a[128:131], v1 offset:32768
  ds_read_b128 a[132:135], v2 offset:32768
  v_mfma_f32_16x16x32_bf16 v[40:43], a[136:139], v[120:123], v[40:43]
  v_exp_f32 v33, v33
  v_mfma_f32_16x16x32_bf16 v[40:43], a[140:143], v[124:127], v[40:43]
  ds_read_b128 a[136:139], v3 offset:32768
  ds_read_b128 a[140:143], v4 offset:32768
  v_mfma_f32_16x16x32_bf16 v[44:47], a[144:147], v[112:115], v[64:67]
  v_exp_f32 v34, v34
  v_mfma_f32_16x16x32_bf16 v[44:47], a[148:151], v[116:119], v[44:47]
  ds_read_b128 a[144:147], v1 offset:36864
  ds_read_b128 a[148:151], v2 offset:36864
  v_mfma_f32_16x16x32_bf16 v[44:47], a[152:155], v[120:123], v[44:47]
  s_waitcnt lgkmcnt(6)
  v_cvt_pk_bf16_f32 v48, v32, v33
  v_mfma_f32_16x16x32_bf16 v[44:47], a[156:159], v[124:127], v[44:47]
  ds_read_b128 a[152:155], v3 offset:36864
  ds_read_b128 a[156:159], v4 offset:36864
  v_mfma_f32_16x16x32_bf16 a[0:3], a[160:163], v[52:55], a[0:3]
  v_exp_f32 v35, v35
  v_mfma_f32_16x16x32_bf16 a[4:7], a[164:167], v[52:55], a[4:7]
  v_exp_f32 v36, v36
  v_mfma_f32_16x16x32_bf16 a[8:11], a[168:171], v[52:55], a[8:11]
  v_exp_f32 v37, v37
  v_mfma_f32_16x16x32_bf16 a[12:15], a[172:175], v[52:55], a[12:15]
  v_cvt_pk_bf16_f32 v49, v34, v35
  v_cvt_pk_bf16_f32 v50, v36, v37
  v_mfma_f32_16x16x32_bf16 a[16:19], a[176:179], v[52:55], a[16:19]
  v_exp_f32 v38, v38
  v_mfma_f32_16x16x32_bf16 a[20:23], a[180:183], v[52:55], a[20:23]
  v_exp_f32 v39, v39
  v_mfma_f32_16x16x32_bf16 a[24:27], a[184:187], v[52:55], a[24:27]
  v_cvt_pk_bf16_f32 v51, v38, v39
  v_mfma_f32_16x16x32_bf16 a[28:31], a[188:191], v[52:55], a[28:31]
  v_mfma_f32_16x16x32_bf16 a[192:195], a[216:219], v[52:55], a[192:195]
  s_waitcnt lgkmcnt(0)
  v_mfma_f32_16x16x32_bf16 v[32:35], a[128:131], v[128:131], v[68:71]
  v_exp_f32 v40, v40
  v_mfma_f32_16x16x32_bf16 v[32:35], a[132:135], v[132:135], v[32:35]
  v_exp_f32 v41, v41
  v_mfma_f32_16x16x32_bf16 v[32:35], a[136:139], v[136:139], v[32:35]
  v_exp_f32 v42, v42
  v_mfma_f32_16x16x32_bf16 v[32:35], a[140:143], v[140:143], v[32:35]
  v_exp_f32 v43, v43
  v_mfma_f32_16x16x32_bf16 v[36:39], a[144:147], v[128:131], v[68:71]
  v_cvt_pk_bf16_f32 v52, v40, v41
  v_cvt_pk_bf16_f32 v53, v42, v43
  v_mfma_f32_16x16x32_bf16 v[36:39], a[148:151], v[132:135], v[36:39]
  v_exp_f32 v44, v44
  v_mfma_f32_16x16x32_bf16 v[36:39], a[152:155], v[136:139], v[36:39]
  v_exp_f32 v45, v45
  v_mfma_f32_16x16x32_bf16 v[36:39], a[156:159], v[140:143], v[36:39]
  v_exp_f32 v46, v46
  v_mfma_f32_16x16x32_bf16 a[32:35], a[160:163], v[48:51], a[32:35]
  v_exp_f32 v47, v47
  v_mfma_f32_16x16x32_bf16 a[36:39], a[164:167], v[48:51], a[36:39]
  v_cvt_pk_bf16_f32 v54, v44, v45
  v_cvt_pk_bf16_f32 v55, v46, v47
  v_mfma_f32_16x16x32_bf16 a[40:43], a[168:171], v[48:51], a[40:43]
  v_exp_f32 v32, v32
  v_mfma_f32_16x16x32_bf16 a[44:47], a[172:175], v[48:51], a[44:47]
  v_exp_f32 v33, v33
  v_mfma_f32_16x16x32_bf16 a[48:51], a[176:179], v[48:51], a[48:51]
  v_mfma_f32_16x16x32_bf16 a[52:55], a[180:183], v[48:51], a[52:55]
  v_mfma_f32_16x16x32_bf16 a[56:59], a[184:187], v[48:51], a[56:59]
  v_mfma_f32_16x16x32_bf16 a[60:63], a[188:191], v[48:51], a[60:63]
  v_mfma_f32_16x16x32_bf16 a[196:199], a[216:219], v[48:51], a[196:199]
  v_mfma_f32_16x16x32_bf16 v[40:43], a[128:131], v[144:147], v[72:75]
  v_exp_f32 v34, v34
  v_mfma_f32_16x16x32_bf16 v[40:43], a[132:135], v[148:151], v[40:43]
  v_exp_f32 v35, v35
  v_mfma_f32_16x16x32_bf16 v[40:43], a[136:139], v[152:155], v[40:43]
  v_cvt_pk_bf16_f32 v48, v32, v33
  v_cvt_pk_bf16_f32 v49, v34, v35
  v_mfma_f32_16x16x32_bf16 v[40:43], a[140:143], v[156:159], v[40:43]
  v_exp_f32 v36, v36
  v_mfma_f32_16x16x32_bf16 v[44:47], a[144:147], v[144:147], v[72:75]
  v_exp_f32 v37, v37
  v_mfma_f32_16x16x32_bf16 v[44:47], a[148:151], v[148:151], v[44:47]
  v_exp_f32 v38, v38
  v_mfma_f32_16x16x32_bf16 v[44:47], a[152:155], v[152:155], v[44:47]
  v_exp_f32 v39, v39
  v_mfma_f32_16x16x32_bf16 v[44:47], a[156:159], v[156:159], v[44:47]
  v_cvt_pk_bf16_f32 v50, v36, v37
  v_cvt_pk_bf16_f32 v51, v38, v39
  v_mfma_f32_16x16x32_bf16 a[64:67], a[160:163], v[52:55], a[64:67]
  ds_read_b64_tr_b16 a[160:161], v5 offset:32768
  ds_read_b64_tr_b16 a[162:163], v5 offset:36864
  v_mfma_f32_16x16x32_bf16 a[68:71], a[164:167], v[52:55], a[68:71]
  ds_read_b64_tr_b16 a[164:165], v6 offset:32768
  ds_read_b64_tr_b16 a[166:167], v6 offset:36864
  v_mfma_f32_16x16x32_bf16 a[72:75], a[168:171], v[52:55], a[72:75]
  ds_read_b64_tr_b16 a[168:169], v7 offset:32768
  ds_read_b64_tr_b16 a[170:171], v7 offset:36864
  v_mfma_f32_16x16x32_bf16 a[76:79], a[172:175], v[52:55], a[76:79]
  ds_read_b64_tr_b16 a[172:173], v8 offset:32768
  ds_read_b64_tr_b16 a[174:175], v8 offset:36864
  v_mfma_f32_16x16x32_bf16 a[80:83], a[176:179], v[52:55], a[80:83]
  ds_read_b64_tr_b16 a[176:177], v9 offset:32768
  ds_read_b64_tr_b16 a[178:179], v9 offset:36864
  v_mfma_f32_16x16x32_bf16 a[84:87], a[180:183], v[52:55], a[84:87]
  ds_read_b64_tr_b16 a[180:181], v10 offset:32768
  ds_read_b64_tr_b16 a[182:183], v10 offset:36864
  v_mfma_f32_16x16x32_bf16 a[88:91], a[184:187], v[52:55], a[88:91]
  ds_read_b64_tr_b16 a[184:185], v11 offset:32768
  ds_read_b64_tr_b16 a[186:187], v11 offset:36864
  v_mfma_f32_16x16x32_bf16 a[92:95], a[188:191], v[52:55], a[92:95]
  ds_read_b64_tr_b16 a[188:189], v12 offset:32768
  ds_read_b64_tr_b16 a[190:191], v12 offset:36864
  v_mfma_f32_16x16x32_bf16 a[200:203], a[216:219], v[52:55], a[200:203]
  v_mfma_f32_16x16x32_bf16 v[32:35], a[128:131], v[160:163], v[76:79]
  ds_read_b128 a[128:131], v1 offset:40960
  v_exp_f32 v40, v40
  v_exp_f32 v41, v41
  v_mfma_f32_16x16x32_bf16 v[32:35], a[132:135], v[164:167], v[32:35]
  ds_read_b128 a[132:135], v2 offset:40960
  v_exp_f32 v42, v42
  v_mfma_f32_16x16x32_bf16 v[32:35], a[136:139], v[168:171], v[32:35]
  ds_read_b128 a[136:139], v3 offset:40960
  v_cvt_pk_bf16_f32 v52, v40, v41
  v_exp_f32 v43, v43
  v_mfma_f32_16x16x32_bf16 v[32:35], a[140:143], v[172:175], v[32:35]
  ds_read_b128 a[140:143], v4 offset:40960
  v_exp_f32 v44, v44
  v_mfma_f32_16x16x32_bf16 v[36:39], a[144:147], v[160:163], v[76:79]
  ds_read_b128 a[144:147], v1 offset:45056
  v_cvt_pk_bf16_f32 v53, v42, v43
  v_exp_f32 v45, v45
  v_mfma_f32_16x16x32_bf16 v[36:39], a[148:151], v[164:167], v[36:39]
  ds_read_b128 a[148:151], v2 offset:45056
  v_exp_f32 v46, v46
  v_cvt_pk_bf16_f32 v54, v44, v45
  v_mfma_f32_16x16x32_bf16 v[36:39], a[152:155], v[168:171], v[36:39]
  ds_read_b128 a[152:155], v3 offset:45056
  v_exp_f32 v47, v47
  v_mfma_f32_16x16x32_bf16 v[36:39], a[156:159], v[172:175], v[36:39]
  ds_read_b128 a[156:159], v4 offset:45056
  v_cvt_pk_bf16_f32 v55, v46, v47
  v_accvgpr_read_b32 v23, a192
  v_rcp_f32 v22, v23
  s_waitcnt lgkmcnt(8)
  v_mfma_f32_16x16x32_bf16 a[96:99], a[160:163], v[48:51], a[96:99]
  v_mov_b32 v21, v23
  v_accvgpr_read_b32 v23, a254
  v_mfma_f32_16x16x32_bf16 a[100:103], a[164:167], v[48:51], a[100:103]
  v_accvgpr_read_b32 v240, a0
  v_accvgpr_read_b32 v241, a1
  v_accvgpr_read_b32 v242, a2
  v_mfma_f32_16x16x32_bf16 a[104:107], a[168:171], v[48:51], a[104:107]
  v_accvgpr_read_b32 v243, a3
  v_accvgpr_read_b32 v244, a4
  v_mfma_f32_16x16x32_bf16 a[108:111], a[172:175], v[48:51], a[108:111]
  v_accvgpr_read_b32 v245, a5
  v_accvgpr_read_b32 v246, a6
  v_accvgpr_read_b32 v247, a7
  v_pk_mul_f32 v[240:241], v[240:241], v[22:23] op_sel_hi:[1,0]
  v_pk_mul_f32 v[242:243], v[242:243], v[22:23] op_sel_hi:[1,0]
  v_pk_mul_f32 v[244:245], v[244:245], v[22:23] op_sel_hi:[1,0]
  v_pk_mul_f32 v[246:247], v[246:247], v[22:23] op_sel_hi:[1,0]
  v_mfma_f32_16x16x32_bf16 a[112:115], a[176:179], v[48:51], a[112:115]
  v_cvt_pk_bf16_f32 v24, v240, v241
  v_mfma_f32_16x16x32_bf16 a[116:119], a[180:183], v[48:51], a[116:119]
  v_cvt_pk_bf16_f32 v25, v242, v243
  v_mfma_f32_16x16x32_bf16 a[120:123], a[184:187], v[48:51], a[120:123]
  v_cvt_pk_bf16_f32 v26, v244, v245
  v_cvt_pk_bf16_f32 v27, v246, v247
  v_mfma_f32_16x16x32_bf16 a[124:127], a[188:191], v[48:51], a[124:127]
  ds_write_b64 v23, v[24:25] offset:0
  v_xor_b32 v23, 32, v23
  ds_write_b64 v23, v[26:27] offset:0
  v_mfma_f32_16x16x32_bf16 a[204:207], a[216:219], v[48:51], a[204:207]
  v_xor_b32 v23, 96, v23
  v_accvgpr_read_b32 v240, a8
  s_waitcnt lgkmcnt(2)
  v_mfma_f32_16x16x32_bf16 v[40:43], a[128:131], v[128:131], v[68:71]
  v_exp_f32 v32, v32
  v_exp_f32 v33, v33
  v_mfma_f32_16x16x32_bf16 v[40:43], a[132:135], v[132:135], v[40:43]
  v_exp_f32 v34, v34
  v_mfma_f32_16x16x32_bf16 v[40:43], a[136:139], v[136:139], v[40:43]
  v_cvt_pk_bf16_f32 v48, v32, v33
  v_exp_f32 v35, v35
  v_mfma_f32_16x16x32_bf16 v[40:43], a[140:143], v[140:143], v[40:43]
  v_exp_f32 v36, v36
  v_mfma_f32_16x16x32_bf16 v[44:47], a[144:147], v[128:131], v[68:71]
  v_cvt_pk_bf16_f32 v49, v34, v35
  v_exp_f32 v37, v37
  v_mfma_f32_16x16x32_bf16 v[44:47], a[148:151], v[132:135], v[44:47]
  v_exp_f32 v38, v38
  v_cvt_pk_bf16_f32 v50, v36, v37
  v_mfma_f32_16x16x32_bf16 v[44:47], a[152:155], v[136:139], v[44:47]
  v_exp_f32 v39, v39
  v_mfma_f32_16x16x32_bf16 v[44:47], a[156:159], v[140:143], v[44:47]
  v_cvt_pk_bf16_f32 v51, v38, v39
  v_accvgpr_read_b32 v241, a9
  v_accvgpr_read_b32 v242, a10
  v_mfma_f32_16x16x32_bf16 v[176:179], a[160:163], v[52:55], v[176:179]
  v_accvgpr_read_b32 v243, a11
  v_accvgpr_read_b32 v244, a12
  v_accvgpr_read_b32 v245, a13
  v_accvgpr_read_b32 v246, a14
  v_accvgpr_read_b32 v247, a15
  v_pk_mul_f32 v[240:241], v[240:241], v[22:23] op_sel_hi:[1,0]
  v_pk_mul_f32 v[242:243], v[242:243], v[22:23] op_sel_hi:[1,0]
  v_pk_mul_f32 v[244:245], v[244:245], v[22:23] op_sel_hi:[1,0]
  v_pk_mul_f32 v[246:247], v[246:247], v[22:23] op_sel_hi:[1,0]
  v_mfma_f32_16x16x32_bf16 v[180:183], a[164:167], v[52:55], v[180:183]
  v_cvt_pk_bf16_f32 v28, v240, v241
  v_mfma_f32_16x16x32_bf16 v[184:187], a[168:171], v[52:55], v[184:187]
  v_cvt_pk_bf16_f32 v29, v242, v243
  v_mfma_f32_16x16x32_bf16 v[188:191], a[172:175], v[52:55], v[188:191]
  v_cvt_pk_bf16_f32 v30, v244, v245
  v_mfma_f32_16x16x32_bf16 v[192:195], a[176:179], v[52:55], v[192:195]
  v_cvt_pk_bf16_f32 v31, v246, v247
  ds_write_b64 v23, v[28:29] offset:0
  v_mfma_f32_16x16x32_bf16 v[196:199], a[180:183], v[52:55], v[196:199]
  v_xor_b32 v23, 32, v23
  ds_write_b64 v23, v[30:31] offset:0
  v_mfma_f32_16x16x32_bf16 v[200:203], a[184:187], v[52:55], v[200:203]
  v_xor_b32 v23, 224, v23
  v_accvgpr_read_b32 v240, a16
  v_accvgpr_read_b32 v241, a17
  v_mfma_f32_16x16x32_bf16 v[204:207], a[188:191], v[52:55], v[204:207]
  v_accvgpr_read_b32 v242, a18
  v_accvgpr_read_b32 v243, a19
  v_accvgpr_read_b32 v244, a20
  v_mfma_f32_16x16x32_bf16 a[208:211], a[216:219], v[52:55], a[208:211]
  v_accvgpr_read_b32 v245, a21
  v_accvgpr_read_b32 v246, a22
  v_mfma_f32_16x16x32_bf16 v[32:35], a[128:131], v[144:147], v[72:75]
  v_exp_f32 v40, v40
  v_exp_f32 v41, v41
  v_mfma_f32_16x16x32_bf16 v[32:35], a[132:135], v[148:151], v[32:35]
  v_exp_f32 v42, v42
  v_mfma_f32_16x16x32_bf16 v[32:35], a[136:139], v[152:155], v[32:35]
  v_cvt_pk_bf16_f32 v52, v40, v41
  v_exp_f32 v43, v43
  v_mfma_f32_16x16x32_bf16 v[32:35], a[140:143], v[156:159], v[32:35]
  v_exp_f32 v44, v44
  v_mfma_f32_16x16x32_bf16 v[36:39], a[144:147], v[144:147], v[72:75]
  v_cvt_pk_bf16_f32 v53, v42, v43
  v_exp_f32 v45, v45
  v_mfma_f32_16x16x32_bf16 v[36:39], a[148:151], v[148:151], v[36:39]
  v_exp_f32 v46, v46
  v_cvt_pk_bf16_f32 v54, v44, v45
  v_mfma_f32_16x16x32_bf16 v[36:39], a[152:155], v[152:155], v[36:39]
  v_exp_f32 v47, v47
  s_nop 0
  v_cvt_pk_bf16_f32 v55, v46, v47
  v_accvgpr_read_b32 v247, a23
  v_pk_mul_f32 v[240:241], v[240:241], v[22:23] op_sel_hi:[1,0]
  v_pk_mul_f32 v[242:243], v[242:243], v[22:23] op_sel_hi:[1,0]
  v_pk_mul_f32 v[244:245], v[244:245], v[22:23] op_sel_hi:[1,0]
  v_pk_mul_f32 v[246:247], v[246:247], v[22:23] op_sel_hi:[1,0]
  v_mfma_f32_16x16x32_bf16 v[36:39], a[156:159], v[156:159], v[36:39]
  v_cvt_pk_bf16_f32 v24, v240, v241
  v_mfma_f32_16x16x32_bf16 v[208:211], a[160:163], v[48:51], v[208:211]
  ds_read_b64_tr_b16 a[160:161], v5 offset:40960
  ds_read_b64_tr_b16 a[162:163], v5 offset:45056
  v_cvt_pk_bf16_f32 v25, v242, v243
  v_mfma_f32_16x16x32_bf16 v[212:215], a[164:167], v[48:51], v[212:215]
  ds_read_b64_tr_b16 a[164:165], v6 offset:40960
  ds_read_b64_tr_b16 a[166:167], v6 offset:45056
  v_cvt_pk_bf16_f32 v26, v244, v245
  v_mfma_f32_16x16x32_bf16 v[216:219], a[168:171], v[48:51], v[216:219]
  ds_read_b64_tr_b16 a[168:169], v7 offset:40960
  ds_read_b64_tr_b16 a[170:171], v7 offset:45056
  v_cvt_pk_bf16_f32 v27, v246, v247
  ds_write_b64 v23, v[24:25] offset:0
  v_mfma_f32_16x16x32_bf16 v[220:223], a[172:175], v[48:51], v[220:223]
  ds_read_b64_tr_b16 a[172:173], v8 offset:40960
  ds_read_b64_tr_b16 a[174:175], v8 offset:45056
  v_xor_b32 v23, 32, v23
  ds_write_b64 v23, v[26:27] offset:0
  v_xor_b32 v23, 96, v23
  v_mfma_f32_16x16x32_bf16 v[224:227], a[176:179], v[48:51], v[224:227]
  ds_read_b64_tr_b16 a[176:177], v9 offset:40960
  ds_read_b64_tr_b16 a[178:179], v9 offset:45056
  v_accvgpr_read_b32 v240, a24
  v_accvgpr_read_b32 v241, a25
  v_accvgpr_read_b32 v242, a26
  v_mfma_f32_16x16x32_bf16 v[228:231], a[180:183], v[48:51], v[228:231]
  ds_read_b64_tr_b16 a[180:181], v10 offset:40960
  ds_read_b64_tr_b16 a[182:183], v10 offset:45056
  v_accvgpr_read_b32 v243, a27
  v_accvgpr_read_b32 v244, a28
  v_mfma_f32_16x16x32_bf16 v[232:235], a[184:187], v[48:51], v[232:235]
  ds_read_b64_tr_b16 a[184:185], v11 offset:40960
  ds_read_b64_tr_b16 a[186:187], v11 offset:45056
  v_accvgpr_read_b32 v245, a29
  v_accvgpr_read_b32 v246, a30
  v_accvgpr_read_b32 v247, a31
  v_pk_mul_f32 v[240:241], v[240:241], v[22:23] op_sel_hi:[1,0]
  v_pk_mul_f32 v[242:243], v[242:243], v[22:23] op_sel_hi:[1,0]
  v_pk_mul_f32 v[244:245], v[244:245], v[22:23] op_sel_hi:[1,0]
  v_pk_mul_f32 v[246:247], v[246:247], v[22:23] op_sel_hi:[1,0]
  v_mfma_f32_16x16x32_bf16 v[236:239], a[188:191], v[48:51], v[236:239]
  ds_read_b64_tr_b16 a[188:189], v12 offset:40960
  ds_read_b64_tr_b16 a[190:191], v12 offset:45056
  v_cvt_pk_bf16_f32 v28, v240, v241
  v_mfma_f32_16x16x32_bf16 a[212:215], a[216:219], v[48:51], a[212:215]
  v_mfma_f32_16x16x32_bf16 v[40:43], a[128:131], v[160:163], v[76:79]
  ds_read_b128 a[128:131], v1 offset:49152
  v_exp_f32 v32, v32
  v_exp_f32 v33, v33
  v_mfma_f32_16x16x32_bf16 v[40:43], a[132:135], v[164:167], v[40:43]
  ds_read_b128 a[132:135], v2 offset:49152
  v_exp_f32 v34, v34
  v_mfma_f32_16x16x32_bf16 v[40:43], a[136:139], v[168:171], v[40:43]
  ds_read_b128 a[136:139], v3 offset:49152
  v_cvt_pk_bf16_f32 v48, v32, v33
  v_exp_f32 v35, v35
  v_mfma_f32_16x16x32_bf16 v[40:43], a[140:143], v[172:175], v[40:43]
  ds_read_b128 a[140:143], v4 offset:49152
  v_exp_f32 v36, v36
  v_cvt_pk_bf16_f32 v49, v34, v35
  v_mfma_f32_16x16x32_bf16 v[44:47], a[144:147], v[160:163], v[76:79]
  ds_read_b128 a[144:147], v1 offset:53248
  v_exp_f32 v37, v37
  v_mfma_f32_16x16x32_bf16 v[44:47], a[148:151], v[164:167], v[44:47]
  ds_read_b128 a[148:151], v2 offset:53248
  v_exp_f32 v38, v38
  v_cvt_pk_bf16_f32 v50, v36, v37
  v_mfma_f32_16x16x32_bf16 v[44:47], a[152:155], v[168:171], v[44:47]
  ds_read_b128 a[152:155], v3 offset:53248
  v_exp_f32 v39, v39
  s_nop 0
  v_cvt_pk_bf16_f32 v51, v38, v39
  v_mfma_f32_16x16x32_bf16 v[44:47], a[156:159], v[172:175], v[44:47]
  ds_read_b128 a[156:159], v4 offset:53248
  v_cvt_pk_bf16_f32 v29, v242, v243
  v_cvt_pk_bf16_f32 v30, v244, v245
  v_cvt_pk_bf16_f32 v31, v246, v247
  s_waitcnt lgkmcnt(8)
  v_mfma_f32_16x16x32_bf16 a[96:99], a[160:163], v[52:55], a[96:99]
  ds_write_b64 v23, v[28:29] offset:0
  v_xor_b32 v23, 32, v23
  v_mfma_f32_16x16x32_bf16 a[100:103], a[164:167], v[52:55], a[100:103]
  ds_write_b64 v23, v[30:31] offset:0
  v_accvgpr_read_b32 v23, a255
  ds_read_b128 a[0:3], v23 offset:0
  v_mfma_f32_16x16x32_bf16 a[104:107], a[168:171], v[52:55], a[104:107]
  v_xor_b32 v23, 64, v23
  ds_read_b128 a[4:7], v23 offset:1024
  v_xor_b32 v23, 192, v23
  v_mfma_f32_16x16x32_bf16 a[108:111], a[172:175], v[52:55], a[108:111]
  ds_read_b128 a[8:11], v23 offset:2048
  v_xor_b32 v23, 64, v23
  ds_read_b128 a[12:15], v23 offset:3072
  v_mfma_f32_16x16x32_bf16 a[112:115], a[176:179], v[52:55], a[112:115]
  v_accvgpr_read_b32 v23, a196
  v_rcp_f32 v22, v23
  v_mfma_f32_16x16x32_bf16 a[116:119], a[180:183], v[52:55], a[116:119]
  v_add_f32 v21, v21, v23
  v_accvgpr_read_b32 v23, a254
  v_mfma_f32_16x16x32_bf16 a[120:123], a[184:187], v[52:55], a[120:123]
  v_accvgpr_read_b32 v240, a32
  v_accvgpr_read_b32 v241, a33
  v_accvgpr_read_b32 v242, a34
  v_mfma_f32_16x16x32_bf16 a[124:127], a[188:191], v[52:55], a[124:127]
  v_accvgpr_read_b32 v243, a35
  v_accvgpr_read_b32 v244, a36
  v_accvgpr_read_b32 v245, a37
  v_mfma_f32_16x16x32_bf16 a[204:207], a[216:219], v[52:55], a[204:207]
  v_accvgpr_read_b32 v246, a38
  v_accvgpr_read_b32 v247, a39
  s_waitcnt lgkmcnt(6)
  v_mfma_f32_16x16x32_bf16 v[32:35], a[128:131], v[128:131], v[68:71]
  v_exp_f32 v40, v40
  v_exp_f32 v41, v41
  v_mfma_f32_16x16x32_bf16 v[32:35], a[132:135], v[132:135], v[32:35]
  v_exp_f32 v42, v42
  v_mfma_f32_16x16x32_bf16 v[32:35], a[136:139], v[136:139], v[32:35]
  v_cvt_pk_bf16_f32 v52, v40, v41
  v_exp_f32 v43, v43
  v_mfma_f32_16x16x32_bf16 v[32:35], a[140:143], v[140:143], v[32:35]
  v_exp_f32 v44, v44
  v_mfma_f32_16x16x32_bf16 v[36:39], a[144:147], v[128:131], v[68:71]
  v_cvt_pk_bf16_f32 v53, v42, v43
  v_exp_f32 v45, v45
  v_mfma_f32_16x16x32_bf16 v[36:39], a[148:151], v[132:135], v[36:39]
  v_exp_f32 v46, v46
  v_cvt_pk_bf16_f32 v54, v44, v45
  v_exp_f32 v47, v47
  s_nop 0
  v_cvt_pk_bf16_f32 v55, v46, v47
  v_pk_mul_f32 v[240:241], v[240:241], v[22:23] op_sel_hi:[1,0]
  v_pk_mul_f32 v[242:243], v[242:243], v[22:23] op_sel_hi:[1,0]
  v_pk_mul_f32 v[244:245], v[244:245], v[22:23] op_sel_hi:[1,0]
  v_pk_mul_f32 v[246:247], v[246:247], v[22:23] op_sel_hi:[1,0]
  v_mfma_f32_16x16x32_bf16 v[36:39], a[152:155], v[136:139], v[36:39]
  v_cvt_pk_bf16_f32 v24, v240, v241
  v_mfma_f32_16x16x32_bf16 v[36:39], a[156:159], v[140:143], v[36:39]
  v_cvt_pk_bf16_f32 v25, v242, v243
  v_mfma_f32_16x16x32_bf16 v[176:179], a[160:163], v[48:51], v[176:179]
  v_cvt_pk_bf16_f32 v26, v244, v245
  v_mfma_f32_16x16x32_bf16 v[180:183], a[164:167], v[48:51], v[180:183]
  v_cvt_pk_bf16_f32 v27, v246, v247
  v_mfma_f32_16x16x32_bf16 v[184:187], a[168:171], v[48:51], v[184:187]
  ds_write_b64 v23, v[24:25] offset:4096
  v_xor_b32 v23, 32, v23
  v_mfma_f32_16x16x32_bf16 v[188:191], a[172:175], v[48:51], v[188:191]
  ds_write_b64 v23, v[26:27] offset:4096
  v_xor_b32 v23, 96, v23
  v_accvgpr_read_b32 v240, a40
  v_mfma_f32_16x16x32_bf16 v[192:195], a[176:179], v[48:51], v[192:195]
  v_accvgpr_read_b32 v241, a41
  v_accvgpr_read_b32 v242, a42
  v_accvgpr_read_b32 v243, a43
  v_mfma_f32_16x16x32_bf16 v[196:199], a[180:183], v[48:51], v[196:199]
  v_accvgpr_read_b32 v244, a44
  v_accvgpr_read_b32 v245, a45
  v_accvgpr_read_b32 v246, a46
  v_accvgpr_read_b32 v247, a47
  v_pk_mul_f32 v[240:241], v[240:241], v[22:23] op_sel_hi:[1,0]
  v_pk_mul_f32 v[242:243], v[242:243], v[22:23] op_sel_hi:[1,0]
  v_pk_mul_f32 v[244:245], v[244:245], v[22:23] op_sel_hi:[1,0]
  v_pk_mul_f32 v[246:247], v[246:247], v[22:23] op_sel_hi:[1,0]
  v_mfma_f32_16x16x32_bf16 v[200:203], a[184:187], v[48:51], v[200:203]
  v_cvt_pk_bf16_f32 v28, v240, v241
  v_mfma_f32_16x16x32_bf16 v[204:207], a[188:191], v[48:51], v[204:207]
  v_cvt_pk_bf16_f32 v29, v242, v243
  v_mfma_f32_16x16x32_bf16 a[208:211], a[216:219], v[48:51], a[208:211]
  v_mfma_f32_16x16x32_bf16 v[40:43], a[128:131], v[144:147], v[72:75]
  v_exp_f32 v32, v32
  v_exp_f32 v33, v33
  v_mfma_f32_16x16x32_bf16 v[40:43], a[132:135], v[148:151], v[40:43]
  v_exp_f32 v34, v34
  v_mfma_f32_16x16x32_bf16 v[40:43], a[136:139], v[152:155], v[40:43]
  v_cvt_pk_bf16_f32 v48, v32, v33
  v_exp_f32 v35, v35
  v_mfma_f32_16x16x32_bf16 v[40:43], a[140:143], v[156:159], v[40:43]
  v_exp_f32 v36, v36
  v_mfma_f32_16x16x32_bf16 v[44:47], a[144:147], v[144:147], v[72:75]
  v_cvt_pk_bf16_f32 v49, v34, v35
  v_exp_f32 v37, v37
  v_mfma_f32_16x16x32_bf16 v[44:47], a[148:151], v[148:151], v[44:47]
  v_exp_f32 v38, v38
  v_cvt_pk_bf16_f32 v50, v36, v37
  v_mfma_f32_16x16x32_bf16 v[44:47], a[152:155], v[152:155], v[44:47]
  v_exp_f32 v39, v39
  v_mfma_f32_16x16x32_bf16 v[44:47], a[156:159], v[156:159], v[44:47]
  v_cvt_pk_bf16_f32 v51, v38, v39
  v_cvt_pk_bf16_f32 v30, v244, v245
  v_cvt_pk_bf16_f32 v31, v246, v247
  v_mfma_f32_16x16x32_bf16 v[208:211], a[160:163], v[52:55], v[208:211]
  ds_read_b64_tr_b16 a[160:161], v5 offset:49152
  ds_read_b64_tr_b16 a[162:163], v5 offset:53248
  ds_write_b64 v23, v[28:29] offset:4096
  v_xor_b32 v23, 32, v23
  ds_write_b64 v23, v[30:31] offset:4096
  v_mfma_f32_16x16x32_bf16 v[212:215], a[164:167], v[52:55], v[212:215]
  ds_read_b64_tr_b16 a[164:165], v6 offset:49152
  ds_read_b64_tr_b16 a[166:167], v6 offset:53248
  v_xor_b32 v23, 224, v23
  v_accvgpr_read_b32 v240, a48
  v_accvgpr_read_b32 v241, a49
  v_mfma_f32_16x16x32_bf16 v[216:219], a[168:171], v[52:55], v[216:219]
  ds_read_b64_tr_b16 a[168:169], v7 offset:49152
  ds_read_b64_tr_b16 a[170:171], v7 offset:53248
  v_accvgpr_read_b32 v242, a50
  v_accvgpr_read_b32 v243, a51
  v_mfma_f32_16x16x32_bf16 v[220:223], a[172:175], v[52:55], v[220:223]
  ds_read_b64_tr_b16 a[172:173], v8 offset:49152
  ds_read_b64_tr_b16 a[174:175], v8 offset:53248
  v_accvgpr_read_b32 v244, a52
  v_accvgpr_read_b32 v245, a53
  v_accvgpr_read_b32 v246, a54
  v_accvgpr_read_b32 v247, a55
  v_pk_mul_f32 v[240:241], v[240:241], v[22:23] op_sel_hi:[1,0]
  v_pk_mul_f32 v[242:243], v[242:243], v[22:23] op_sel_hi:[1,0]
  v_pk_mul_f32 v[244:245], v[244:245], v[22:23] op_sel_hi:[1,0]
  v_pk_mul_f32 v[246:247], v[246:247], v[22:23] op_sel_hi:[1,0]
  v_mfma_f32_16x16x32_bf16 v[224:227], a[176:179], v[52:55], v[224:227]
  ds_read_b64_tr_b16 a[176:177], v9 offset:49152
  ds_read_b64_tr_b16 a[178:179], v9 offset:53248
  v_cvt_pk_bf16_f32 v24, v240, v241
  v_mfma_f32_16x16x32_bf16 v[228:231], a[180:183], v[52:55], v[228:231]
  ds_read_b64_tr_b16 a[180:181], v10 offset:49152
  ds_read_b64_tr_b16 a[182:183], v10 offset:53248
  v_cvt_pk_bf16_f32 v25, v242, v243
  v_mfma_f32_16x16x32_bf16 v[232:235], a[184:187], v[52:55], v[232:235]
  ds_read_b64_tr_b16 a[184:185], v11 offset:49152
  ds_read_b64_tr_b16 a[186:187], v11 offset:53248
  v_cvt_pk_bf16_f32 v26, v244, v245
  v_mfma_f32_16x16x32_bf16 v[236:239], a[188:191], v[52:55], v[236:239]
  ds_read_b64_tr_b16 a[188:189], v12 offset:49152
  ds_read_b64_tr_b16 a[190:191], v12 offset:53248
  v_cvt_pk_bf16_f32 v27, v246, v247
  ds_write_b64 v23, v[24:25] offset:4096
  v_xor_b32 v23, 32, v23
  v_mfma_f32_16x16x32_bf16 a[212:215], a[216:219], v[52:55], a[212:215]
  ds_write_b64 v23, v[26:27] offset:4096
  v_xor_b32 v23, 96, v23
  v_mfma_f32_16x16x32_bf16 v[32:35], a[128:131], v[160:163], v[76:79]
  ds_read_b128 a[128:131], v1 offset:57344
  v_exp_f32 v40, v40
  v_exp_f32 v41, v41
  v_mfma_f32_16x16x32_bf16 v[32:35], a[132:135], v[164:167], v[32:35]
  ds_read_b128 a[132:135], v2 offset:57344
  v_exp_f32 v42, v42
  v_mfma_f32_16x16x32_bf16 v[32:35], a[136:139], v[168:171], v[32:35]
  ds_read_b128 a[136:139], v3 offset:57344
  v_cvt_pk_bf16_f32 v52, v40, v41
  v_exp_f32 v43, v43
  v_mfma_f32_16x16x32_bf16 v[32:35], a[140:143], v[172:175], v[32:35]
  ds_read_b128 a[140:143], v4 offset:57344
  v_exp_f32 v44, v44
  v_mfma_f32_16x16x32_bf16 v[36:39], a[144:147], v[160:163], v[76:79]
  ds_read_b128 a[144:147], v1 offset:61440
  v_cvt_pk_bf16_f32 v53, v42, v43
  v_exp_f32 v45, v45
  v_mfma_f32_16x16x32_bf16 v[36:39], a[148:151], v[164:167], v[36:39]
  ds_read_b128 a[148:151], v2 offset:61440
  v_exp_f32 v46, v46
  v_cvt_pk_bf16_f32 v54, v44, v45
  v_mfma_f32_16x16x32_bf16 v[36:39], a[152:155], v[168:171], v[36:39]
  ds_read_b128 a[152:155], v3 offset:61440
  v_exp_f32 v47, v47
  v_mfma_f32_16x16x32_bf16 v[36:39], a[156:159], v[172:175], v[36:39]
  ds_read_b128 a[156:159], v4 offset:61440
  v_cvt_pk_bf16_f32 v55, v46, v47
  v_accvgpr_read_b32 v240, a56
  v_accvgpr_read_b32 v241, a57
  s_waitcnt lgkmcnt(10)
  v_mfma_f32_16x16x32_bf16 a[96:99], a[160:163], v[48:51], a[96:99]
  v_accvgpr_read_b32 v242, a58
  v_accvgpr_read_b32 v243, a59
  v_accvgpr_read_b32 v244, a60
  v_mfma_f32_16x16x32_bf16 a[100:103], a[164:167], v[48:51], a[100:103]
  v_accvgpr_read_b32 v245, a61
  v_accvgpr_read_b32 v246, a62
  v_accvgpr_read_b32 v247, a63
  v_pk_mul_f32 v[240:241], v[240:241], v[22:23] op_sel_hi:[1,0]
  v_pk_mul_f32 v[242:243], v[242:243], v[22:23] op_sel_hi:[1,0]
  v_pk_mul_f32 v[244:245], v[244:245], v[22:23] op_sel_hi:[1,0]
  v_pk_mul_f32 v[246:247], v[246:247], v[22:23] op_sel_hi:[1,0]
  v_mfma_f32_16x16x32_bf16 a[104:107], a[168:171], v[48:51], a[104:107]
  v_cvt_pk_bf16_f32 v28, v240, v241
  v_mfma_f32_16x16x32_bf16 a[108:111], a[172:175], v[48:51], a[108:111]
  v_cvt_pk_bf16_f32 v29, v242, v243
  v_mfma_f32_16x16x32_bf16 a[112:115], a[176:179], v[48:51], a[112:115]
  v_cvt_pk_bf16_f32 v30, v244, v245
  v_cvt_pk_bf16_f32 v31, v246, v247
  v_mfma_f32_16x16x32_bf16 a[116:119], a[180:183], v[48:51], a[116:119]
  ds_write_b64 v23, v[28:29] offset:4096
  v_xor_b32 v23, 32, v23
  v_mfma_f32_16x16x32_bf16 a[120:123], a[184:187], v[48:51], a[120:123]
  ds_write_b64 v23, v[30:31] offset:4096
  v_accvgpr_read_b32 v23, a255
  ds_read_b128 a[32:35], v23 offset:4096
  v_mfma_f32_16x16x32_bf16 a[124:127], a[188:191], v[48:51], a[124:127]
  v_xor_b32 v23, 64, v23
  ds_read_b128 a[36:39], v23 offset:5120
  v_xor_b32 v23, 192, v23
  v_mfma_f32_16x16x32_bf16 a[204:207], a[216:219], v[48:51], a[204:207]
  ds_read_b128 a[40:43], v23 offset:6144
  v_xor_b32 v23, 64, v23
  s_waitcnt lgkmcnt(5)
  v_mfma_f32_16x16x32_bf16 v[40:43], a[128:131], v[128:131], v[68:71]
  v_exp_f32 v32, v32
  v_exp_f32 v33, v33
  v_mfma_f32_16x16x32_bf16 v[40:43], a[132:135], v[132:135], v[40:43]
  v_exp_f32 v34, v34
  v_mfma_f32_16x16x32_bf16 v[40:43], a[136:139], v[136:139], v[40:43]
  v_cvt_pk_bf16_f32 v48, v32, v33
  v_exp_f32 v35, v35
  v_mfma_f32_16x16x32_bf16 v[40:43], a[140:143], v[140:143], v[40:43]
  v_exp_f32 v36, v36
  v_cvt_pk_bf16_f32 v49, v34, v35
  v_mfma_f32_16x16x32_bf16 v[44:47], a[144:147], v[128:131], v[68:71]
  v_exp_f32 v37, v37
  v_mfma_f32_16x16x32_bf16 v[44:47], a[148:151], v[132:135], v[44:47]
  v_exp_f32 v38, v38
  v_cvt_pk_bf16_f32 v50, v36, v37
  v_mfma_f32_16x16x32_bf16 v[44:47], a[152:155], v[136:139], v[44:47]
  v_exp_f32 v39, v39
  s_nop 0
  v_cvt_pk_bf16_f32 v51, v38, v39
  v_mfma_f32_16x16x32_bf16 v[44:47], a[156:159], v[140:143], v[44:47]
  ds_read_b128 a[44:47], v23 offset:7168
  s_add_u32 s64, s51, 0
  s_waitcnt lgkmcnt(15)
  v_mfma_f32_16x16x32_bf16 v[176:179], a[160:163], v[52:55], v[176:179]
  buffer_store_dwordx4 a[0:3], v20, s[20:23], s64 offen offset:0 nt
  buffer_store_dwordx4 a[4:7], v20, s[20:23], s64 offen offset:1024 nt
  v_mfma_f32_16x16x32_bf16 v[180:183], a[164:167], v[52:55], v[180:183]
  buffer_store_dwordx4 a[8:11], v20, s[20:23], s64 offen offset:2048 nt
  buffer_store_dwordx4 a[12:15], v20, s[20:23], s64 offen offset:3072 nt
  v_accvgpr_read_b32 v23, a200
  v_mfma_f32_16x16x32_bf16 v[184:187], a[168:171], v[52:55], v[184:187]
  v_rcp_f32 v22, v23
  v_add_f32 v21, v21, v23
  v_mfma_f32_16x16x32_bf16 v[188:191], a[172:175], v[52:55], v[188:191]
  v_accvgpr_read_b32 v23, a254
  v_accvgpr_read_b32 v240, a64
  v_accvgpr_read_b32 v241, a65
  v_mfma_f32_16x16x32_bf16 v[192:195], a[176:179], v[52:55], v[192:195]
  v_accvgpr_read_b32 v242, a66
  v_accvgpr_read_b32 v243, a67
  v_mfma_f32_16x16x32_bf16 v[196:199], a[180:183], v[52:55], v[196:199]
  v_accvgpr_read_b32 v244, a68
  v_accvgpr_read_b32 v245, a69
  v_accvgpr_read_b32 v246, a70
  v_accvgpr_read_b32 v247, a71
  v_pk_mul_f32 v[240:241], v[240:241], v[22:23] op_sel_hi:[1,0]
  v_pk_mul_f32 v[242:243], v[242:243], v[22:23] op_sel_hi:[1,0]
  v_pk_mul_f32 v[244:245], v[244:245], v[22:23] op_sel_hi:[1,0]
  v_pk_mul_f32 v[246:247], v[246:247], v[22:23] op_sel_hi:[1,0]
  v_mfma_f32_16x16x32_bf16 v[200:203], a[184:187], v[52:55], v[200:203]
  v_cvt_pk_bf16_f32 v24, v240, v241
  v_mfma_f32_16x16x32_bf16 v[204:207], a[188:191], v[52:55], v[204:207]
  v_cvt_pk_bf16_f32 v25, v242, v243
  v_mfma_f32_16x16x32_bf16 a[208:211], a[216:219], v[52:55], a[208:211]
  v_cvt_pk_bf16_f32 v26, v244, v245
  v_mfma_f32_16x16x32_bf16 v[32:35], a[128:131], v[144:147], v[72:75]
  v_exp_f32 v40, v40
  v_exp_f32 v41, v41
  v_mfma_f32_16x16x32_bf16 v[32:35], a[132:135], v[148:151], v[32:35]
  v_exp_f32 v42, v42
  v_mfma_f32_16x16x32_bf16 v[32:35], a[136:139], v[152:155], v[32:35]
  v_cvt_pk_bf16_f32 v52, v40, v41
  v_exp_f32 v43, v43
  v_mfma_f32_16x16x32_bf16 v[32:35], a[140:143], v[156:159], v[32:35]
  v_exp_f32 v44, v44
  v_mfma_f32_16x16x32_bf16 v[36:39], a[144:147], v[144:147], v[72:75]
  v_cvt_pk_bf16_f32 v53, v42, v43
  v_exp_f32 v45, v45
  v_mfma_f32_16x16x32_bf16 v[36:39], a[148:151], v[148:151], v[36:39]
  v_exp_f32 v46, v46
  v_cvt_pk_bf16_f32 v54, v44, v45
  v_mfma_f32_16x16x32_bf16 v[36:39], a[152:155], v[152:155], v[36:39]
  v_exp_f32 v47, v47
  v_mfma_f32_16x16x32_bf16 v[36:39], a[156:159], v[156:159], v[36:39]
  v_cvt_pk_bf16_f32 v55, v46, v47
  v_cvt_pk_bf16_f32 v27, v246, v247
  ds_write_b64 v23, v[24:25] offset:0
  v_mfma_f32_16x16x32_bf16 v[208:211], a[160:163], v[48:51], v[208:211]
  ds_read_b64_tr_b16 a[160:161], v5 offset:57344
  ds_read_b64_tr_b16 a[162:163], v5 offset:61440
  v_xor_b32 v23, 32, v23
  ds_write_b64 v23, v[26:27] offset:0
  v_xor_b32 v23, 96, v23
  v_mfma_f32_16x16x32_bf16 v[212:215], a[164:167], v[48:51], v[212:215]
  ds_read_b64_tr_b16 a[164:165], v6 offset:57344
  ds_read_b64_tr_b16 a[166:167], v6 offset:61440
  v_accvgpr_read_b32 v240, a72
  v_accvgpr_read_b32 v241, a73
  v_accvgpr_read_b32 v242, a74
  v_mfma_f32_16x16x32_bf16 v[216:219], a[168:171], v[48:51], v[216:219]
  ds_read_b64_tr_b16 a[168:169], v7 offset:57344
  ds_read_b64_tr_b16 a[170:171], v7 offset:61440
  v_accvgpr_read_b32 v243, a75
  v_accvgpr_read_b32 v244, a76
  v_mfma_f32_16x16x32_bf16 v[220:223], a[172:175], v[48:51], v[220:223]
  ds_read_b64_tr_b16 a[172:173], v8 offset:57344
  ds_read_b64_tr_b16 a[174:175], v8 offset:61440
  v_accvgpr_read_b32 v245, a77
  v_accvgpr_read_b32 v246, a78
  v_accvgpr_read_b32 v247, a79
  v_pk_mul_f32 v[240:241], v[240:241], v[22:23] op_sel_hi:[1,0]
  v_pk_mul_f32 v[242:243], v[242:243], v[22:23] op_sel_hi:[1,0]
  v_pk_mul_f32 v[244:245], v[244:245], v[22:23] op_sel_hi:[1,0]
  v_pk_mul_f32 v[246:247], v[246:247], v[22:23] op_sel_hi:[1,0]
  v_mfma_f32_16x16x32_bf16 v[224:227], a[176:179], v[48:51], v[224:227]
  ds_read_b64_tr_b16 a[176:177], v9 offset:57344
  ds_read_b64_tr_b16 a[178:179], v9 offset:61440
  v_cvt_pk_bf16_f32 v28, v240, v241
  v_mfma_f32_16x16x32_bf16 v[228:231], a[180:183], v[48:51], v[228:231]
  ds_read_b64_tr_b16 a[180:181], v10 offset:57344
  ds_read_b64_tr_b16 a[182:183], v10 offset:61440
  v_cvt_pk_bf16_f32 v29, v242, v243
  v_mfma_f32_16x16x32_bf16 v[232:235], a[184:187], v[48:51], v[232:235]
  ds_read_b64_tr_b16 a[184:185], v11 offset:57344
  ds_read_b64_tr_b16 a[186:187], v11 offset:61440
  v_cvt_pk_bf16_f32 v30, v244, v245
  v_cvt_pk_bf16_f32 v31, v246, v247
  v_mfma_f32_16x16x32_bf16 v[236:239], a[188:191], v[48:51], v[236:239]
  ds_read_b64_tr_b16 a[188:189], v12 offset:57344
  ds_read_b64_tr_b16 a[190:191], v12 offset:61440
  ds_write_b64 v23, v[28:29] offset:0
  v_xor_b32 v23, 32, v23
  ds_write_b64 v23, v[30:31] offset:0
  v_mfma_f32_16x16x32_bf16 a[212:215], a[216:219], v[48:51], a[212:215]
  v_xor_b32 v23, 224, v23
  v_accvgpr_read_b32 v240, a80
  v_mfma_f32_16x16x32_bf16 v[40:43], a[128:131], v[160:163], v[76:79]
  v_exp_f32 v32, v32
  v_exp_f32 v33, v33
  v_mfma_f32_16x16x32_bf16 v[40:43], a[132:135], v[164:167], v[40:43]
  v_exp_f32 v34, v34
  v_mfma_f32_16x16x32_bf16 v[40:43], a[136:139], v[168:171], v[40:43]
  v_cvt_pk_bf16_f32 v48, v32, v33
  v_exp_f32 v35, v35
  v_mfma_f32_16x16x32_bf16 v[40:43], a[140:143], v[172:175], v[40:43]
  v_exp_f32 v36, v36
  v_mfma_f32_16x16x32_bf16 v[44:47], a[144:147], v[160:163], v[76:79]
  v_cvt_pk_bf16_f32 v49, v34, v35
  v_exp_f32 v37, v37
  v_mfma_f32_16x16x32_bf16 v[44:47], a[148:151], v[164:167], v[44:47]
  v_exp_f32 v38, v38
  v_cvt_pk_bf16_f32 v50, v36, v37
  v_mfma_f32_16x16x32_bf16 v[44:47], a[152:155], v[168:171], v[44:47]
  v_exp_f32 v39, v39
  v_mfma_f32_16x16x32_bf16 v[44:47], a[156:159], v[172:175], v[44:47]
  v_cvt_pk_bf16_f32 v51, v38, v39
  v_accvgpr_read_b32 v241, a81
  v_accvgpr_read_b32 v242, a82
  s_waitcnt lgkmcnt(2)
  v_mfma_f32_16x16x32_bf16 a[96:99], a[160:163], v[52:55], a[96:99]
  v_accvgpr_read_b32 v243, a83
  v_accvgpr_read_b32 v244, a84
  v_accvgpr_read_b32 v245, a85
  v_accvgpr_read_b32 v246, a86
  v_accvgpr_read_b32 v247, a87
  v_pk_mul_f32 v[240:241], v[240:241], v[22:23] op_sel_hi:[1,0]
  v_pk_mul_f32 v[242:243], v[242:243], v[22:23] op_sel_hi:[1,0]
  v_pk_mul_f32 v[244:245], v[244:245], v[22:23] op_sel_hi:[1,0]
  v_pk_mul_f32 v[246:247], v[246:247], v[22:23] op_sel_hi:[1,0]
  v_mfma_f32_16x16x32_bf16 a[100:103], a[164:167], v[52:55], a[100:103]
  v_cvt_pk_bf16_f32 v24, v240, v241
  v_mfma_f32_16x16x32_bf16 a[104:107], a[168:171], v[52:55], a[104:107]
  v_cvt_pk_bf16_f32 v25, v242, v243
  v_mfma_f32_16x16x32_bf16 a[108:111], a[172:175], v[52:55], a[108:111]
  v_cvt_pk_bf16_f32 v26, v244, v245
  v_mfma_f32_16x16x32_bf16 a[112:115], a[176:179], v[52:55], a[112:115]
  v_cvt_pk_bf16_f32 v27, v246, v247
  ds_write_b64 v23, v[24:25] offset:0
  v_mfma_f32_16x16x32_bf16 a[116:119], a[180:183], v[52:55], a[116:119]
  v_xor_b32 v23, 32, v23
  ds_write_b64 v23, v[26:27] offset:0
  v_mfma_f32_16x16x32_bf16 a[120:123], a[184:187], v[52:55], a[120:123]
  v_xor_b32 v23, 96, v23
  v_accvgpr_read_b32 v240, a88
  v_accvgpr_read_b32 v241, a89
  v_mfma_f32_16x16x32_bf16 a[124:127], a[188:191], v[52:55], a[124:127]
  v_accvgpr_read_b32 v242, a90
  v_accvgpr_read_b32 v243, a91
  v_accvgpr_read_b32 v244, a92
  v_mfma_f32_16x16x32_bf16 a[204:207], a[216:219], v[52:55], a[204:207]
  v_accvgpr_read_b32 v245, a93
  v_accvgpr_read_b32 v246, a94
  v_mfma_f32_16x16x32_bf16 v[176:179], a[160:163], v[48:51], v[176:179]
  v_exp_f32 v40, v40
  v_exp_f32 v41, v41
  v_exp_f32 v42, v42
  v_mfma_f32_16x16x32_bf16 v[180:183], a[164:167], v[48:51], v[180:183]
  v_cvt_pk_bf16_f32 v52, v40, v41
  v_exp_f32 v43, v43
  v_exp_f32 v44, v44
  v_mfma_f32_16x16x32_bf16 v[184:187], a[168:171], v[48:51], v[184:187]
  v_cvt_pk_bf16_f32 v53, v42, v43
  v_exp_f32 v45, v45
  v_exp_f32 v46, v46
  v_mfma_f32_16x16x32_bf16 v[188:191], a[172:175], v[48:51], v[188:191]
  v_cvt_pk_bf16_f32 v54, v44, v45
  v_exp_f32 v47, v47
  s_nop 0
  v_cvt_pk_bf16_f32 v55, v46, v47
  v_accvgpr_read_b32 v247, a95
  v_pk_mul_f32 v[240:241], v[240:241], v[22:23] op_sel_hi:[1,0]
  v_pk_mul_f32 v[242:243], v[242:243], v[22:23] op_sel_hi:[1,0]
  v_pk_mul_f32 v[244:245], v[244:245], v[22:23] op_sel_hi:[1,0]
  v_pk_mul_f32 v[246:247], v[246:247], v[22:23] op_sel_hi:[1,0]
  v_mfma_f32_16x16x32_bf16 v[192:195], a[176:179], v[48:51], v[192:195]
  v_cvt_pk_bf16_f32 v28, v240, v241
  v_mfma_f32_16x16x32_bf16 v[196:199], a[180:183], v[48:51], v[196:199]
  v_cvt_pk_bf16_f32 v29, v242, v243
  v_cvt_pk_bf16_f32 v30, v244, v245
  v_cvt_pk_bf16_f32 v31, v246, v247
  ds_write_b64 v23, v[28:29] offset:0
  v_xor_b32 v23, 32, v23
  v_mfma_f32_16x16x32_bf16 v[200:203], a[184:187], v[48:51], v[200:203]
  ds_write_b64 v23, v[30:31] offset:0
  v_accvgpr_read_b32 v23, a255
  ds_read_b128 a[64:67], v23 offset:0
  v_xor_b32 v23, 64, v23
  ds_read_b128 a[68:71], v23 offset:1024
  v_mfma_f32_16x16x32_bf16 v[204:207], a[188:191], v[48:51], v[204:207]
  v_xor_b32 v23, 192, v23
  ds_read_b128 a[72:75], v23 offset:2048
  v_xor_b32 v23, 64, v23
  ds_read_b128 a[76:79], v23 offset:3072
  s_add_u32 s64, s51, 4096
  v_mfma_f32_16x16x32_bf16 a[208:211], a[216:219], v[48:51], a[208:211]
  s_waitcnt lgkmcnt(15)
  buffer_store_dwordx4 a[32:35], v20, s[20:23], s64 offen offset:0 nt
  buffer_store_dwordx4 a[36:39], v20, s[20:23], s64 offen offset:1024 nt
  buffer_store_dwordx4 a[40:43], v20, s[20:23], s64 offen offset:2048 nt
  buffer_store_dwordx4 a[44:47], v20, s[20:23], s64 offen offset:3072 nt
  v_mfma_f32_16x16x32_bf16 v[208:211], a[160:163], v[52:55], v[208:211]
  v_mfma_f32_16x16x32_bf16 v[212:215], a[164:167], v[52:55], v[212:215]
  v_mfma_f32_16x16x32_bf16 v[216:219], a[168:171], v[52:55], v[216:219]
  v_mfma_f32_16x16x32_bf16 v[220:223], a[172:175], v[52:55], v[220:223]
  v_mfma_f32_16x16x32_bf16 v[224:227], a[176:179], v[52:55], v[224:227]
  v_mfma_f32_16x16x32_bf16 v[228:231], a[180:183], v[52:55], v[228:231]
  v_mfma_f32_16x16x32_bf16 v[232:235], a[184:187], v[52:55], v[232:235]
  v_mfma_f32_16x16x32_bf16 v[236:239], a[188:191], v[52:55], v[236:239]
  v_mfma_f32_16x16x32_bf16 a[212:215], a[216:219], v[52:55], a[212:215]
  s_mov_b32 s68, 1
  s_branch L_epi2
L_end:
  s_mov_b32 s68, 0
  v_mov_b32 v240, s32
  v_mov_b32 v241, s65
  v_mov_b32 v242, 131072
  ds_write_b32 v241, v240 offset:0
  s_waitcnt lgkmcnt(0)
  s_barrier
  ds_read_b32 v248, v242 offset:0
  ds_read_b32 v249, v242 offset:8192
  ds_read_b32 v250, v242 offset:16384
  ds_read_b32 v251, v242 offset:24576
  s_waitcnt lgkmcnt(0)
  v_or_b32 v240, v248, v249
  v_or3_b32 v240, v240, v250, v251
  s_nop 0
  v_readfirstlane_b32 s32, v240
  s_nop 1
  s_cmp_eq_u32 s32, 0
  s_cbranch_scc1 L_exit
L_max_pre:
  s_waitcnt vmcnt(0)
  s_barrier
  s_and_b32 s48, s32, 1
  s_add_u32 s49, s2, 256
  s_cmp_lg_u32 s48, 0
  s_cselect_b32 s26, s2, s49
  s_cselect_b32 s48, 1, 2
  s_andn2_b32 s32, s32, s48
  s_mov_b32 s31, 1
  s_mov_b32 s34, 0
  s_mov_b32 s27, 0xffff
  s_mul_i32 s33, s26, 98304
  buffer_load_dwordx4 v[80:83], v19, s[8:11], s33 offen offset:0
  buffer_load_dwordx4 v[84:87], v19, s[8:11], s33 offen offset:64
  buffer_load_dwordx4 v[88:91], v19, s[8:11], s33 offen offset:128
  buffer_load_dwordx4 v[92:95], v19, s[8:11], s33 offen offset:192
  s_add_u32 s33, s33, 4096
  buffer_load_dwordx4 v[96:99], v19, s[8:11], s33 offen offset:0
  buffer_load_dwordx4 v[100:103], v19, s[8:11], s33 offen offset:64
  buffer_load_dwordx4 v[104:107], v19, s[8:11], s33 offen offset:128
  buffer_load_dwordx4 v[108:111], v19, s[8:11], s33 offen offset:192
  s_add_u32 s33, s33, 4096
  buffer_load_dwordx4 v[112:115], v19, s[8:11], s33 offen offset:0
  buffer_load_dwordx4 v[116:119], v19, s[8:11], s33 offen offset:64
  buffer_load_dwordx4 v[120:123], v19, s[8:11], s33 offen offset:128
  buffer_load_dwordx4 v[124:127], v19, s[8:11], s33 offen offset:192
  s_add_u32 s33, s33, 4096
  buffer_load_dwordx4 v[128:131], v19, s[8:11], s33 offen offset:0
  buffer_load_dwordx4 v[132:135], v19, s[8:11], s33 offen offset:64
  buffer_load_dwordx4 v[136:139], v19, s[8:11], s33 offen offset:128
  buffer_load_dwordx4 v[140:143], v19, s[8:11], s33 offen offset:192
  s_add_u32 s33, s33, 4096
  buffer_load_dwordx4 v[144:147], v19, s[8:11], s33 offen offset:0
  buffer_load_dwordx4 v[148:151], v19, s[8:11], s33 offen offset:64
  buffer_load_dwordx4 v[152:155], v19, s[8:11], s33 offen offset:128
  buffer_load_dwordx4 v[156:159], v19, s[8:11], s33 offen offset:192
  s_add_u32 s33, s33, 4096
  buffer_load_dwordx4 v[160:163], v19, s[8:11], s33 offen offset:0
  buffer_load_dwordx4 v[164:167], v19, s[8:11], s33 offen offset:64
  buffer_load_dwordx4 v[168:171], v19, s[8:11], s33 offen offset:128
  buffer_load_dwordx4 v[172:175], v19, s[8:11], s33 offen offset:192
  s_add_u32 s33, s33, 4096
  s_waitcnt vmcnt(0)
  v_lshlrev_b32 v240, 16, v80
  v_and_b32 v241, s46, v80
  v_lshlrev_b32 v242, 16, v81
  v_and_b32 v243, s46, v81
  v_lshlrev_b32 v244, 16, v82
  v_and_b32 v245, s46, v82
  v_lshlrev_b32 v246, 16, v83
  v_and_b32 v247, s46, v83
  v_pk_mul_f32 v[240:241], v[240:241], s[44:45]
  v_pk_mul_f32 v[242:243], v[242:243], s[44:45]
  v_pk_mul_f32 v[244:245], v[244:245], s[44:45]
  v_pk_mul_f32 v[246:247], v[246:247], s[44:45]
  v_cvt_pk_bf16_f32 v80, v240, v241
  v_cvt_pk_bf16_f32 v81, v242, v243
  v_cvt_pk_bf16_f32 v82, v244, v245
  v_cvt_pk_bf16_f32 v83, v246, v247
  v_lshlrev_b32 v240, 16, v84
  v_and_b32 v241, s46, v84
  v_lshlrev_b32 v242, 16, v85
  v_and_b32 v243, s46, v85
  v_lshlrev_b32 v244, 16, v86
  v_and_b32 v245, s46, v86
  v_lshlrev_b32 v246, 16, v87
  v_and_b32 v247, s46, v87
  v_pk_mul_f32 v[240:241], v[240:241], s[44:45]
  v_pk_mul_f32 v[242:243], v[242:243], s[44:45]
  v_pk_mul_f32 v[244:245], v[244:245], s[44:45]
  v_pk_mul_f32 v[246:247], v[246:247], s[44:45]
  v_cvt_pk_bf16_f32 v84, v240, v241
  v_cvt_pk_bf16_f32 v85, v242, v243
  v_cvt_pk_bf16_f32 v86, v244, v245
  v_cvt_pk_bf16_f32 v87, v246, v247
  v_lshlrev_b32 v240, 16, v88
  v_and_b32 v241, s46, v88
  v_lshlrev_b32 v242, 16, v89
  v_and_b32 v243, s46, v89
  v_lshlrev_b32 v244, 16, v90
  v_and_b32 v245, s46, v90
  v_lshlrev_b32 v246, 16, v91
  v_and_b32 v247, s46, v91
  v_pk_mul_f32 v[240:241], v[240:241], s[44:45]
  v_pk_mul_f32 v[242:243], v[242:243], s[44:45]
  v_pk_mul_f32 v[244:245], v[244:245], s[44:45]
  v_pk_mul_f32 v[246:247], v[246:247], s[44:45]
  v_cvt_pk_bf16_f32 v88, v240, v241
  v_cvt_pk_bf16_f32 v89, v242, v243
  v_cvt_pk_bf16_f32 v90, v244, v245
  v_cvt_pk_bf16_f32 v91, v246, v247
  v_lshlrev_b32 v240, 16, v92
  v_and_b32 v241, s46, v92
  v_lshlrev_b32 v242, 16, v93
  v_and_b32 v243, s46, v93
  v_lshlrev_b32 v244, 16, v94
  v_and_b32 v245, s46, v94
  v_lshlrev_b32 v246, 16, v95
  v_and_b32 v247, s46, v95
  v_pk_mul_f32 v[240:241], v[240:241], s[44:45]
  v_pk_mul_f32 v[242:243], v[242:243], s[44:45]
  v_pk_mul_f32 v[244:245], v[244:245], s[44:45]
  v_pk_mul_f32 v[246:247], v[246:247], s[44:45]
  v_cvt_pk_bf16_f32 v92, v240, v241
  v_cvt_pk_bf16_f32 v93, v242, v243
  v_cvt_pk_bf16_f32 v94, v244, v245
  v_cvt_pk_bf16_f32 v95, v246, v247
  v_lshlrev_b32 v240, 16, v96
  v_and_b32 v241, s46, v96
  v_lshlrev_b32 v242, 16, v97
  v_and_b32 v243, s46, v97
  v_lshlrev_b32 v244, 16, v98
  v_and_b32 v245, s46, v98
  v_lshlrev_b32 v246, 16, v99
  v_and_b32 v247, s46, v99
  v_pk_mul_f32 v[240:241], v[240:241], s[44:45]
  v_pk_mul_f32 v[242:243], v[242:243], s[44:45]
  v_pk_mul_f32 v[244:245], v[244:245], s[44:45]
  v_pk_mul_f32 v[246:247], v[246:247], s[44:45]
  v_cvt_pk_bf16_f32 v96, v240, v241
  v_cvt_pk_bf16_f32 v97, v242, v243
  v_cvt_pk_bf16_f32 v98, v244, v245
  v_cvt_pk_bf16_f32 v99, v246, v247
  v_lshlrev_b32 v240, 16, v100
  v_and_b32 v241, s46, v100
  v_lshlrev_b32 v242, 16, v101
  v_and_b32 v243, s46, v101
  v_lshlrev_b32 v244, 16, v102
  v_and_b32 v245, s46, v102
  v_lshlrev_b32 v246, 16, v103
  v_and_b32 v247, s46, v103
  v_pk_mul_f32 v[240:241], v[240:241], s[44:45]
  v_pk_mul_f32 v[242:243], v[242:243], s[44:45]
  v_pk_mul_f32 v[244:245], v[244:245], s[44:45]
  v_pk_mul_f32 v[246:247], v[246:247], s[44:45]
  v_cvt_pk_bf16_f32 v100, v240, v241
  v_cvt_pk_bf16_f32 v101, v242, v243
  v_cvt_pk_bf16_f32 v102, v244, v245
  v_cvt_pk_bf16_f32 v103, v246, v247
  v_lshlrev_b32 v240, 16, v104
  v_and_b32 v241, s46, v104
  v_lshlrev_b32 v242, 16, v105
  v_and_b32 v243, s46, v105
  v_lshlrev_b32 v244, 16, v106
  v_and_b32 v245, s46, v106
  v_lshlrev_b32 v246, 16, v107
  v_and_b32 v247, s46, v107
  v_pk_mul_f32 v[240:241], v[240:241], s[44:45]
  v_pk_mul_f32 v[242:243], v[242:243], s[44:45]
  v_pk_mul_f32 v[244:245], v[244:245], s[44:45]
  v_pk_mul_f32 v[246:247], v[246:247], s[44:45]
  v_cvt_pk_bf16_f32 v104, v240, v241
  v_cvt_pk_bf16_f32 v105, v242, v243
  v_cvt_pk_bf16_f32 v106, v244, v245
  v_cvt_pk_bf16_f32 v107, v246, v247
  v_lshlrev_b32 v240, 16, v108
  v_and_b32 v241, s46, v108
  v_lshlrev_b32 v242, 16, v109
  v_and_b32 v243, s46, v109
  v_lshlrev_b32 v244, 16, v110
  v_and_b32 v245, s46, v110
  v_lshlrev_b32 v246, 16, v111
  v_and_b32 v247, s46, v111
  v_pk_mul_f32 v[240:241], v[240:241], s[44:45]
  v_pk_mul_f32 v[242:243], v[242:243], s[44:45]
  v_pk_mul_f32 v[244:245], v[244:245], s[44:45]
  v_pk_mul_f32 v[246:247], v[246:247], s[44:45]
  v_cvt_pk_bf16_f32 v108, v240, v241
  v_cvt_pk_bf16_f32 v109, v242, v243
  v_cvt_pk_bf16_f32 v110, v244, v245
  v_cvt_pk_bf16_f32 v111, v246, v247
  v_lshlrev_b32 v240, 16, v112
  v_and_b32 v241, s46, v112
  v_lshlrev_b32 v242, 16, v113
  v_and_b32 v243, s46, v113
  v_lshlrev_b32 v244, 16, v114
  v_and_b32 v245, s46, v114
  v_lshlrev_b32 v246, 16, v115
  v_and_b32 v247, s46, v115
  v_pk_mul_f32 v[240:241], v[240:241], s[44:45]
  v_pk_mul_f32 v[242:243], v[242:243], s[44:45]
  v_pk_mul_f32 v[244:245], v[244:245], s[44:45]
  v_pk_mul_f32 v[246:247], v[246:247], s[44:45]
  v_cvt_pk_bf16_f32 v112, v240, v241
  v_cvt_pk_bf16_f32 v113, v242, v243
  v_cvt_pk_bf16_f32 v114, v244, v245
  v_cvt_pk_bf16_f32 v115, v246, v247
  v_lshlrev_b32 v240, 16, v116
  v_and_b32 v241, s46, v116
  v_lshlrev_b32 v242, 16, v117
  v_and_b32 v243, s46, v117
  v_lshlrev_b32 v244, 16, v118
  v_and_b32 v245, s46, v118
  v_lshlrev_b32 v246, 16, v119
  v_and_b32 v247, s46, v119
  v_pk_mul_f32 v[240:241], v[240:241], s[44:45]
  v_pk_mul_f32 v[242:243], v[242:243], s[44:45]
  v_pk_mul_f32 v[244:245], v[244:245], s[44:45]
  v_pk_mul_f32 v[246:247], v[246:247], s[44:45]
  v_cvt_pk_bf16_f32 v116, v240, v241
  v_cvt_pk_bf16_f32 v117, v242, v243
  v_cvt_pk_bf16_f32 v118, v244, v245
  v_cvt_pk_bf16_f32 v119, v246, v247
  v_lshlrev_b32 v240, 16, v120
  v_and_b32 v241, s46, v120
  v_lshlrev_b32 v242, 16, v121
  v_and_b32 v243, s46, v121
  v_lshlrev_b32 v244, 16, v122
  v_and_b32 v245, s46, v122
  v_lshlrev_b32 v246, 16, v123
  v_and_b32 v247, s46, v123
  v_pk_mul_f32 v[240:241], v[240:241], s[44:45]
  v_pk_mul_f32 v[242:243], v[242:243], s[44:45]
  v_pk_mul_f32 v[244:245], v[244:245], s[44:45]
  v_pk_mul_f32 v[246:247], v[246:247], s[44:45]
  v_cvt_pk_bf16_f32 v120, v240, v241
  v_cvt_pk_bf16_f32 v121, v242, v243
  v_cvt_pk_bf16_f32 v122, v244, v245
  v_cvt_pk_bf16_f32 v123, v246, v247
  v_lshlrev_b32 v240, 16, v124
  v_and_b32 v241, s46, v124
  v_lshlrev_b32 v242, 16, v125
  v_and_b32 v243, s46, v125
  v_lshlrev_b32 v244, 16, v126
  v_and_b32 v245, s46, v126
  v_lshlrev_b32 v246, 16, v127
  v_and_b32 v247, s46, v127
  v_pk_mul_f32 v[240:241], v[240:241], s[44:45]
  v_pk_mul_f32 v[242:243], v[242:243], s[44:45]
  v_pk_mul_f32 v[244:245], v[244:245], s[44:45]
  v_pk_mul_f32 v[246:247], v[246:247], s[44:45]
  v_cvt_pk_bf16_f32 v124, v240, v241
  v_cvt_pk_bf16_f32 v125, v242, v243
  v_cvt_pk_bf16_f32 v126, v244, v245
  v_cvt_pk_bf16_f32 v127, v246, v247
  v_lshlrev_b32 v240, 16, v128
  v_and_b32 v241, s46, v128
  v_lshlrev_b32 v242, 16, v129
  v_and_b32 v243, s46, v129
  v_lshlrev_b32 v244, 16, v130
  v_and_b32 v245, s46, v130
  v_lshlrev_b32 v246, 16, v131
  v_and_b32 v247, s46, v131
  v_pk_mul_f32 v[240:241], v[240:241], s[44:45]
  v_pk_mul_f32 v[242:243], v[242:243], s[44:45]
  v_pk_mul_f32 v[244:245], v[244:245], s[44:45]
  v_pk_mul_f32 v[246:247], v[246:247], s[44:45]
  v_cvt_pk_bf16_f32 v128, v240, v241
  v_cvt_pk_bf16_f32 v129, v242, v243
  v_cvt_pk_bf16_f32 v130, v244, v245
  v_cvt_pk_bf16_f32 v131, v246, v247
  v_lshlrev_b32 v240, 16, v132
  v_and_b32 v241, s46, v132
  v_lshlrev_b32 v242, 16, v133
  v_and_b32 v243, s46, v133
  v_lshlrev_b32 v244, 16, v134
  v_and_b32 v245, s46, v134
  v_lshlrev_b32 v246, 16, v135
  v_and_b32 v247, s46, v135
  v_pk_mul_f32 v[240:241], v[240:241], s[44:45]
  v_pk_mul_f32 v[242:243], v[242:243], s[44:45]
  v_pk_mul_f32 v[244:245], v[244:245], s[44:45]
  v_pk_mul_f32 v[246:247], v[246:247], s[44:45]
  v_cvt_pk_bf16_f32 v132, v240, v241
  v_cvt_pk_bf16_f32 v133, v242, v243
  v_cvt_pk_bf16_f32 v134, v244, v245
  v_cvt_pk_bf16_f32 v135, v246, v247
  v_lshlrev_b32 v240, 16, v136
  v_and_b32 v241, s46, v136
  v_lshlrev_b32 v242, 16, v137
  v_and_b32 v243, s46, v137
  v_lshlrev_b32 v244, 16, v138
  v_and_b32 v245, s46, v138
  v_lshlrev_b32 v246, 16, v139
  v_and_b32 v247, s46, v139
  v_pk_mul_f32 v[240:241], v[240:241], s[44:45]
  v_pk_mul_f32 v[242:243], v[242:243], s[44:45]
  v_pk_mul_f32 v[244:245], v[244:245], s[44:45]
  v_pk_mul_f32 v[246:247], v[246:247], s[44:45]
  v_cvt_pk_bf16_f32 v136, v240, v241
  v_cvt_pk_bf16_f32 v137, v242, v243
  v_cvt_pk_bf16_f32 v138, v244, v245
  v_cvt_pk_bf16_f32 v139, v246, v247
  v_lshlrev_b32 v240, 16, v140
  v_and_b32 v241, s46, v140
  v_lshlrev_b32 v242, 16, v141
  v_and_b32 v243, s46, v141
  v_lshlrev_b32 v244, 16, v142
  v_and_b32 v245, s46, v142
  v_lshlrev_b32 v246, 16, v143
  v_and_b32 v247, s46, v143
  v_pk_mul_f32 v[240:241], v[240:241], s[44:45]
  v_pk_mul_f32 v[242:243], v[242:243], s[44:45]
  v_pk_mul_f32 v[244:245], v[244:245], s[44:45]
  v_pk_mul_f32 v[246:247], v[246:247], s[44:45]
  v_cvt_pk_bf16_f32 v140, v240, v241
  v_cvt_pk_bf16_f32 v141, v242, v243
  v_cvt_pk_bf16_f32 v142, v244, v245
  v_cvt_pk_bf16_f32 v143, v246, v247
  v_lshlrev_b32 v240, 16, v144
  v_and_b32 v241, s46, v144
  v_lshlrev_b32 v242, 16, v145
  v_and_b32 v243, s46, v145
  v_lshlrev_b32 v244, 16, v146
  v_and_b32 v245, s46, v146
  v_lshlrev_b32 v246, 16, v147
  v_and_b32 v247, s46, v147
  v_pk_mul_f32 v[240:241], v[240:241], s[44:45]
  v_pk_mul_f32 v[242:243], v[242:243], s[44:45]
  v_pk_mul_f32 v[244:245], v[244:245], s[44:45]
  v_pk_mul_f32 v[246:247], v[246:247], s[44:45]
  v_cvt_pk_bf16_f32 v144, v240, v241
  v_cvt_pk_bf16_f32 v145, v242, v243
  v_cvt_pk_bf16_f32 v146, v244, v245
  v_cvt_pk_bf16_f32 v147, v246, v247
  v_lshlrev_b32 v240, 16, v148
  v_and_b32 v241, s46, v148
  v_lshlrev_b32 v242, 16, v149
  v_and_b32 v243, s46, v149
  v_lshlrev_b32 v244, 16, v150
  v_and_b32 v245, s46, v150
  v_lshlrev_b32 v246, 16, v151
  v_and_b32 v247, s46, v151
  v_pk_mul_f32 v[240:241], v[240:241], s[44:45]
  v_pk_mul_f32 v[242:243], v[242:243], s[44:45]
  v_pk_mul_f32 v[244:245], v[244:245], s[44:45]
  v_pk_mul_f32 v[246:247], v[246:247], s[44:45]
  v_cvt_pk_bf16_f32 v148, v240, v241
  v_cvt_pk_bf16_f32 v149, v242, v243
  v_cvt_pk_bf16_f32 v150, v244, v245
  v_cvt_pk_bf16_f32 v151, v246, v247
  v_lshlrev_b32 v240, 16, v152
  v_and_b32 v241, s46, v152
  v_lshlrev_b32 v242, 16, v153
  v_and_b32 v243, s46, v153
  v_lshlrev_b32 v244, 16, v154
  v_and_b32 v245, s46, v154
  v_lshlrev_b32 v246, 16, v155
  v_and_b32 v247, s46, v155
  v_pk_mul_f32 v[240:241], v[240:241], s[44:45]
  v_pk_mul_f32 v[242:243], v[242:243], s[44:45]
  v_pk_mul_f32 v[244:245], v[244:245], s[44:45]
  v_pk_mul_f32 v[246:247], v[246:247], s[44:45]
  v_cvt_pk_bf16_f32 v152, v240, v241
  v_cvt_pk_bf16_f32 v153, v242, v243
  v_cvt_pk_bf16_f32 v154, v244, v245
  v_cvt_pk_bf16_f32 v155, v246, v247
  v_lshlrev_b32 v240, 16, v156
  v_and_b32 v241, s46, v156
  v_lshlrev_b32 v242, 16, v157
  v_and_b32 v243, s46, v157
  v_lshlrev_b32 v244, 16, v158
  v_and_b32 v245, s46, v158
  v_lshlrev_b32 v246, 16, v159
  v_and_b32 v247, s46, v159
  v_pk_mul_f32 v[240:241], v[240:241], s[44:45]
  v_pk_mul_f32 v[242:243], v[242:243], s[44:45]
  v_pk_mul_f32 v[244:245], v[244:245], s[44:45]
  v_pk_mul_f32 v[246:247], v[246:247], s[44:45]
  v_cvt_pk_bf16_f32 v156, v240, v241
  v_cvt_pk_bf16_f32 v157, v242, v243
  v_cvt_pk_bf16_f32 v158, v244, v245
  v_cvt_pk_bf16_f32 v159, v246, v247
  v_lshlrev_b32 v240, 16, v160
  v_and_b32 v241, s46, v160
  v_lshlrev_b32 v242, 16, v161
  v_and_b32 v243, s46, v161
  v_lshlrev_b32 v244, 16, v162
  v_and_b32 v245, s46, v162
  v_lshlrev_b32 v246, 16, v163
  v_and_b32 v247, s46, v163
  v_pk_mul_f32 v[240:241], v[240:241], s[44:45]
  v_pk_mul_f32 v[242:243], v[242:243], s[44:45]
  v_pk_mul_f32 v[244:245], v[244:245], s[44:45]
  v_pk_mul_f32 v[246:247], v[246:247], s[44:45]
  v_cvt_pk_bf16_f32 v160, v240, v241
  v_cvt_pk_bf16_f32 v161, v242, v243
  v_cvt_pk_bf16_f32 v162, v244, v245
  v_cvt_pk_bf16_f32 v163, v246, v247
  v_lshlrev_b32 v240, 16, v164
  v_and_b32 v241, s46, v164
  v_lshlrev_b32 v242, 16, v165
  v_and_b32 v243, s46, v165
  v_lshlrev_b32 v244, 16, v166
  v_and_b32 v245, s46, v166
  v_lshlrev_b32 v246, 16, v167
  v_and_b32 v247, s46, v167
  v_pk_mul_f32 v[240:241], v[240:241], s[44:45]
  v_pk_mul_f32 v[242:243], v[242:243], s[44:45]
  v_pk_mul_f32 v[244:245], v[244:245], s[44:45]
  v_pk_mul_f32 v[246:247], v[246:247], s[44:45]
  v_cvt_pk_bf16_f32 v164, v240, v241
  v_cvt_pk_bf16_f32 v165, v242, v243
  v_cvt_pk_bf16_f32 v166, v244, v245
  v_cvt_pk_bf16_f32 v167, v246, v247
  v_lshlrev_b32 v240, 16, v168
  v_and_b32 v241, s46, v168
  v_lshlrev_b32 v242, 16, v169
  v_and_b32 v243, s46, v169
  v_lshlrev_b32 v244, 16, v170
  v_and_b32 v245, s46, v170
  v_lshlrev_b32 v246, 16, v171
  v_and_b32 v247, s46, v171
  v_pk_mul_f32 v[240:241], v[240:241], s[44:45]
  v_pk_mul_f32 v[242:243], v[242:243], s[44:45]
  v_pk_mul_f32 v[244:245], v[244:245], s[44:45]
  v_pk_mul_f32 v[246:247], v[246:247], s[44:45]
  v_cvt_pk_bf16_f32 v168, v240, v241
  v_cvt_pk_bf16_f32 v169, v242, v243
  v_cvt_pk_bf16_f32 v170, v244, v245
  v_cvt_pk_bf16_f32 v171, v246, v247
  v_lshlrev_b32 v240, 16, v172
  v_and_b32 v241, s46, v172
  v_lshlrev_b32 v242, 16, v173
  v_and_b32 v243, s46, v173
  v_lshlrev_b32 v244, 16, v174
  v_and_b32 v245, s46, v174
  v_lshlrev_b32 v246, 16, v175
  v_and_b32 v247, s46, v175
  v_pk_mul_f32 v[240:241], v[240:241], s[44:45]
  v_pk_mul_f32 v[242:243], v[242:243], s[44:45]
  v_pk_mul_f32 v[244:245], v[244:245], s[44:45]
  v_pk_mul_f32 v[246:247], v[246:247], s[44:45]
  v_cvt_pk_bf16_f32 v172, v240, v241
  v_cvt_pk_bf16_f32 v173, v242, v243
  v_cvt_pk_bf16_f32 v174, v244, v245
  v_cvt_pk_bf16_f32 v175, v246, v247
  v_mov_b32 v59, 0xff800000
  v_mov_b32 v63, 0xff800000
  v_mov_b32 v67, 0xff800000
  v_mov_b32 v71, 0xff800000
  v_mov_b32 v75, 0xff800000
  v_mov_b32 v79, 0xff800000
  v_mbcnt_lo_u32_b32 v242, -1, 0
  v_mbcnt_hi_u32_b32 v242, -1, v242
  v_and_b32 v240, 15, v242
  v_lshrrev_b32 v241, 4, v242
  v_lshlrev_b32 v240, 8, v240
  v_lshl_add_u32 v21, v241, 4, v240
  s_mul_i32 s49, s26, 262144
  s_mov_b32 s50, 0
L_maxloop:
  buffer_load_dwordx4 a[128:131], v21, s[12:15], s49 offen offset:0
  buffer_load_dwordx4 a[132:135], v21, s[12:15], s49 offen offset:64
  buffer_load_dwordx4 a[136:139], v21, s[12:15], s49 offen offset:128
  buffer_load_dwordx4 a[140:143], v21, s[12:15], s49 offen offset:192
  s_waitcnt vmcnt(0)
  v_mfma_f32_16x16x32_bf16 v[32:35], a[128:131], v[80:83], 0
  v_mfma_f32_16x16x32_bf16 v[32:35], a[132:135], v[84:87], v[32:35]
  v_mfma_f32_16x16x32_bf16 v[32:35], a[136:139], v[88:91], v[32:35]
  v_mfma_f32_16x16x32_bf16 v[32:35], a[140:143], v[92:95], v[32:35]
  v_mfma_f32_16x16x32_bf16 v[36:39], a[128:131], v[96:99], 0
  v_mfma_f32_16x16x32_bf16 v[36:39], a[132:135], v[100:103], v[36:39]
  v_mfma_f32_16x16x32_bf16 v[36:39], a[136:139], v[104:107], v[36:39]
  v_mfma_f32_16x16x32_bf16 v[36:39], a[140:143], v[108:111], v[36:39]
  v_mfma_f32_16x16x32_bf16 v[40:43], a[128:131], v[112:115], 0
  v_mfma_f32_16x16x32_bf16 v[40:43], a[132:135], v[116:119], v[40:43]
  v_mfma_f32_16x16x32_bf16 v[40:43], a[136:139], v[120:123], v[40:43]
  v_mfma_f32_16x16x32_bf16 v[40:43], a[140:143], v[124:127], v[40:43]
  v_mfma_f32_16x16x32_bf16 v[44:47], a[128:131], v[128:131], 0
  v_mfma_f32_16x16x32_bf16 v[44:47], a[132:135], v[132:135], v[44:47]
  v_mfma_f32_16x16x32_bf16 v[44:47], a[136:139], v[136:139], v[44:47]
  v_mfma_f32_16x16x32_bf16 v[44:47], a[140:143], v[140:143], v[44:47]
  v_mfma_f32_16x16x32_bf16 v[240:243], a[128:131], v[144:147], 0
  v_mfma_f32_16x16x32_bf16 v[240:243], a[132:135], v[148:151], v[240:243]
  v_mfma_f32_16x16x32_bf16 v[240:243], a[136:139], v[152:155], v[240:243]
  v_mfma_f32_16x16x32_bf16 v[240:243], a[140:143], v[156:159], v[240:243]
  v_mfma_f32_16x16x32_bf16 v[244:247], a[128:131], v[160:163], 0
  v_mfma_f32_16x16x32_bf16 v[244:247], a[132:135], v[164:167], v[244:247]
  v_mfma_f32_16x16x32_bf16 v[244:247], a[136:139], v[168:171], v[244:247]
  v_mfma_f32_16x16x32_bf16 v[244:247], a[140:143], v[172:175], v[244:247]
  v_max3_f32 v59, v32, v33, v59
  v_max3_f32 v59, v34, v35, v59
  v_max3_f32 v63, v36, v37, v63
  v_max3_f32 v63, v38, v39, v63
  v_max3_f32 v67, v40, v41, v67
  v_max3_f32 v67, v42, v43, v67
  v_max3_f32 v71, v44, v45, v71
  v_max3_f32 v71, v46, v47, v71
  v_max3_f32 v75, v240, v241, v75
  v_max3_f32 v75, v242, v243, v75
  v_max3_f32 v79, v244, v245, v79
  v_max3_f32 v79, v246, v247, v79
  s_add_u32 s49, s49, 4096
  s_add_u32 s50, s50, 1
  s_cmp_lt_u32 s50, 64
  s_cbranch_scc1 L_maxloop
  s_mul_i32 s62, s26, 98304
  s_mul_i32 s49, s24, 20480
  s_add_u32 s62, s62, s49
  s_mul_i32 s28, s26, 262144
  s_add_u32 s33, s62, 0
  s_add_u32 m0, s65, 0
  s_nop 0
  buffer_load_dwordx4 v13, s[8:11], s33 offen offset:0 nt lds
  buffer_load_dwordx4 v14, s[8:11], s33 offen offset:1024 nt lds
  buffer_load_dwordx4 v15, s[8:11], s33 offen offset:2048 nt lds
  buffer_load_dwordx4 v16, s[8:11], s33 offen offset:3072 nt lds
  s_add_u32 m0, s25, 0
  s_nop 0
  buffer_load_dwordx4 v13, s[12:15], s28 offen offset:0 nt lds
  buffer_load_dwordx4 v14, s[12:15], s28 offen offset:1024 nt lds
  buffer_load_dwordx4 v15, s[12:15], s28 offen offset:2048 nt lds
  buffer_load_dwordx4 v16, s[12:15], s28 offen offset:3072 nt lds
  s_add_u32 s33, s62, 4096
  s_add_u32 m0, s65, 4096
  s_nop 0
  buffer_load_dwordx4 v13, s[8:11], s33 offen offset:0 nt lds
  buffer_load_dwordx4 v14, s[8:11], s33 offen offset:1024 nt lds
  buffer_load_dwordx4 v15, s[8:11], s33 offen offset:2048 nt lds
  buffer_load_dwordx4 v16, s[8:11], s33 offen offset:3072 nt lds
  s_branch L_stream
L_exit:
  s_endpgm
.section .rodata,"a"
.p2align 6
.amdhsa_kernel standalone__mha_softmax__near_ridge_kernel
  .amdhsa_next_free_vgpr 512
  .amdhsa_next_free_sgpr 80
  .amdhsa_accum_offset 256
  .amdhsa_group_segment_fixed_size 0
  .amdhsa_kernarg_size 48
  .amdhsa_user_sgpr_count 2
  .amdhsa_user_sgpr_kernarg_segment_ptr 1
  .amdhsa_system_sgpr_workgroup_id_x 1
.end_amdhsa_kernel
```
